```python
import torch

def _softmax(x, axis=-1):
    return torch.softmax(x, dim=axis)
def _gelu(x):
    return torch.nn.functional.gelu(x, approximate="tanh")
def _silu(x):
    return torch.nn.functional.silu(x)
def _sigmoid(x):
    return torch.sigmoid(x)
def _layernorm(x, axis=-1, eps=1e-5):
    m = x.mean(dim=axis, keepdim=True)
    v = x.var(dim=axis, keepdim=True, unbiased=False)
    return (x - m) / torch.sqrt(v + eps)
def _scatter_add(tgt, idx, src, axis=0):
    return tgt.clone().index_add_(axis, idx, src)
def _segment_sum(src, seg, n):
    out = torch.zeros((n,) + src.shape[1:], dtype=src.dtype)
    return out.index_add_(0, seg, src)
def _pad(x, pw):
    flat = tuple(v for pair in reversed(pw) for v in pair)
    return torch.nn.functional.pad(x, flat)

kernel_name = 'concat_heads__mha_block_cached__mha_block_cached__near_ridge'

def setup_inputs():

    _w = (lambda a: (lambda t: t.to(torch.bfloat16) if t.is_floating_point() else t)(torch.as_tensor(a)))
    def _A_setup():
        B, Sq, D = 8, 96, 640
        H, Sk, Dh = 32, 1024, 128
        return {
            "x": _w((lambda *s: torch.randn(*s, dtype=torch.bfloat16) * 0.8)(B, Sq, D)),
            "k_cache": _w((lambda *s: torch.randn(*s, dtype=torch.bfloat16) * 0.8)(B, H, Sk, Dh)),
            "v_cache": _w((lambda *s: torch.randn(*s, dtype=torch.bfloat16) * 0.05)(B, H, Sk, Dh)),
            "wq": _w((lambda *s: torch.randn(*s, dtype=torch.bfloat16) * 0.8)(D, H * Dh) * (D ** -0.5)),
            "wo": _w((lambda *s: torch.randn(*s, dtype=torch.bfloat16) * 0.05)(H * Dh, D) * ((H * Dh) ** -0.5)),
        }
    _A_in = _A_setup()

    def _B_setup():
        B, Sq, D = 8, 96, 640
        H, Sk, Dh = 32, 1024, 128
        return {
            "x": _w((lambda *s: torch.randn(*s, dtype=torch.bfloat16) * 0.8)(B, Sq, D)),
            "k_cache": _w((lambda *s: torch.randn(*s, dtype=torch.bfloat16) * 0.8)(B, H, Sk, Dh)),
            "v_cache": _w((lambda *s: torch.randn(*s, dtype=torch.bfloat16) * 0.05)(B, H, Sk, Dh)),
            "wq": _w((lambda *s: torch.randn(*s, dtype=torch.bfloat16) * 0.8)(D, H * Dh) * (D ** -0.5)),
            "wo": _w((lambda *s: torch.randn(*s, dtype=torch.bfloat16) * 0.05)(H * Dh, D) * ((H * Dh) ** -0.5)),
        }
    _B_in = _B_setup()

    return {
        "A_x": _A_in["x"],
        "A_k_cache": _A_in["k_cache"],
        "A_v_cache": _A_in["v_cache"],
        "A_wq": _A_in["wq"],
        "A_wo": _A_in["wo"],
        "B_x": _B_in["x"],
        "B_k_cache": _B_in["k_cache"],
        "B_v_cache": _B_in["v_cache"],
        "B_wq": _B_in["wq"],
        "B_wo": _B_in["wo"],
    }

def reference(A_x, A_k_cache, A_v_cache, A_wq, A_wo, B_x, B_k_cache, B_v_cache, B_wq, B_wo):
    def _A_ref(x, k_cache, v_cache, wq, wo):
        B, Sq, D = x.shape
        H, Dh = 32, 128
        q = (lambda x, *d: x.permute(*d))((x @ wq).reshape(B, Sq, H, Dh), 0, 2, 1, 3)
        scores = torch.einsum("bhqd,bhkd->bhqk", q, k_cache) * (Dh ** -0.5)
        p = _softmax(scores, axis=-1)
        o = torch.einsum("bhqk,bhkd->bhqd", p, v_cache)
        return (lambda x, *d: x.permute(*d))(o, 0, 2, 1, 3).reshape(B, Sq, H * Dh) @ wo

    def _B_ref(x, k_cache, v_cache, wq, wo):
        B, Sq, D = x.shape
        H, Dh = 32, 128
        q = (lambda x, *d: x.permute(*d))((x @ wq).reshape(B, Sq, H, Dh), 0, 2, 1, 3)
        scores = torch.einsum("bhqd,bhkd->bhqk", q, k_cache) * (Dh ** -0.5)
        p = _softmax(scores, axis=-1)
        o = torch.einsum("bhqk,bhkd->bhqd", p, v_cache)
        return (lambda x, *d: x.permute(*d))(o, 0, 2, 1, 3).reshape(B, Sq, H * Dh) @ wo

    a = _A_ref(A_x, A_k_cache, A_v_cache, A_wq, A_wo)
    b = _B_ref(B_x, B_k_cache, B_v_cache, B_wq, B_wo)
    return torch.concatenate([a, b], axis=-1)
```

```asm
; @launch grid=(256,1,1) block=(256,1,1) lds=163840
.amdgcn_target "amdgcn-amd-amdhsa--gfx950"
.text
.globl concat_heads__mha_block_cached__mha_block_cached__near_ridge_kernel
.p2align 8
.type concat_heads__mha_block_cached__mha_block_cached__near_ridge_kernel,@function
concat_heads__mha_block_cached__mha_block_cached__near_ridge_kernel:
  s_cmp_ge_u32 s2, 256
  s_cbranch_scc1 L_end
  s_load_dwordx4 s[16:19], s[0:1], 80
  s_load_dwordx2 s[14:15], s[0:1], 96
  s_bfe_u32 s43, s2, 0x10002
  s_mul_i32 s46, s43, 40
  s_add_u32 s0, s0, s46
  s_addc_u32 s1, s1, 0
  s_load_dwordx8 s[4:11], s[0:1], 0
  s_load_dwordx2 s[12:13], s[0:1], 32
  v_lshrrev_b32 v1, 6, v0
  v_and_b32 v0, 63, v0
  v_readfirstlane_b32 s3, v1
  s_and_b32 s46, s2, 7
  s_and_b32 s41, s2, 3
  s_lshr_b32 s42, s2, 5
  s_bfe_u32 s40, s2, 0x20003
  s_lshl_b32 s47, s40, 3
  s_add_u32 s47, s47, s46
  s_mul_i32 s44, s47, 13
  s_lshr_b32 s44, s44, 5
  s_add_u32 s44, s44, 3
  s_lshl_b32 s47, s42, 2
  s_add_u32 s47, s47, s41
  s_lshr_b32 s48, s47, 3
  s_mov_b32 s45, 0x54444444
  s_cmp_eq_u32 s48, 1
  s_cselect_b32 s45, 0x87776655, s45
  s_cmp_eq_u32 s48, 2
  s_cselect_b32 s45, 0xbbbbaa99, s45
  s_cmp_eq_u32 s48, 3
  s_cselect_b32 s45, 0xdddddddc, s45
  s_and_b32 s48, s47, 7
  s_lshl_b32 s48, s48, 2
  s_lshr_b32 s45, s45, s48
  s_and_b32 s45, s45, 15
  s_cmp_lg_u32 s3, 3
  s_cbranch_scc1 L_consumer
  v_lshrrev_b32 v40, 4, v0
  v_lshrrev_b32 v42, 3, v0
  v_mul_u32_u24 v42, 1280, v42
  v_and_b32 v43, 7, v0
  v_xor_b32 v43, v43, v40
  v_xor_b32 v41, 0, v43
  v_lshl_add_u32 v10, v41, 4, v42
  v_xor_b32 v41, 4, v43
  v_lshl_add_u32 v11, v41, 4, v42
  v_add_u32 v11, 9216, v11
  v_xor_b32 v41, 0, v43
  v_lshl_add_u32 v12, v41, 4, v42
  v_add_u32 v12, 18432, v12
  v_xor_b32 v41, 4, v43
  v_lshl_add_u32 v13, v41, 4, v42
  v_add_u32 v13, 27648, v13
  v_and_b32 v41, 15, v0
  v_lshlrev_b32 v42, 1, v40
  v_xor_b32 v43, v41, v42
  v_lshlrev_b32 v43, 4, v43
  v_lshl_add_u32 v6, v40, 13, v43
  v_xor_b32 v8, 128, v6
  v_add_u32 v7, 31744, v6
  v_add_u32 v9, 95232, v8
  v_add_u32 v8, 63488, v8
  s_lshl_b32 s48, s41, 3
  s_add_u32 s48, s48, s40
  s_lshl_b32 s58, s48, 8
  s_mul_i32 s59, s42, 122880
  s_mov_b32 s50, 0
  s_mul_i32 s65, s40, 5
  s_add_u32 s65, s65, 1
  s_lshr_b32 s65, s65, 1
  s_add_u32 s65, s65, s42
  s_cmp_ge_u32 s65, 10
  s_cselect_b32 s46, 10, 0
  s_sub_u32 s65, s65, s46
  s_lshl_b32 s46, s65, 7
  s_add_u32 s59, s59, s46
  s_lshl_b32 s46, s65, 19
  s_add_u32 s58, s58, s46
  s_waitcnt lgkmcnt(0)
  s_mov_b32 s32, s4
  s_and_b32 s33, s5, 0xffff
  s_mov_b32 s34, 983040
  s_mov_b32 s35, 0x20000
  s_mov_b32 s28, s10
  s_and_b32 s29, s11, 0xffff
  s_mov_b32 s30, 5242880
  s_mov_b32 s31, 0x20000
  s_mov_b32 s36, s12
  s_and_b32 s37, s13, 0xffff
  s_mov_b32 s38, 5242880
  s_mov_b32 s39, 0x20000
  s_mov_b32 s61, 2
L_h0:
  s_waitcnt vmcnt(59)
  s_add_u32 m0, s50, 16384
  s_nop 0
  buffer_load_dwordx4 v10, s[32:35], s59 offen offset:0 lds
  buffer_load_dwordx4 v11, s[32:35], s59 offen offset:1024 lds
  buffer_load_dwordx4 v12, s[32:35], s59 offen offset:2048 lds
  buffer_load_dwordx4 v13, s[32:35], s59 offen offset:3072 lds
  s_waitcnt vmcnt(59)
  s_add_u32 m0, s50, 20480
  s_add_u32 s66, s59, 40960
  buffer_load_dwordx4 v10, s[32:35], s66 offen offset:0 lds
  buffer_load_dwordx4 v11, s[32:35], s66 offen offset:1024 lds
  buffer_load_dwordx4 v12, s[32:35], s66 offen offset:2048 lds
  buffer_load_dwordx4 v13, s[32:35], s66 offen offset:3072 lds
  s_waitcnt vmcnt(59)
  s_add_u32 m0, s50, 24576
  s_add_u32 s66, s59, 81920
  buffer_load_dwordx4 v10, s[32:35], s66 offen offset:0 lds
  buffer_load_dwordx4 v11, s[32:35], s66 offen offset:1024 lds
  buffer_load_dwordx4 v12, s[32:35], s66 offen offset:2048 lds
  buffer_load_dwordx4 v13, s[32:35], s66 offen offset:3072 lds
  s_waitcnt vmcnt(59)
  s_add_u32 m0, s50, 0
  s_nop 0
  buffer_load_dwordx4 v6, s[28:31], s58 offen offset:0 lds
  buffer_load_dwordx4 v7, s[28:31], s58 offen offset:1024 lds
  buffer_load_dwordx4 v8, s[28:31], s58 offen offset:2048 lds
  buffer_load_dwordx4 v9, s[28:31], s58 offen offset:3072 lds
  s_waitcnt vmcnt(59)
  s_add_u32 m0, s50, 4096
  s_add_u32 s66, s58, 131072
  buffer_load_dwordx4 v6, s[28:31], s66 offen offset:0 lds
  buffer_load_dwordx4 v7, s[28:31], s66 offen offset:1024 lds
  buffer_load_dwordx4 v8, s[28:31], s66 offen offset:2048 lds
  buffer_load_dwordx4 v9, s[28:31], s66 offen offset:3072 lds
  s_waitcnt vmcnt(59)
  s_add_u32 m0, s50, 8192
  s_add_u32 s66, s58, 262144
  buffer_load_dwordx4 v6, s[28:31], s66 offen offset:0 lds
  buffer_load_dwordx4 v7, s[28:31], s66 offen offset:1024 lds
  buffer_load_dwordx4 v8, s[28:31], s66 offen offset:2048 lds
  buffer_load_dwordx4 v9, s[28:31], s66 offen offset:3072 lds
  s_waitcnt vmcnt(59)
  s_add_u32 m0, s50, 12288
  s_add_u32 s66, s58, 393216
  buffer_load_dwordx4 v6, s[28:31], s66 offen offset:0 lds
  buffer_load_dwordx4 v7, s[28:31], s66 offen offset:1024 lds
  buffer_load_dwordx4 v8, s[28:31], s66 offen offset:2048 lds
  buffer_load_dwordx4 v9, s[28:31], s66 offen offset:3072 lds
  s_add_u32 s65, s65, 1
  s_cmp_eq_u32 s65, 10
  s_cselect_b32 s65, 0, s65
  s_cselect_b32 s66, -9, 1
  s_lshl_b32 s46, s66, 7
  s_lshl_b32 s66, s66, 19
  s_add_u32 s59, s59, s46
  s_add_u32 s58, s58, s66
  s_add_u32 s50, s50, 40960
  s_cmp_eq_u32 s50, 163840
  s_cselect_b32 s50, 0, s50
  s_sub_u32 s61, s61, 1
  s_cmp_lg_u32 s61, 0
  s_cbranch_scc1 L_h0
  s_waitcnt vmcnt(28)
  s_barrier
  s_mov_b32 s61, 2
L_h1:
  s_waitcnt vmcnt(59)
  s_add_u32 m0, s50, 16384
  s_nop 0
  buffer_load_dwordx4 v10, s[32:35], s59 offen offset:0 lds
  buffer_load_dwordx4 v11, s[32:35], s59 offen offset:1024 lds
  buffer_load_dwordx4 v12, s[32:35], s59 offen offset:2048 lds
  buffer_load_dwordx4 v13, s[32:35], s59 offen offset:3072 lds
  s_waitcnt vmcnt(59)
  s_add_u32 m0, s50, 20480
  s_add_u32 s66, s59, 40960
  buffer_load_dwordx4 v10, s[32:35], s66 offen offset:0 lds
  buffer_load_dwordx4 v11, s[32:35], s66 offen offset:1024 lds
  buffer_load_dwordx4 v12, s[32:35], s66 offen offset:2048 lds
  buffer_load_dwordx4 v13, s[32:35], s66 offen offset:3072 lds
  s_waitcnt vmcnt(59)
  s_add_u32 m0, s50, 24576
  s_add_u32 s66, s59, 81920
  buffer_load_dwordx4 v10, s[32:35], s66 offen offset:0 lds
  buffer_load_dwordx4 v11, s[32:35], s66 offen offset:1024 lds
  buffer_load_dwordx4 v12, s[32:35], s66 offen offset:2048 lds
  buffer_load_dwordx4 v13, s[32:35], s66 offen offset:3072 lds
  s_waitcnt vmcnt(59)
  s_add_u32 m0, s50, 0
  s_nop 0
  buffer_load_dwordx4 v6, s[28:31], s58 offen offset:0 lds
  buffer_load_dwordx4 v7, s[28:31], s58 offen offset:1024 lds
  buffer_load_dwordx4 v8, s[28:31], s58 offen offset:2048 lds
  buffer_load_dwordx4 v9, s[28:31], s58 offen offset:3072 lds
  s_waitcnt vmcnt(59)
  s_add_u32 m0, s50, 4096
  s_add_u32 s66, s58, 131072
  buffer_load_dwordx4 v6, s[28:31], s66 offen offset:0 lds
  buffer_load_dwordx4 v7, s[28:31], s66 offen offset:1024 lds
  buffer_load_dwordx4 v8, s[28:31], s66 offen offset:2048 lds
  buffer_load_dwordx4 v9, s[28:31], s66 offen offset:3072 lds
  s_waitcnt vmcnt(59)
  s_add_u32 m0, s50, 8192
  s_add_u32 s66, s58, 262144
  buffer_load_dwordx4 v6, s[28:31], s66 offen offset:0 lds
  buffer_load_dwordx4 v7, s[28:31], s66 offen offset:1024 lds
  buffer_load_dwordx4 v8, s[28:31], s66 offen offset:2048 lds
  buffer_load_dwordx4 v9, s[28:31], s66 offen offset:3072 lds
  s_waitcnt vmcnt(59)
  s_add_u32 m0, s50, 12288
  s_add_u32 s66, s58, 393216
  buffer_load_dwordx4 v6, s[28:31], s66 offen offset:0 lds
  buffer_load_dwordx4 v7, s[28:31], s66 offen offset:1024 lds
  buffer_load_dwordx4 v8, s[28:31], s66 offen offset:2048 lds
  buffer_load_dwordx4 v9, s[28:31], s66 offen offset:3072 lds
  s_add_u32 s65, s65, 1
  s_cmp_eq_u32 s65, 10
  s_cselect_b32 s65, 0, s65
  s_cselect_b32 s66, -9, 1
  s_lshl_b32 s46, s66, 7
  s_lshl_b32 s66, s66, 19
  s_add_u32 s59, s59, s46
  s_add_u32 s58, s58, s66
  s_add_u32 s50, s50, 40960
  s_cmp_eq_u32 s50, 163840
  s_cselect_b32 s50, 0, s50
  s_sub_u32 s61, s61, 1
  s_cmp_lg_u32 s61, 0
  s_cbranch_scc1 L_h1
  v_mov_b32 v44, 0
  v_lshl_add_u32 v34, v40, 8, v43
  v_xor_b32 v35, 128, v34
  v_lshlrev_b32 v42, 2, v40
  v_xor_b32 v42, v41, v42
  v_lshlrev_b32 v42, 4, v42
  v_lshl_add_u32 v42, v40, 8, v42
  v_add_u32 v2, 128, v42
  v_add_u32 v3, 96, v42
  v_add_u32 v4, 64, v42
  v_add_u32 v5, 32, v42
  s_sub_u32 s6, s6, 128
  s_subb_u32 s7, s7, 0
  s_mov_b32 s20, s6
  s_and_b32 s21, s7, 0xffff
  s_mov_b32 s22, 67108992
  s_mov_b32 s23, 0x20000
  s_mov_b32 s24, s8
  s_and_b32 s25, s9, 0xffff
  s_mov_b32 s26, 67108864
  s_mov_b32 s27, 0x20000
  s_mov_b32 s96, s14
  s_and_b32 s97, s15, 0xffff
  s_mov_b32 s98, 25493504
  s_mov_b32 s99, 0x20000
  s_lshl_b32 s56, s42, 5
  s_add_u32 s56, s56, s48
  s_lshl_b32 s56, s56, 18
  s_mov_b32 s57, s56
  s_mov_b32 s55, 1
  s_mov_b32 s60, 0
  s_mov_b32 s53, 28
  s_mov_b32 s54, 28
  v_lshlrev_b32 v48, 4, v0
  s_mul_i32 s64, s42, 655360
  s_lshl_b32 s47, s48, 8
  s_add_u32 s64, s64, s47
  s_add_u32 s64, s64, 1024
  s_mul_i32 s51, s41, 1310720
  s_lshr_b32 s47, s2, 3
  s_mul_i32 s47, s47, 40960
  s_add_u32 s51, s51, s47
  s_mov_b32 s61, 2
  s_call_b64 s[68:69], L_rwq
  global_load_dwordx2 v[46:47], v44, s[18:19] sc1
  s_mov_b32 s61, 4
  s_call_b64 s[68:69], L_rwqp
  s_add_u32 s58, s58, 1024
  s_mov_b32 s46, 0
L_nget1:
  v_cmp_eq_u32 vcc, 0, v46
  s_cbranch_vccz L_nget2
  global_load_dwordx2 v[46:47], v44, s[18:19] sc1
  s_waitcnt vmcnt(0)
  s_add_u32 s46, s46, 1
  s_cmp_lt_u32 s46, 0x200000
  s_cbranch_scc1 L_nget1
L_nget2:
  v_mov_b32 v45, 40000
  ds_write_b64 v45, v[46:47]
  s_getreg_b32 s46, hwreg(HW_REG_XCC_ID, 0, 4)
  v_mov_b32 v56, v46
  v_mov_b32 v57, v47
  v_mov_b32 v58, s46
  v_mov_b32 v59, 0
  s_lshl_b32 s46, s2, 7
  s_add_u32 s46, s46, 25460736
  s_mov_b64 exec, 1
  buffer_store_dwordx4 v[56:59], v44, s[96:99], s46 offen sc1
  s_mov_b64 exec, -1
  s_waitcnt lgkmcnt(0)
  s_add_u32 s67, s53, s54
  s_cmp_ge_u32 s67, 56
  s_cbranch_scc0 Lws_1
  s_waitcnt vmcnt(56)
Lwb_2:
  s_barrier
  s_mov_b32 s53, s54
  s_mov_b32 s54, 16
  s_waitcnt vmcnt(59)
  s_add_u32 m0, s50, 0
  s_nop 0
  buffer_load_dwordx4 v2, s[20:23], s56 offen offset:0 nt lds
  buffer_load_dwordx4 v3, s[20:23], s56 offen offset:1056 nt lds
  buffer_load_dwordx4 v4, s[20:23], s56 offen offset:2112 nt lds
  buffer_load_dwordx4 v5, s[20:23], s56 offen offset:3168 nt lds
  s_waitcnt vmcnt(59)
  s_add_u32 m0, s50, 4224
  s_add_u32 s66, s56, 4096
  buffer_load_dwordx4 v2, s[20:23], s66 offen offset:0 nt lds
  buffer_load_dwordx4 v3, s[20:23], s66 offen offset:1056 nt lds
  buffer_load_dwordx4 v4, s[20:23], s66 offen offset:2112 nt lds
  buffer_load_dwordx4 v5, s[20:23], s66 offen offset:3168 nt lds
  s_waitcnt vmcnt(59)
  s_add_u32 m0, s50, 8448
  s_add_u32 s66, s56, 8192
  buffer_load_dwordx4 v2, s[20:23], s66 offen offset:0 nt lds
  buffer_load_dwordx4 v3, s[20:23], s66 offen offset:1056 nt lds
  buffer_load_dwordx4 v4, s[20:23], s66 offen offset:2112 nt lds
  buffer_load_dwordx4 v5, s[20:23], s66 offen offset:3168 nt lds
  s_waitcnt vmcnt(59)
  s_add_u32 m0, s50, 12672
  s_add_u32 s66, s56, 12288
  buffer_load_dwordx4 v2, s[20:23], s66 offen offset:0 nt lds
  buffer_load_dwordx4 v3, s[20:23], s66 offen offset:1056 nt lds
  buffer_load_dwordx4 v4, s[20:23], s66 offen offset:2112 nt lds
  buffer_load_dwordx4 v5, s[20:23], s66 offen offset:3168 nt lds
  s_add_u32 s56, s56, 16384
  s_add_u32 s50, s50, 40960
  s_cmp_eq_u32 s50, 163840
  s_cselect_b32 s50, 0, s50
  s_mov_b32 s61, 1
  s_call_b64 s[68:69], L_rkv
  v_add_u32 v40, 0, v0
  v_mul_u32_u24 v41, 3277, v40
  v_lshrrev_b32 v41, 16, v41
  v_mul_u32_u24 v42, 20, v41
  v_sub_u32 v42, v40, v42
  v_bfe_u32 v43, v41, 2, 1
  v_lshlrev_b32 v43, 1, v43
  v_xor_b32 v42, v42, v43
  v_mul_u32_u24 v41, 1280, v41
  v_lshl_add_u32 v14, v42, 4, v41
  v_add_u32 v40, 64, v0
  v_mul_u32_u24 v41, 3277, v40
  v_lshrrev_b32 v41, 16, v41
  v_mul_u32_u24 v42, 20, v41
  v_sub_u32 v42, v40, v42
  v_bfe_u32 v43, v41, 2, 1
  v_lshlrev_b32 v43, 1, v43
  v_xor_b32 v42, v42, v43
  v_mul_u32_u24 v41, 1280, v41
  v_lshl_add_u32 v15, v42, 4, v41
  v_subrev_u32 v15, 1024, v15
  v_add_u32 v40, 128, v0
  v_mul_u32_u24 v41, 3277, v40
  v_lshrrev_b32 v41, 16, v41
  v_mul_u32_u24 v42, 20, v41
  v_sub_u32 v42, v40, v42
  v_bfe_u32 v43, v41, 2, 1
  v_lshlrev_b32 v43, 1, v43
  v_xor_b32 v42, v42, v43
  v_mul_u32_u24 v41, 1280, v41
  v_lshl_add_u32 v16, v42, 4, v41
  v_subrev_u32 v16, 2048, v16
  v_add_u32 v40, 192, v0
  v_mul_u32_u24 v41, 3277, v40
  v_lshrrev_b32 v41, 16, v41
  v_mul_u32_u24 v42, 20, v41
  v_sub_u32 v42, v40, v42
  v_bfe_u32 v43, v41, 2, 1
  v_lshlrev_b32 v43, 1, v43
  v_xor_b32 v42, v42, v43
  v_mul_u32_u24 v41, 1280, v41
  v_lshl_add_u32 v17, v42, 4, v41
  v_subrev_u32 v17, 3072, v17
  v_add_u32 v40, 256, v0
  v_mul_u32_u24 v41, 3277, v40
  v_lshrrev_b32 v41, 16, v41
  v_mul_u32_u24 v42, 20, v41
  v_sub_u32 v42, v40, v42
  v_bfe_u32 v43, v41, 2, 1
  v_lshlrev_b32 v43, 1, v43
  v_xor_b32 v42, v42, v43
  v_mul_u32_u24 v41, 1280, v41
  v_lshl_add_u32 v18, v42, 4, v41
  v_add_u32 v40, 0, v0
  v_mul_u32_u24 v41, 3277, v40
  v_lshrrev_b32 v41, 16, v41
  v_mul_u32_u24 v42, 20, v41
  v_sub_u32 v42, v40, v42
  v_bfe_u32 v43, v41, 2, 1
  v_lshlrev_b32 v43, 1, v43
  v_xor_b32 v42, v42, v43
  v_mul_u32_u24 v41, 1280, v41
  v_lshl_add_u32 v19, v42, 4, v41
  v_add_u32 v19, 19456, v19
  v_add_u32 v40, 64, v0
  v_mul_u32_u24 v41, 3277, v40
  v_lshrrev_b32 v41, 16, v41
  v_mul_u32_u24 v42, 20, v41
  v_sub_u32 v42, v40, v42
  v_bfe_u32 v43, v41, 2, 1
  v_lshlrev_b32 v43, 1, v43
  v_xor_b32 v42, v42, v43
  v_mul_u32_u24 v41, 1280, v41
  v_lshl_add_u32 v20, v42, 4, v41
  v_add_u32 v20, 18432, v20
  v_add_u32 v40, 128, v0
  v_mul_u32_u24 v41, 3277, v40
  v_lshrrev_b32 v41, 16, v41
  v_mul_u32_u24 v42, 20, v41
  v_sub_u32 v42, v40, v42
  v_bfe_u32 v43, v41, 2, 1
  v_lshlrev_b32 v43, 1, v43
  v_xor_b32 v42, v42, v43
  v_mul_u32_u24 v41, 1280, v41
  v_lshl_add_u32 v21, v42, 4, v41
  v_add_u32 v21, 17408, v21
  v_add_u32 v40, 192, v0
  v_mul_u32_u24 v41, 3277, v40
  v_lshrrev_b32 v41, 16, v41
  v_mul_u32_u24 v42, 20, v41
  v_sub_u32 v42, v40, v42
  v_bfe_u32 v43, v41, 2, 1
  v_lshlrev_b32 v43, 1, v43
  v_xor_b32 v42, v42, v43
  v_mul_u32_u24 v41, 1280, v41
  v_lshl_add_u32 v22, v42, 4, v41
  v_add_u32 v40, 256, v0
  v_mul_u32_u24 v41, 3277, v40
  v_lshrrev_b32 v41, 16, v41
  v_mul_u32_u24 v42, 20, v41
  v_sub_u32 v42, v40, v42
  v_bfe_u32 v43, v41, 2, 1
  v_lshlrev_b32 v43, 1, v43
  v_xor_b32 v42, v42, v43
  v_mul_u32_u24 v41, 1280, v41
  v_lshl_add_u32 v23, v42, 4, v41
  v_subrev_u32 v23, 1024, v23
  v_add_u32 v40, 0, v0
  v_mul_u32_u24 v41, 3277, v40
  v_lshrrev_b32 v41, 16, v41
  v_mul_u32_u24 v42, 20, v41
  v_sub_u32 v42, v40, v42
  v_bfe_u32 v43, v41, 2, 1
  v_lshlrev_b32 v43, 1, v43
  v_xor_b32 v42, v42, v43
  v_mul_u32_u24 v41, 1280, v41
  v_lshl_add_u32 v24, v42, 4, v41
  v_add_u32 v24, 18432, v24
  v_add_u32 v40, 64, v0
  v_mul_u32_u24 v41, 3277, v40
  v_lshrrev_b32 v41, 16, v41
  v_mul_u32_u24 v42, 20, v41
  v_sub_u32 v42, v40, v42
  v_bfe_u32 v43, v41, 2, 1
  v_lshlrev_b32 v43, 1, v43
  v_xor_b32 v42, v42, v43
  v_mul_u32_u24 v41, 1280, v41
  v_lshl_add_u32 v25, v42, 4, v41
  v_add_u32 v25, 17408, v25
  v_add_u32 v40, 128, v0
  v_mul_u32_u24 v41, 3277, v40
  v_lshrrev_b32 v41, 16, v41
  v_mul_u32_u24 v42, 20, v41
  v_sub_u32 v42, v40, v42
  v_bfe_u32 v43, v41, 2, 1
  v_lshlrev_b32 v43, 1, v43
  v_xor_b32 v42, v42, v43
  v_mul_u32_u24 v41, 1280, v41
  v_lshl_add_u32 v26, v42, 4, v41
  v_add_u32 v40, 192, v0
  v_mul_u32_u24 v41, 3277, v40
  v_lshrrev_b32 v41, 16, v41
  v_mul_u32_u24 v42, 20, v41
  v_sub_u32 v42, v40, v42
  v_bfe_u32 v43, v41, 2, 1
  v_lshlrev_b32 v43, 1, v43
  v_xor_b32 v42, v42, v43
  v_mul_u32_u24 v41, 1280, v41
  v_lshl_add_u32 v27, v42, 4, v41
  v_subrev_u32 v27, 1024, v27
  v_add_u32 v40, 256, v0
  v_mul_u32_u24 v41, 3277, v40
  v_lshrrev_b32 v41, 16, v41
  v_mul_u32_u24 v42, 20, v41
  v_sub_u32 v42, v40, v42
  v_bfe_u32 v43, v41, 2, 1
  v_lshlrev_b32 v43, 1, v43
  v_xor_b32 v42, v42, v43
  v_mul_u32_u24 v41, 1280, v41
  v_lshl_add_u32 v28, v42, 4, v41
  v_subrev_u32 v28, 2048, v28
  v_add_u32 v40, 0, v0
  v_mul_u32_u24 v41, 3277, v40
  v_lshrrev_b32 v41, 16, v41
  v_mul_u32_u24 v42, 20, v41
  v_sub_u32 v42, v40, v42
  v_bfe_u32 v43, v41, 2, 1
  v_lshlrev_b32 v43, 1, v43
  v_xor_b32 v42, v42, v43
  v_mul_u32_u24 v41, 1280, v41
  v_lshl_add_u32 v29, v42, 4, v41
  v_add_u32 v29, 17408, v29
  v_add_u32 v40, 64, v0
  v_mul_u32_u24 v41, 3277, v40
  v_lshrrev_b32 v41, 16, v41
  v_mul_u32_u24 v42, 20, v41
  v_sub_u32 v42, v40, v42
  v_bfe_u32 v43, v41, 2, 1
  v_lshlrev_b32 v43, 1, v43
  v_xor_b32 v42, v42, v43
  v_mul_u32_u24 v41, 1280, v41
  v_lshl_add_u32 v30, v42, 4, v41
  v_add_u32 v40, 128, v0
  v_mul_u32_u24 v41, 3277, v40
  v_lshrrev_b32 v41, 16, v41
  v_mul_u32_u24 v42, 20, v41
  v_sub_u32 v42, v40, v42
  v_bfe_u32 v43, v41, 2, 1
  v_lshlrev_b32 v43, 1, v43
  v_xor_b32 v42, v42, v43
  v_mul_u32_u24 v41, 1280, v41
  v_lshl_add_u32 v31, v42, 4, v41
  v_subrev_u32 v31, 1024, v31
  v_add_u32 v40, 192, v0
  v_mul_u32_u24 v41, 3277, v40
  v_lshrrev_b32 v41, 16, v41
  v_mul_u32_u24 v42, 20, v41
  v_sub_u32 v42, v40, v42
  v_bfe_u32 v43, v41, 2, 1
  v_lshlrev_b32 v43, 1, v43
  v_xor_b32 v42, v42, v43
  v_mul_u32_u24 v41, 1280, v41
  v_lshl_add_u32 v32, v42, 4, v41
  v_subrev_u32 v32, 2048, v32
  v_add_u32 v40, 256, v0
  v_mul_u32_u24 v41, 3277, v40
  v_lshrrev_b32 v41, 16, v41
  v_mul_u32_u24 v42, 20, v41
  v_sub_u32 v42, v40, v42
  v_bfe_u32 v43, v41, 2, 1
  v_lshlrev_b32 v43, 1, v43
  v_xor_b32 v42, v42, v43
  v_mul_u32_u24 v41, 1280, v41
  v_lshl_add_u32 v33, v42, 4, v41
  v_subrev_u32 v33, 3072, v33
  s_mov_b32 s61, 1
  s_call_b64 s[68:69], L_rkv
  s_mov_b32 s52, 3
  s_cmp_ge_u32 s44, 8
  s_cbranch_scc0 L_s0
  s_mov_b32 s61, 5
  s_call_b64 s[68:69], L_rkvo
  s_mov_b32 s52, 8
L_s0:
  s_sub_u32 s61, s44, s52
  s_cmp_eq_u32 s61, 0
  s_cbranch_scc1 L_s1
  s_call_b64 s[68:69], L_rkv
L_s1:
  s_mov_b32 s61, 10
  s_call_b64 s[68:69], L_rwq
  s_mov_b32 s52, 17
  s_cmp_ge_u32 s44, 8
  s_cbranch_scc1 L_s4
  s_mov_b32 s61, 5
  s_call_b64 s[68:69], L_rkvo
  s_mov_b32 s52, 12
L_s4:
  s_sub_u32 s61, s52, s44
  s_call_b64 s[68:69], L_rkv
  s_and_b32 s46, s2, 0xe7
  s_lshl_b32 s46, s46, 7
  s_add_u32 s46, s46, 25460736
  v_lshlrev_b32 v60, 10, v0
  s_mov_b64 exec, 15
  buffer_load_dwordx4 v[160:163], v60, s[96:99], s46 offen sc1
  s_mov_b64 exec, -1
  s_mov_b32 s61, 3
  s_call_b64 s[68:69], L_rkv
  v_add_u32 v49, 33280, v48
  v_add_u32 v50, 115200, v48
  s_mul_i32 s64, s2, 49152
  v_mul_u32_u24 v51, 384, v0
  s_mul_i32 s51, s2, 1152
  s_add_u32 s51, s51, 25165824
  s_add_u32 s45, s45, 2
  s_add_u32 s67, s53, s54
  s_cmp_ge_u32 s67, 63
  s_cbranch_scc0 Lws_3
  s_waitcnt vmcnt(63)
Lwb_4:
  s_barrier
  s_mov_b32 s53, s54
  s_mov_b32 s54, 32
  ds_read_b128 v[64:67], v49 offset:0
  ds_read_b128 v[68:71], v49 offset:1024
  ds_read_b128 v[72:75], v49 offset:40960
  ds_read_b128 v[76:79], v49 offset:41984
  ds_read_b128 v[80:83], v50 offset:0
  ds_read_b128 v[84:87], v50 offset:1024
  ds_read_b128 v[88:91], v50 offset:40960
  ds_read_b128 v[92:95], v50 offset:41984
  ds_read_b128 v[96:99], v49 offset:2048
  ds_read_b128 v[100:103], v49 offset:3072
  ds_read_b128 v[104:107], v49 offset:43008
  ds_read_b128 v[108:111], v49 offset:44032
  ds_read_b128 v[112:115], v50 offset:2048
  ds_read_b128 v[116:119], v50 offset:3072
  ds_read_b128 v[120:123], v50 offset:43008
  ds_read_b128 v[124:127], v50 offset:44032
  ds_read_b128 v[128:131], v49 offset:4096
  ds_read_b128 v[132:135], v49 offset:5120
  ds_read_b128 v[136:139], v49 offset:45056
  ds_read_b128 v[140:143], v49 offset:46080
  ds_read_b128 v[144:147], v50 offset:4096
  ds_read_b128 v[148:151], v50 offset:5120
  ds_read_b128 v[152:155], v50 offset:45056
  ds_read_b128 v[156:159], v50 offset:46080
  v_cmp_eq_u64 vcc, v[160:161], v[46:47]
  v_cmp_eq_u32 s[46:47], v162, v58
  s_nop 1
  s_and_b32 s100, vcc_lo, s46
  s_and_b32 s100, s100, 15
  s_waitcnt lgkmcnt(0)
  s_cmp_eq_u32 s45, 6
  s_cbranch_scc1 L_s5
  s_waitcnt vmcnt(59)
  s_add_u32 m0, s50, 0
  s_nop 0
  buffer_load_dwordx4 v2, s[20:23], s56 offen offset:0 nt lds
  buffer_load_dwordx4 v3, s[20:23], s56 offen offset:1056 nt lds
  buffer_load_dwordx4 v4, s[20:23], s56 offen offset:2112 nt lds
  buffer_load_dwordx4 v5, s[20:23], s56 offen offset:3168 nt lds
  s_waitcnt vmcnt(59)
  s_add_u32 m0, s50, 4224
  s_add_u32 s66, s56, 4096
  buffer_load_dwordx4 v2, s[20:23], s66 offen offset:0 nt lds
  buffer_load_dwordx4 v3, s[20:23], s66 offen offset:1056 nt lds
  buffer_load_dwordx4 v4, s[20:23], s66 offen offset:2112 nt lds
  buffer_load_dwordx4 v5, s[20:23], s66 offen offset:3168 nt lds
  s_waitcnt vmcnt(59)
  s_add_u32 m0, s50, 8448
  s_add_u32 s66, s56, 8192
  buffer_load_dwordx4 v2, s[20:23], s66 offen offset:0 nt lds
  buffer_load_dwordx4 v3, s[20:23], s66 offen offset:1056 nt lds
  buffer_load_dwordx4 v4, s[20:23], s66 offen offset:2112 nt lds
  buffer_load_dwordx4 v5, s[20:23], s66 offen offset:3168 nt lds
  s_waitcnt vmcnt(59)
  s_add_u32 m0, s50, 12672
  s_add_u32 s66, s56, 12288
  buffer_load_dwordx4 v2, s[20:23], s66 offen offset:0 nt lds
  buffer_load_dwordx4 v3, s[20:23], s66 offen offset:1056 nt lds
  buffer_load_dwordx4 v4, s[20:23], s66 offen offset:2112 nt lds
  buffer_load_dwordx4 v5, s[20:23], s66 offen offset:3168 nt lds
  s_waitcnt vmcnt(59)
  s_add_u32 m0, s50, 16896
  s_nop 0
  buffer_load_dwordx4 v34, s[24:27], s57 offen offset:0 nt lds
  buffer_load_dwordx4 v35, s[24:27], s57 offen offset:1024 nt lds
  buffer_load_dwordx4 v34, s[24:27], s57 offen offset:2048 nt lds
  buffer_load_dwordx4 v35, s[24:27], s57 offen offset:3072 nt lds
  s_waitcnt vmcnt(59)
  s_add_u32 m0, s50, 20992
  s_add_u32 s66, s57, 4096
  buffer_load_dwordx4 v34, s[24:27], s66 offen offset:0 nt lds
  buffer_load_dwordx4 v35, s[24:27], s66 offen offset:1024 nt lds
  buffer_load_dwordx4 v34, s[24:27], s66 offen offset:2048 nt lds
  buffer_load_dwordx4 v35, s[24:27], s66 offen offset:3072 nt lds
  s_waitcnt vmcnt(59)
  s_add_u32 m0, s50, 25088
  s_add_u32 s66, s57, 8192
  buffer_load_dwordx4 v34, s[24:27], s66 offen offset:0 nt lds
  buffer_load_dwordx4 v35, s[24:27], s66 offen offset:1024 nt lds
  buffer_load_dwordx4 v34, s[24:27], s66 offen offset:2048 nt lds
  buffer_load_dwordx4 v35, s[24:27], s66 offen offset:3072 nt lds
  s_waitcnt vmcnt(59)
  s_add_u32 m0, s50, 29184
  s_add_u32 s66, s57, 12288
  buffer_load_dwordx4 v34, s[24:27], s66 offen offset:0 nt lds
  buffer_load_dwordx4 v35, s[24:27], s66 offen offset:1024 nt lds
  buffer_load_dwordx4 v34, s[24:27], s66 offen offset:2048 nt lds
  buffer_load_dwordx4 v35, s[24:27], s66 offen offset:3072 nt lds
  s_cmp_eq_u32 s55, 15
  s_cselect_b32 s66, 49, 1
  s_lshl_b32 s66, s66, 14
  s_add_u32 s56, s56, s66
  s_cmp_eq_u32 s55, 16
  s_cselect_b32 s66, 49, 1
  s_lshl_b32 s66, s66, 14
  s_add_u32 s57, s57, s66
  s_add_u32 s55, s55, 1
  s_add_u32 s50, s50, 40960
  s_cmp_eq_u32 s50, 163840
  s_cselect_b32 s50, 0, s50
  s_sub_u32 s61, s45, 7
  s_cmp_eq_u32 s61, 0
  s_cbranch_scc1 L_s2
  s_call_b64 s[68:69], L_rkv
L_s2:
  s_add_u32 s67, s53, s54
  s_cmp_ge_u32 s67, 63
  s_cbranch_scc0 Lws_5
  s_waitcnt vmcnt(63)
Lwb_6:
  s_barrier
  s_mov_b32 s53, s54
  s_mov_b32 s54, 32
L_s5:
  s_mov_b32 s54, 57
  s_cmp_eq_u32 s100, 15
  s_cbranch_scc1 Lfa_7
  s_waitcnt vmcnt(59)
  buffer_store_dwordx4 v[64:67], v48, s[96:99], s64 offen offset:0 sc1
  buffer_store_dwordx4 v[68:71], v48, s[96:99], s64 offen offset:1024 sc1
  buffer_store_dwordx4 v[72:75], v48, s[96:99], s64 offen offset:2048 sc1
  buffer_store_dwordx4 v[76:79], v48, s[96:99], s64 offen offset:3072 sc1
  s_waitcnt vmcnt(59)
  s_add_u32 s64, s64, 4096
  buffer_store_dwordx4 v[80:83], v48, s[96:99], s64 offen offset:0 sc1
  buffer_store_dwordx4 v[84:87], v48, s[96:99], s64 offen offset:1024 sc1
  buffer_store_dwordx4 v[88:91], v48, s[96:99], s64 offen offset:2048 sc1
  buffer_store_dwordx4 v[92:95], v48, s[96:99], s64 offen offset:3072 sc1
  s_waitcnt vmcnt(59)
  s_add_u32 s64, s64, 4096
  buffer_store_dwordx4 v[96:99], v48, s[96:99], s64 offen offset:0 sc1
  buffer_store_dwordx4 v[100:103], v48, s[96:99], s64 offen offset:1024 sc1
  buffer_store_dwordx4 v[104:107], v48, s[96:99], s64 offen offset:2048 sc1
  buffer_store_dwordx4 v[108:111], v48, s[96:99], s64 offen offset:3072 sc1
  s_waitcnt vmcnt(59)
  s_add_u32 s64, s64, 4096
  buffer_store_dwordx4 v[112:115], v48, s[96:99], s64 offen offset:0 sc1
  buffer_store_dwordx4 v[116:119], v48, s[96:99], s64 offen offset:1024 sc1
  buffer_store_dwordx4 v[120:123], v48, s[96:99], s64 offen offset:2048 sc1
  buffer_store_dwordx4 v[124:127], v48, s[96:99], s64 offen offset:3072 sc1
  s_waitcnt vmcnt(59)
  s_add_u32 s64, s64, 4096
  buffer_store_dwordx4 v[128:131], v48, s[96:99], s64 offen offset:0 sc1
  buffer_store_dwordx4 v[132:135], v48, s[96:99], s64 offen offset:1024 sc1
  buffer_store_dwordx4 v[136:139], v48, s[96:99], s64 offen offset:2048 sc1
  buffer_store_dwordx4 v[140:143], v48, s[96:99], s64 offen offset:3072 sc1
  s_waitcnt vmcnt(59)
  s_add_u32 s64, s64, 4096
  buffer_store_dwordx4 v[144:147], v48, s[96:99], s64 offen offset:0 sc1
  buffer_store_dwordx4 v[148:151], v48, s[96:99], s64 offen offset:1024 sc1
  buffer_store_dwordx4 v[152:155], v48, s[96:99], s64 offen offset:2048 sc1
  buffer_store_dwordx4 v[156:159], v48, s[96:99], s64 offen offset:3072 sc1
  s_branch Lfb_8
Lfa_7:
  s_waitcnt vmcnt(59)
  buffer_store_dwordx4 v[64:67], v48, s[96:99], s64 offen offset:0
  buffer_store_dwordx4 v[68:71], v48, s[96:99], s64 offen offset:1024
  buffer_store_dwordx4 v[72:75], v48, s[96:99], s64 offen offset:2048
  buffer_store_dwordx4 v[76:79], v48, s[96:99], s64 offen offset:3072
  s_waitcnt vmcnt(59)
  s_add_u32 s64, s64, 4096
  buffer_store_dwordx4 v[80:83], v48, s[96:99], s64 offen offset:0
  buffer_store_dwordx4 v[84:87], v48, s[96:99], s64 offen offset:1024
  buffer_store_dwordx4 v[88:91], v48, s[96:99], s64 offen offset:2048
  buffer_store_dwordx4 v[92:95], v48, s[96:99], s64 offen offset:3072
  s_waitcnt vmcnt(59)
  s_add_u32 s64, s64, 4096
  buffer_store_dwordx4 v[96:99], v48, s[96:99], s64 offen offset:0
  buffer_store_dwordx4 v[100:103], v48, s[96:99], s64 offen offset:1024
  buffer_store_dwordx4 v[104:107], v48, s[96:99], s64 offen offset:2048
  buffer_store_dwordx4 v[108:111], v48, s[96:99], s64 offen offset:3072
  s_waitcnt vmcnt(59)
  s_add_u32 s64, s64, 4096
  buffer_store_dwordx4 v[112:115], v48, s[96:99], s64 offen offset:0
  buffer_store_dwordx4 v[116:119], v48, s[96:99], s64 offen offset:1024
  buffer_store_dwordx4 v[120:123], v48, s[96:99], s64 offen offset:2048
  buffer_store_dwordx4 v[124:127], v48, s[96:99], s64 offen offset:3072
  s_waitcnt vmcnt(59)
  s_add_u32 s64, s64, 4096
  buffer_store_dwordx4 v[128:131], v48, s[96:99], s64 offen offset:0
  buffer_store_dwordx4 v[132:135], v48, s[96:99], s64 offen offset:1024
  buffer_store_dwordx4 v[136:139], v48, s[96:99], s64 offen offset:2048
  buffer_store_dwordx4 v[140:143], v48, s[96:99], s64 offen offset:3072
  s_waitcnt vmcnt(59)
  s_add_u32 s64, s64, 4096
  buffer_store_dwordx4 v[144:147], v48, s[96:99], s64 offen offset:0
  buffer_store_dwordx4 v[148:151], v48, s[96:99], s64 offen offset:1024
  buffer_store_dwordx4 v[152:155], v48, s[96:99], s64 offen offset:2048
  buffer_store_dwordx4 v[156:159], v48, s[96:99], s64 offen offset:3072
Lfb_8:
  s_waitcnt vmcnt(59)
  s_add_u32 m0, s50, 0
  s_nop 0
  buffer_load_dwordx4 v2, s[20:23], s56 offen offset:0 nt lds
  buffer_load_dwordx4 v3, s[20:23], s56 offen offset:1056 nt lds
  buffer_load_dwordx4 v4, s[20:23], s56 offen offset:2112 nt lds
  buffer_load_dwordx4 v5, s[20:23], s56 offen offset:3168 nt lds
  s_waitcnt vmcnt(59)
  s_add_u32 m0, s50, 4224
  s_add_u32 s66, s56, 4096
  buffer_load_dwordx4 v2, s[20:23], s66 offen offset:0 nt lds
  buffer_load_dwordx4 v3, s[20:23], s66 offen offset:1056 nt lds
  buffer_load_dwordx4 v4, s[20:23], s66 offen offset:2112 nt lds
  buffer_load_dwordx4 v5, s[20:23], s66 offen offset:3168 nt lds
  s_waitcnt vmcnt(59)
  s_add_u32 m0, s50, 8448
  s_add_u32 s66, s56, 8192
  buffer_load_dwordx4 v2, s[20:23], s66 offen offset:0 nt lds
  buffer_load_dwordx4 v3, s[20:23], s66 offen offset:1056 nt lds
  buffer_load_dwordx4 v4, s[20:23], s66 offen offset:2112 nt lds
  buffer_load_dwordx4 v5, s[20:23], s66 offen offset:3168 nt lds
  s_waitcnt vmcnt(59)
  s_add_u32 m0, s50, 12672
  s_add_u32 s66, s56, 12288
  buffer_load_dwordx4 v2, s[20:23], s66 offen offset:0 nt lds
  buffer_load_dwordx4 v3, s[20:23], s66 offen offset:1056 nt lds
  buffer_load_dwordx4 v4, s[20:23], s66 offen offset:2112 nt lds
  buffer_load_dwordx4 v5, s[20:23], s66 offen offset:3168 nt lds
  s_waitcnt vmcnt(59)
  s_add_u32 m0, s50, 16896
  s_nop 0
  buffer_load_dwordx4 v34, s[24:27], s57 offen offset:0 nt lds
  buffer_load_dwordx4 v35, s[24:27], s57 offen offset:1024 nt lds
  buffer_load_dwordx4 v34, s[24:27], s57 offen offset:2048 nt lds
  buffer_load_dwordx4 v35, s[24:27], s57 offen offset:3072 nt lds
  s_waitcnt vmcnt(59)
  s_add_u32 m0, s50, 20992
  s_add_u32 s66, s57, 4096
  buffer_load_dwordx4 v34, s[24:27], s66 offen offset:0 nt lds
  buffer_load_dwordx4 v35, s[24:27], s66 offen offset:1024 nt lds
  buffer_load_dwordx4 v34, s[24:27], s66 offen offset:2048 nt lds
  buffer_load_dwordx4 v35, s[24:27], s66 offen offset:3072 nt lds
  s_waitcnt vmcnt(59)
  s_add_u32 m0, s50, 25088
  s_add_u32 s66, s57, 8192
  buffer_load_dwordx4 v34, s[24:27], s66 offen offset:0 nt lds
  buffer_load_dwordx4 v35, s[24:27], s66 offen offset:1024 nt lds
  buffer_load_dwordx4 v34, s[24:27], s66 offen offset:2048 nt lds
  buffer_load_dwordx4 v35, s[24:27], s66 offen offset:3072 nt lds
  s_waitcnt vmcnt(59)
  s_add_u32 m0, s50, 29184
  s_add_u32 s66, s57, 12288
  buffer_load_dwordx4 v34, s[24:27], s66 offen offset:0 nt lds
  buffer_load_dwordx4 v35, s[24:27], s66 offen offset:1024 nt lds
  buffer_load_dwordx4 v34, s[24:27], s66 offen offset:2048 nt lds
  buffer_load_dwordx4 v35, s[24:27], s66 offen offset:3072 nt lds
  s_cmp_eq_u32 s55, 15
  s_cselect_b32 s66, 49, 1
  s_lshl_b32 s66, s66, 14
  s_add_u32 s56, s56, s66
  s_cmp_eq_u32 s55, 16
  s_cselect_b32 s66, 49, 1
  s_lshl_b32 s66, s66, 14
  s_add_u32 s57, s57, s66
  s_add_u32 s55, s55, 1
  s_add_u32 s50, s50, 40960
  s_cmp_eq_u32 s50, 163840
  s_cselect_b32 s50, 0, s50
  s_waitcnt vmcnt(32)
  s_cmp_eq_u32 s100, 15
  s_cbranch_scc1 Lfa_9
  s_mov_b64 exec, 7
  buffer_store_dwordx4 v[56:59], v51, s[96:99], s51 offen sc1
  s_mov_b64 exec, -1
  s_branch Lfb_10
Lfa_9:
  s_mov_b64 exec, 7
  buffer_store_dwordx4 v[56:59], v51, s[96:99], s51 offen
  s_mov_b64 exec, -1
Lfb_10:
  s_mov_b32 s61, 1
  s_call_b64 s[68:69], L_rkv
  s_mov_b32 s61, 4
  s_call_b64 s[68:69], L_rwo
  s_sub_u32 s61, 16, s45
  s_call_b64 s[68:69], L_rkv
  s_add_u32 s67, s53, s54
  s_cmp_ge_u32 s67, 63
  s_cbranch_scc0 Lws_11
  s_waitcnt vmcnt(63)
Lwb_12:
  s_barrier
  s_mov_b32 s53, s54
  s_mov_b32 s54, 16
  s_waitcnt vmcnt(59)
  s_add_u32 m0, s50, 16896
  s_nop 0
  buffer_load_dwordx4 v34, s[24:27], s57 offen offset:0 nt lds
  buffer_load_dwordx4 v35, s[24:27], s57 offen offset:1024 nt lds
  buffer_load_dwordx4 v34, s[24:27], s57 offen offset:2048 nt lds
  buffer_load_dwordx4 v35, s[24:27], s57 offen offset:3072 nt lds
  s_waitcnt vmcnt(59)
  s_add_u32 m0, s50, 20992
  s_add_u32 s66, s57, 4096
  buffer_load_dwordx4 v34, s[24:27], s66 offen offset:0 nt lds
  buffer_load_dwordx4 v35, s[24:27], s66 offen offset:1024 nt lds
  buffer_load_dwordx4 v34, s[24:27], s66 offen offset:2048 nt lds
  buffer_load_dwordx4 v35, s[24:27], s66 offen offset:3072 nt lds
  s_waitcnt vmcnt(59)
  s_add_u32 m0, s50, 25088
  s_add_u32 s66, s57, 8192
  buffer_load_dwordx4 v34, s[24:27], s66 offen offset:0 nt lds
  buffer_load_dwordx4 v35, s[24:27], s66 offen offset:1024 nt lds
  buffer_load_dwordx4 v34, s[24:27], s66 offen offset:2048 nt lds
  buffer_load_dwordx4 v35, s[24:27], s66 offen offset:3072 nt lds
  s_waitcnt vmcnt(59)
  s_add_u32 m0, s50, 29184
  s_add_u32 s66, s57, 12288
  buffer_load_dwordx4 v34, s[24:27], s66 offen offset:0 nt lds
  buffer_load_dwordx4 v35, s[24:27], s66 offen offset:1024 nt lds
  buffer_load_dwordx4 v34, s[24:27], s66 offen offset:2048 nt lds
  buffer_load_dwordx4 v35, s[24:27], s66 offen offset:3072 nt lds
  s_add_u32 s50, s50, 40960
  s_cmp_eq_u32 s50, 163840
  s_cselect_b32 s50, 0, s50
  s_mov_b32 s61, 4
  s_call_b64 s[68:69], L_rwo
  s_waitcnt vmcnt(63)
  s_barrier
  s_waitcnt vmcnt(40)
  s_barrier
  s_waitcnt vmcnt(0)
  s_barrier
  s_endpgm
L_rwq:
  s_add_u32 s67, s53, s54
  s_cmp_ge_u32 s67, 56
  s_cbranch_scc0 Lws_13
  s_waitcnt vmcnt(56)
Lwb_14:
  s_barrier
  s_mov_b32 s53, s54
  s_mov_b32 s54, 28
  s_waitcnt vmcnt(59)
  s_add_u32 m0, s50, 16384
  s_nop 0
  buffer_load_dwordx4 v10, s[32:35], s59 offen offset:0 lds
  buffer_load_dwordx4 v11, s[32:35], s59 offen offset:1024 lds
  buffer_load_dwordx4 v12, s[32:35], s59 offen offset:2048 lds
  buffer_load_dwordx4 v13, s[32:35], s59 offen offset:3072 lds
  s_waitcnt vmcnt(59)
  s_add_u32 m0, s50, 20480
  s_add_u32 s66, s59, 40960
  buffer_load_dwordx4 v10, s[32:35], s66 offen offset:0 lds
  buffer_load_dwordx4 v11, s[32:35], s66 offen offset:1024 lds
  buffer_load_dwordx4 v12, s[32:35], s66 offen offset:2048 lds
  buffer_load_dwordx4 v13, s[32:35], s66 offen offset:3072 lds
  s_waitcnt vmcnt(59)
  s_add_u32 m0, s50, 24576
  s_add_u32 s66, s59, 81920
  buffer_load_dwordx4 v10, s[32:35], s66 offen offset:0 lds
  buffer_load_dwordx4 v11, s[32:35], s66 offen offset:1024 lds
  buffer_load_dwordx4 v12, s[32:35], s66 offen offset:2048 lds
  buffer_load_dwordx4 v13, s[32:35], s66 offen offset:3072 lds
  s_waitcnt vmcnt(59)
  s_add_u32 m0, s50, 0
  s_nop 0
  buffer_load_dwordx4 v6, s[28:31], s58 offen offset:0 lds
  buffer_load_dwordx4 v7, s[28:31], s58 offen offset:1024 lds
  buffer_load_dwordx4 v8, s[28:31], s58 offen offset:2048 lds
  buffer_load_dwordx4 v9, s[28:31], s58 offen offset:3072 lds
  s_waitcnt vmcnt(59)
  s_add_u32 m0, s50, 4096
  s_add_u32 s66, s58, 131072
  buffer_load_dwordx4 v6, s[28:31], s66 offen offset:0 lds
  buffer_load_dwordx4 v7, s[28:31], s66 offen offset:1024 lds
  buffer_load_dwordx4 v8, s[28:31], s66 offen offset:2048 lds
  buffer_load_dwordx4 v9, s[28:31], s66 offen offset:3072 lds
  s_waitcnt vmcnt(59)
  s_add_u32 m0, s50, 8192
  s_add_u32 s66, s58, 262144
  buffer_load_dwordx4 v6, s[28:31], s66 offen offset:0 lds
  buffer_load_dwordx4 v7, s[28:31], s66 offen offset:1024 lds
  buffer_load_dwordx4 v8, s[28:31], s66 offen offset:2048 lds
  buffer_load_dwordx4 v9, s[28:31], s66 offen offset:3072 lds
  s_waitcnt vmcnt(59)
  s_add_u32 m0, s50, 12288
  s_add_u32 s66, s58, 393216
  buffer_load_dwordx4 v6, s[28:31], s66 offen offset:0 lds
  buffer_load_dwordx4 v7, s[28:31], s66 offen offset:1024 lds
  buffer_load_dwordx4 v8, s[28:31], s66 offen offset:2048 lds
  buffer_load_dwordx4 v9, s[28:31], s66 offen offset:3072 lds
  s_add_u32 s65, s65, 1
  s_cmp_eq_u32 s65, 10
  s_cselect_b32 s65, 0, s65
  s_cselect_b32 s66, -9, 1
  s_lshl_b32 s46, s66, 7
  s_lshl_b32 s66, s66, 19
  s_add_u32 s59, s59, s46
  s_add_u32 s58, s58, s66
  s_add_u32 s50, s50, 40960
  s_cmp_eq_u32 s50, 163840
  s_cselect_b32 s50, 0, s50
  s_sub_u32 s61, s61, 1
  s_cmp_lg_u32 s61, 0
  s_cbranch_scc1 L_rwq
  s_setpc_b64 s[68:69]
L_rwqp:
  s_add_u32 s67, s53, s54
  s_cmp_ge_u32 s67, 56
  s_cbranch_scc0 Lws_15
  s_waitcnt vmcnt(56)
Lwb_16:
  s_barrier
  s_mov_b32 s53, s54
  s_mov_b32 s54, 33
  s_waitcnt vmcnt(59)
  s_add_u32 m0, s50, 16384
  s_nop 0
  buffer_load_dwordx4 v10, s[32:35], s59 offen offset:0 lds
  buffer_load_dwordx4 v11, s[32:35], s59 offen offset:1024 lds
  buffer_load_dwordx4 v12, s[32:35], s59 offen offset:2048 lds
  buffer_load_dwordx4 v13, s[32:35], s59 offen offset:3072 lds
  s_waitcnt vmcnt(59)
  s_add_u32 m0, s50, 20480
  s_add_u32 s66, s59, 40960
  buffer_load_dwordx4 v10, s[32:35], s66 offen offset:0 lds
  buffer_load_dwordx4 v11, s[32:35], s66 offen offset:1024 lds
  buffer_load_dwordx4 v12, s[32:35], s66 offen offset:2048 lds
  buffer_load_dwordx4 v13, s[32:35], s66 offen offset:3072 lds
  s_waitcnt vmcnt(59)
  s_add_u32 m0, s50, 24576
  s_add_u32 s66, s59, 81920
  buffer_load_dwordx4 v10, s[32:35], s66 offen offset:0 lds
  buffer_load_dwordx4 v11, s[32:35], s66 offen offset:1024 lds
  buffer_load_dwordx4 v12, s[32:35], s66 offen offset:2048 lds
  buffer_load_dwordx4 v13, s[32:35], s66 offen offset:3072 lds
  s_waitcnt vmcnt(59)
  s_add_u32 m0, s50, 0
  s_nop 0
  buffer_load_dwordx4 v6, s[28:31], s58 offen offset:0 lds
  buffer_load_dwordx4 v7, s[28:31], s58 offen offset:1024 lds
  buffer_load_dwordx4 v8, s[28:31], s58 offen offset:2048 lds
  buffer_load_dwordx4 v9, s[28:31], s58 offen offset:3072 lds
  s_waitcnt vmcnt(59)
  s_add_u32 m0, s50, 4096
  s_add_u32 s66, s58, 131072
  buffer_load_dwordx4 v6, s[28:31], s66 offen offset:0 lds
  buffer_load_dwordx4 v7, s[28:31], s66 offen offset:1024 lds
  buffer_load_dwordx4 v8, s[28:31], s66 offen offset:2048 lds
  buffer_load_dwordx4 v9, s[28:31], s66 offen offset:3072 lds
  s_waitcnt vmcnt(59)
  s_add_u32 m0, s50, 8192
  s_add_u32 s66, s58, 262144
  buffer_load_dwordx4 v6, s[28:31], s66 offen offset:0 lds
  buffer_load_dwordx4 v7, s[28:31], s66 offen offset:1024 lds
  buffer_load_dwordx4 v8, s[28:31], s66 offen offset:2048 lds
  buffer_load_dwordx4 v9, s[28:31], s66 offen offset:3072 lds
  s_waitcnt vmcnt(59)
  s_add_u32 m0, s50, 12288
  s_add_u32 s66, s58, 393216
  buffer_load_dwordx4 v6, s[28:31], s66 offen offset:0 lds
  buffer_load_dwordx4 v7, s[28:31], s66 offen offset:1024 lds
  buffer_load_dwordx4 v8, s[28:31], s66 offen offset:2048 lds
  buffer_load_dwordx4 v9, s[28:31], s66 offen offset:3072 lds
  s_add_u32 s65, s65, 1
  s_cmp_eq_u32 s65, 10
  s_cselect_b32 s65, 0, s65
  s_cselect_b32 s66, -9, 1
  s_lshl_b32 s46, s66, 7
  s_lshl_b32 s66, s66, 19
  s_add_u32 s59, s59, s46
  s_add_u32 s58, s58, s66
  s_add_u32 s50, s50, 40960
  s_cmp_eq_u32 s50, 163840
  s_cselect_b32 s50, 0, s50
  s_waitcnt vmcnt(59)
  buffer_load_dwordx4 v[52:55], v6, s[28:31], s64 offen
  s_add_u32 s64, s64, 32768
  buffer_load_dwordx4 v[52:55], v6, s[28:31], s64 offen
  s_add_u32 s64, s64, 32768
  buffer_load_dwordx4 v[52:55], v6, s[28:31], s64 offen
  s_add_u32 s64, s64, 32768
  buffer_load_dwordx4 v[52:55], v6, s[28:31], s64 offen
  s_add_u32 s64, s64, 32768
  s_waitcnt vmcnt(59)
  buffer_load_dwordx4 v[52:55], v6, s[28:31], s64 offen
  s_add_u32 s64, s64, 32768
  s_sub_u32 s61, s61, 1
  s_cmp_lg_u32 s61, 0
  s_cbranch_scc1 L_rwqp
  s_setpc_b64 s[68:69]
L_rkv:
  s_add_u32 s67, s53, s54
  s_cmp_ge_u32 s67, 63
  s_cbranch_scc0 Lws_17
  s_waitcnt vmcnt(63)
Lwb_18:
  s_barrier
  s_mov_b32 s53, s54
  s_mov_b32 s54, 32
  s_waitcnt vmcnt(59)
  s_add_u32 m0, s50, 0
  s_nop 0
  buffer_load_dwordx4 v2, s[20:23], s56 offen offset:0 nt lds
  buffer_load_dwordx4 v3, s[20:23], s56 offen offset:1056 nt lds
  buffer_load_dwordx4 v4, s[20:23], s56 offen offset:2112 nt lds
  buffer_load_dwordx4 v5, s[20:23], s56 offen offset:3168 nt lds
  s_waitcnt vmcnt(59)
  s_add_u32 m0, s50, 4224
  s_add_u32 s66, s56, 4096
  buffer_load_dwordx4 v2, s[20:23], s66 offen offset:0 nt lds
  buffer_load_dwordx4 v3, s[20:23], s66 offen offset:1056 nt lds
  buffer_load_dwordx4 v4, s[20:23], s66 offen offset:2112 nt lds
  buffer_load_dwordx4 v5, s[20:23], s66 offen offset:3168 nt lds
  s_waitcnt vmcnt(59)
  s_add_u32 m0, s50, 8448
  s_add_u32 s66, s56, 8192
  buffer_load_dwordx4 v2, s[20:23], s66 offen offset:0 nt lds
  buffer_load_dwordx4 v3, s[20:23], s66 offen offset:1056 nt lds
  buffer_load_dwordx4 v4, s[20:23], s66 offen offset:2112 nt lds
  buffer_load_dwordx4 v5, s[20:23], s66 offen offset:3168 nt lds
  s_waitcnt vmcnt(59)
  s_add_u32 m0, s50, 12672
  s_add_u32 s66, s56, 12288
  buffer_load_dwordx4 v2, s[20:23], s66 offen offset:0 nt lds
  buffer_load_dwordx4 v3, s[20:23], s66 offen offset:1056 nt lds
  buffer_load_dwordx4 v4, s[20:23], s66 offen offset:2112 nt lds
  buffer_load_dwordx4 v5, s[20:23], s66 offen offset:3168 nt lds
  s_waitcnt vmcnt(59)
  s_add_u32 m0, s50, 16896
  s_nop 0
  buffer_load_dwordx4 v34, s[24:27], s57 offen offset:0 nt lds
  buffer_load_dwordx4 v35, s[24:27], s57 offen offset:1024 nt lds
  buffer_load_dwordx4 v34, s[24:27], s57 offen offset:2048 nt lds
  buffer_load_dwordx4 v35, s[24:27], s57 offen offset:3072 nt lds
  s_waitcnt vmcnt(59)
  s_add_u32 m0, s50, 20992
  s_add_u32 s66, s57, 4096
  buffer_load_dwordx4 v34, s[24:27], s66 offen offset:0 nt lds
  buffer_load_dwordx4 v35, s[24:27], s66 offen offset:1024 nt lds
  buffer_load_dwordx4 v34, s[24:27], s66 offen offset:2048 nt lds
  buffer_load_dwordx4 v35, s[24:27], s66 offen offset:3072 nt lds
  s_waitcnt vmcnt(59)
  s_add_u32 m0, s50, 25088
  s_add_u32 s66, s57, 8192
  buffer_load_dwordx4 v34, s[24:27], s66 offen offset:0 nt lds
  buffer_load_dwordx4 v35, s[24:27], s66 offen offset:1024 nt lds
  buffer_load_dwordx4 v34, s[24:27], s66 offen offset:2048 nt lds
  buffer_load_dwordx4 v35, s[24:27], s66 offen offset:3072 nt lds
  s_waitcnt vmcnt(59)
  s_add_u32 m0, s50, 29184
  s_add_u32 s66, s57, 12288
  buffer_load_dwordx4 v34, s[24:27], s66 offen offset:0 nt lds
  buffer_load_dwordx4 v35, s[24:27], s66 offen offset:1024 nt lds
  buffer_load_dwordx4 v34, s[24:27], s66 offen offset:2048 nt lds
  buffer_load_dwordx4 v35, s[24:27], s66 offen offset:3072 nt lds
  s_cmp_eq_u32 s55, 15
  s_cselect_b32 s66, 49, 1
  s_lshl_b32 s66, s66, 14
  s_add_u32 s56, s56, s66
  s_cmp_eq_u32 s55, 16
  s_cselect_b32 s66, 49, 1
  s_lshl_b32 s66, s66, 14
  s_add_u32 s57, s57, s66
  s_add_u32 s55, s55, 1
  s_add_u32 s50, s50, 40960
  s_cmp_eq_u32 s50, 163840
  s_cselect_b32 s50, 0, s50
  s_sub_u32 s61, s61, 1
  s_cmp_lg_u32 s61, 0
  s_cbranch_scc1 L_rkv
  s_setpc_b64 s[68:69]
L_rkvq:
  s_add_u32 s67, s53, s54
  s_cmp_ge_u32 s67, 63
  s_cbranch_scc0 Lws_19
  s_waitcnt vmcnt(63)
Lwb_20:
  s_barrier
  s_mov_b32 s53, s54
  s_mov_b32 s54, 42
  s_waitcnt vmcnt(59)
  s_add_u32 m0, s50, 0
  s_nop 0
  buffer_load_dwordx4 v2, s[20:23], s56 offen offset:0 nt lds
  buffer_load_dwordx4 v3, s[20:23], s56 offen offset:1056 nt lds
  buffer_load_dwordx4 v4, s[20:23], s56 offen offset:2112 nt lds
  buffer_load_dwordx4 v5, s[20:23], s56 offen offset:3168 nt lds
  s_waitcnt vmcnt(59)
  s_add_u32 m0, s50, 4224
  s_add_u32 s66, s56, 4096
  buffer_load_dwordx4 v2, s[20:23], s66 offen offset:0 nt lds
  buffer_load_dwordx4 v3, s[20:23], s66 offen offset:1056 nt lds
  buffer_load_dwordx4 v4, s[20:23], s66 offen offset:2112 nt lds
  buffer_load_dwordx4 v5, s[20:23], s66 offen offset:3168 nt lds
  s_waitcnt vmcnt(59)
  s_add_u32 m0, s50, 8448
  s_add_u32 s66, s56, 8192
  buffer_load_dwordx4 v2, s[20:23], s66 offen offset:0 nt lds
  buffer_load_dwordx4 v3, s[20:23], s66 offen offset:1056 nt lds
  buffer_load_dwordx4 v4, s[20:23], s66 offen offset:2112 nt lds
  buffer_load_dwordx4 v5, s[20:23], s66 offen offset:3168 nt lds
  s_waitcnt vmcnt(59)
  s_add_u32 m0, s50, 12672
  s_add_u32 s66, s56, 12288
  buffer_load_dwordx4 v2, s[20:23], s66 offen offset:0 nt lds
  buffer_load_dwordx4 v3, s[20:23], s66 offen offset:1056 nt lds
  buffer_load_dwordx4 v4, s[20:23], s66 offen offset:2112 nt lds
  buffer_load_dwordx4 v5, s[20:23], s66 offen offset:3168 nt lds
  s_waitcnt vmcnt(59)
  s_add_u32 m0, s50, 16896
  s_nop 0
  buffer_load_dwordx4 v34, s[24:27], s57 offen offset:0 nt lds
  buffer_load_dwordx4 v35, s[24:27], s57 offen offset:1024 nt lds
  buffer_load_dwordx4 v34, s[24:27], s57 offen offset:2048 nt lds
  buffer_load_dwordx4 v35, s[24:27], s57 offen offset:3072 nt lds
  s_waitcnt vmcnt(59)
  s_add_u32 m0, s50, 20992
  s_add_u32 s66, s57, 4096
  buffer_load_dwordx4 v34, s[24:27], s66 offen offset:0 nt lds
  buffer_load_dwordx4 v35, s[24:27], s66 offen offset:1024 nt lds
  buffer_load_dwordx4 v34, s[24:27], s66 offen offset:2048 nt lds
  buffer_load_dwordx4 v35, s[24:27], s66 offen offset:3072 nt lds
  s_waitcnt vmcnt(59)
  s_add_u32 m0, s50, 25088
  s_add_u32 s66, s57, 8192
  buffer_load_dwordx4 v34, s[24:27], s66 offen offset:0 nt lds
  buffer_load_dwordx4 v35, s[24:27], s66 offen offset:1024 nt lds
  buffer_load_dwordx4 v34, s[24:27], s66 offen offset:2048 nt lds
  buffer_load_dwordx4 v35, s[24:27], s66 offen offset:3072 nt lds
  s_waitcnt vmcnt(59)
  s_add_u32 m0, s50, 29184
  s_add_u32 s66, s57, 12288
  buffer_load_dwordx4 v34, s[24:27], s66 offen offset:0 nt lds
  buffer_load_dwordx4 v35, s[24:27], s66 offen offset:1024 nt lds
  buffer_load_dwordx4 v34, s[24:27], s66 offen offset:2048 nt lds
  buffer_load_dwordx4 v35, s[24:27], s66 offen offset:3072 nt lds
  s_waitcnt vmcnt(59)
  buffer_load_dwordx4 v[52:55], v6, s[28:31], s64 offen
  s_add_u32 s64, s64, 32768
  buffer_load_dwordx4 v[52:55], v6, s[28:31], s64 offen
  s_add_u32 s64, s64, 32768
  buffer_load_dwordx4 v[52:55], v6, s[28:31], s64 offen
  s_add_u32 s64, s64, 32768
  buffer_load_dwordx4 v[52:55], v6, s[28:31], s64 offen
  s_add_u32 s64, s64, 32768
  s_waitcnt vmcnt(59)
  buffer_load_dwordx4 v[52:55], v6, s[28:31], s64 offen
  s_add_u32 s64, s64, 32768
  buffer_load_dwordx4 v[52:55], v6, s[28:31], s64 offen
  s_add_u32 s64, s64, 32768
  buffer_load_dwordx4 v[52:55], v6, s[28:31], s64 offen
  s_add_u32 s64, s64, 32768
  buffer_load_dwordx4 v[52:55], v6, s[28:31], s64 offen
  s_add_u32 s64, s64, 32768
  s_waitcnt vmcnt(59)
  buffer_load_dwordx4 v[52:55], v6, s[28:31], s64 offen
  s_add_u32 s64, s64, 32768
  buffer_load_dwordx4 v[52:55], v6, s[28:31], s64 offen
  s_add_u32 s64, s64, 32768
  s_cmp_eq_u32 s55, 15
  s_cselect_b32 s66, 49, 1
  s_lshl_b32 s66, s66, 14
  s_add_u32 s56, s56, s66
  s_cmp_eq_u32 s55, 16
  s_cselect_b32 s66, 49, 1
  s_lshl_b32 s66, s66, 14
  s_add_u32 s57, s57, s66
  s_add_u32 s55, s55, 1
  s_add_u32 s50, s50, 40960
  s_cmp_eq_u32 s50, 163840
  s_cselect_b32 s50, 0, s50
  s_sub_u32 s61, s61, 1
  s_cmp_lg_u32 s61, 0
  s_cbranch_scc1 L_rkvq
  s_setpc_b64 s[68:69]
L_rkvo:
  s_add_u32 s67, s53, s54
  s_cmp_ge_u32 s67, 63
  s_cbranch_scc0 Lws_21
  s_waitcnt vmcnt(63)
Lwb_22:
  s_barrier
  s_mov_b32 s53, s54
  s_mov_b32 s54, 40
  s_waitcnt vmcnt(59)
  s_add_u32 m0, s50, 0
  s_nop 0
  buffer_load_dwordx4 v2, s[20:23], s56 offen offset:0 nt lds
  buffer_load_dwordx4 v3, s[20:23], s56 offen offset:1056 nt lds
  buffer_load_dwordx4 v4, s[20:23], s56 offen offset:2112 nt lds
  buffer_load_dwordx4 v5, s[20:23], s56 offen offset:3168 nt lds
  s_waitcnt vmcnt(59)
  s_add_u32 m0, s50, 4224
  s_add_u32 s66, s56, 4096
  buffer_load_dwordx4 v2, s[20:23], s66 offen offset:0 nt lds
  buffer_load_dwordx4 v3, s[20:23], s66 offen offset:1056 nt lds
  buffer_load_dwordx4 v4, s[20:23], s66 offen offset:2112 nt lds
  buffer_load_dwordx4 v5, s[20:23], s66 offen offset:3168 nt lds
  s_waitcnt vmcnt(59)
  s_add_u32 m0, s50, 8448
  s_add_u32 s66, s56, 8192
  buffer_load_dwordx4 v2, s[20:23], s66 offen offset:0 nt lds
  buffer_load_dwordx4 v3, s[20:23], s66 offen offset:1056 nt lds
  buffer_load_dwordx4 v4, s[20:23], s66 offen offset:2112 nt lds
  buffer_load_dwordx4 v5, s[20:23], s66 offen offset:3168 nt lds
  s_waitcnt vmcnt(59)
  s_add_u32 m0, s50, 12672
  s_add_u32 s66, s56, 12288
  buffer_load_dwordx4 v2, s[20:23], s66 offen offset:0 nt lds
  buffer_load_dwordx4 v3, s[20:23], s66 offen offset:1056 nt lds
  buffer_load_dwordx4 v4, s[20:23], s66 offen offset:2112 nt lds
  buffer_load_dwordx4 v5, s[20:23], s66 offen offset:3168 nt lds
  s_waitcnt vmcnt(59)
  s_add_u32 m0, s50, 16896
  s_nop 0
  buffer_load_dwordx4 v34, s[24:27], s57 offen offset:0 nt lds
  buffer_load_dwordx4 v35, s[24:27], s57 offen offset:1024 nt lds
  buffer_load_dwordx4 v34, s[24:27], s57 offen offset:2048 nt lds
  buffer_load_dwordx4 v35, s[24:27], s57 offen offset:3072 nt lds
  s_waitcnt vmcnt(59)
  s_add_u32 m0, s50, 20992
  s_add_u32 s66, s57, 4096
  buffer_load_dwordx4 v34, s[24:27], s66 offen offset:0 nt lds
  buffer_load_dwordx4 v35, s[24:27], s66 offen offset:1024 nt lds
  buffer_load_dwordx4 v34, s[24:27], s66 offen offset:2048 nt lds
  buffer_load_dwordx4 v35, s[24:27], s66 offen offset:3072 nt lds
  s_waitcnt vmcnt(59)
  s_add_u32 m0, s50, 25088
  s_add_u32 s66, s57, 8192
  buffer_load_dwordx4 v34, s[24:27], s66 offen offset:0 nt lds
  buffer_load_dwordx4 v35, s[24:27], s66 offen offset:1024 nt lds
  buffer_load_dwordx4 v34, s[24:27], s66 offen offset:2048 nt lds
  buffer_load_dwordx4 v35, s[24:27], s66 offen offset:3072 nt lds
  s_waitcnt vmcnt(59)
  s_add_u32 m0, s50, 29184
  s_add_u32 s66, s57, 12288
  buffer_load_dwordx4 v34, s[24:27], s66 offen offset:0 nt lds
  buffer_load_dwordx4 v35, s[24:27], s66 offen offset:1024 nt lds
  buffer_load_dwordx4 v34, s[24:27], s66 offen offset:2048 nt lds
  buffer_load_dwordx4 v35, s[24:27], s66 offen offset:3072 nt lds
  s_waitcnt vmcnt(59)
  buffer_load_dwordx4 v[52:55], v48, s[36:39], s51 offen offset:0
  buffer_load_dwordx4 v[52:55], v48, s[36:39], s51 offen offset:1024
  buffer_load_dwordx4 v[52:55], v48, s[36:39], s51 offen offset:2048
  buffer_load_dwordx4 v[52:55], v48, s[36:39], s51 offen offset:3072
  s_add_u32 s51, s51, 4096
  s_waitcnt vmcnt(59)
  buffer_load_dwordx4 v[52:55], v48, s[36:39], s51 offen offset:0
  buffer_load_dwordx4 v[52:55], v48, s[36:39], s51 offen offset:1024
  buffer_load_dwordx4 v[52:55], v48, s[36:39], s51 offen offset:2048
  buffer_load_dwordx4 v[52:55], v48, s[36:39], s51 offen offset:3072
  s_add_u32 s51, s51, 4096
  s_cmp_eq_u32 s55, 15
  s_cselect_b32 s66, 49, 1
  s_lshl_b32 s66, s66, 14
  s_add_u32 s56, s56, s66
  s_cmp_eq_u32 s55, 16
  s_cselect_b32 s66, 49, 1
  s_lshl_b32 s66, s66, 14
  s_add_u32 s57, s57, s66
  s_add_u32 s55, s55, 1
  s_add_u32 s50, s50, 40960
  s_cmp_eq_u32 s50, 163840
  s_cselect_b32 s50, 0, s50
  s_sub_u32 s61, s61, 1
  s_cmp_lg_u32 s61, 0
  s_cbranch_scc1 L_rkvo
  s_setpc_b64 s[68:69]
L_rwo:
  s_add_u32 s46, s40, s60
  s_and_b32 s46, s46, 3
  s_and_b32 s47, s60, 4
  s_add_u32 s46, s46, s47
  s_lshl_b32 s47, s41, 3
  s_add_u32 s46, s46, s47
  s_mul_i32 s46, s46, 163840
  s_mul_i32 s47, s40, 320
  s_add_u32 s46, s46, s47
  s_add_u32 s67, s53, s54
  s_cmp_ge_u32 s67, 63
  s_cbranch_scc0 Lws_23
  s_waitcnt vmcnt(63)
Lwb_24:
  s_barrier
  s_mov_b32 s53, s54
  s_mov_b32 s54, 40
  s_waitcnt vmcnt(59)
  s_add_u32 m0, s50, 0
  s_nop 0
  buffer_load_dwordx4 v14, s[36:39], s46 offen offset:0 lds
  buffer_load_dwordx4 v15, s[36:39], s46 offen offset:1024 lds
  buffer_load_dwordx4 v16, s[36:39], s46 offen offset:2048 lds
  buffer_load_dwordx4 v17, s[36:39], s46 offen offset:3072 lds
  s_waitcnt vmcnt(59)
  s_add_u32 m0, s50, 4096
  s_nop 0
  buffer_load_dwordx4 v18, s[36:39], s46 offen offset:0 lds
  buffer_load_dwordx4 v19, s[36:39], s46 offen offset:1024 lds
  buffer_load_dwordx4 v20, s[36:39], s46 offen offset:2048 lds
  buffer_load_dwordx4 v21, s[36:39], s46 offen offset:3072 lds
  s_waitcnt vmcnt(59)
  s_add_u32 m0, s50, 8192
  s_add_u32 s66, s46, 20480
  buffer_load_dwordx4 v22, s[36:39], s66 offen offset:0 lds
  buffer_load_dwordx4 v23, s[36:39], s66 offen offset:1024 lds
  buffer_load_dwordx4 v24, s[36:39], s66 offen offset:2048 lds
  buffer_load_dwordx4 v25, s[36:39], s66 offen offset:3072 lds
  s_waitcnt vmcnt(59)
  s_add_u32 m0, s50, 12288
  s_add_u32 s66, s46, 40960
  buffer_load_dwordx4 v26, s[36:39], s66 offen offset:0 lds
  buffer_load_dwordx4 v27, s[36:39], s66 offen offset:1024 lds
  buffer_load_dwordx4 v28, s[36:39], s66 offen offset:2048 lds
  buffer_load_dwordx4 v29, s[36:39], s66 offen offset:3072 lds
  s_waitcnt vmcnt(59)
  s_add_u32 m0, s50, 16384
  s_add_u32 s66, s46, 61440
  buffer_load_dwordx4 v30, s[36:39], s66 offen offset:0 lds
  buffer_load_dwordx4 v31, s[36:39], s66 offen offset:1024 lds
  buffer_load_dwordx4 v32, s[36:39], s66 offen offset:2048 lds
  buffer_load_dwordx4 v33, s[36:39], s66 offen offset:3072 lds
  s_waitcnt vmcnt(59)
  s_add_u32 m0, s50, 20480
  s_add_u32 s66, s46, 81920
  buffer_load_dwordx4 v14, s[36:39], s66 offen offset:0 lds
  buffer_load_dwordx4 v15, s[36:39], s66 offen offset:1024 lds
  buffer_load_dwordx4 v16, s[36:39], s66 offen offset:2048 lds
  buffer_load_dwordx4 v17, s[36:39], s66 offen offset:3072 lds
  s_waitcnt vmcnt(59)
  s_add_u32 m0, s50, 24576
  s_add_u32 s66, s46, 81920
  buffer_load_dwordx4 v18, s[36:39], s66 offen offset:0 lds
  buffer_load_dwordx4 v19, s[36:39], s66 offen offset:1024 lds
  buffer_load_dwordx4 v20, s[36:39], s66 offen offset:2048 lds
  buffer_load_dwordx4 v21, s[36:39], s66 offen offset:3072 lds
  s_waitcnt vmcnt(59)
  s_add_u32 m0, s50, 28672
  s_add_u32 s66, s46, 102400
  buffer_load_dwordx4 v22, s[36:39], s66 offen offset:0 lds
  buffer_load_dwordx4 v23, s[36:39], s66 offen offset:1024 lds
  buffer_load_dwordx4 v24, s[36:39], s66 offen offset:2048 lds
  buffer_load_dwordx4 v25, s[36:39], s66 offen offset:3072 lds
  s_waitcnt vmcnt(59)
  s_add_u32 m0, s50, 32768
  s_add_u32 s66, s46, 122880
  buffer_load_dwordx4 v26, s[36:39], s66 offen offset:0 lds
  buffer_load_dwordx4 v27, s[36:39], s66 offen offset:1024 lds
  buffer_load_dwordx4 v28, s[36:39], s66 offen offset:2048 lds
  buffer_load_dwordx4 v29, s[36:39], s66 offen offset:3072 lds
  s_waitcnt vmcnt(59)
  s_add_u32 m0, s50, 36864
  s_add_u32 s66, s46, 143360
  buffer_load_dwordx4 v30, s[36:39], s66 offen offset:0 lds
  buffer_load_dwordx4 v31, s[36:39], s66 offen offset:1024 lds
  buffer_load_dwordx4 v32, s[36:39], s66 offen offset:2048 lds
  buffer_load_dwordx4 v33, s[36:39], s66 offen offset:3072 lds
  s_add_u32 s60, s60, 1
  s_add_u32 s50, s50, 40960
  s_cmp_eq_u32 s50, 163840
  s_cselect_b32 s50, 0, s50
  s_sub_u32 s61, s61, 1
  s_cmp_lg_u32 s61, 0
  s_cbranch_scc1 L_rwo
  s_setpc_b64 s[68:69]
L_wslow:
  s_cmp_ge_u32 s67, 60
  s_cbranch_scc0 Lw_25
  s_waitcnt vmcnt(60)
  s_setpc_b64 s[62:63]
Lw_25:
  s_cmp_ge_u32 s67, 56
  s_cbranch_scc0 Lw_26
  s_waitcnt vmcnt(56)
  s_setpc_b64 s[62:63]
Lw_26:
  s_cmp_ge_u32 s67, 48
  s_cbranch_scc0 Lw_27
  s_waitcnt vmcnt(48)
  s_setpc_b64 s[62:63]
Lw_27:
  s_cmp_ge_u32 s67, 44
  s_cbranch_scc0 Lw_28
  s_waitcnt vmcnt(44)
  s_setpc_b64 s[62:63]
Lw_28:
  s_waitcnt vmcnt(0)
  s_setpc_b64 s[62:63]
Lws_1:
  s_call_b64 s[62:63], L_wslow
  s_branch Lwb_2
Lws_3:
  s_call_b64 s[62:63], L_wslow
  s_branch Lwb_4
Lws_5:
  s_call_b64 s[62:63], L_wslow
  s_branch Lwb_6
Lws_11:
  s_call_b64 s[62:63], L_wslow
  s_branch Lwb_12
Lws_13:
  s_call_b64 s[62:63], L_wslow
  s_branch Lwb_14
Lws_15:
  s_call_b64 s[62:63], L_wslow
  s_branch Lwb_16
Lws_17:
  s_call_b64 s[62:63], L_wslow
  s_branch Lwb_18
Lws_19:
  s_call_b64 s[62:63], L_wslow
  s_branch Lwb_20
Lws_21:
  s_call_b64 s[62:63], L_wslow
  s_branch Lwb_22
Lws_23:
  s_call_b64 s[62:63], L_wslow
  s_branch Lwb_24
L_consumer:
  s_getpc_b64 s[60:61]
L_pc0:
  s_lshr_b32 s48, s2, 3
  s_mul_i32 s48, s48, 3
  s_add_u32 s48, s48, s3
  s_lshl_b32 s48, s48, 10
  s_cmp_lt_u32 s48, L_end-concat_heads__mha_block_cached__mha_block_cached__near_ridge_kernel-1024
  s_cbranch_scc0 L_noipf
  s_sub_u32 s60, s60, L_pc0-concat_heads__mha_block_cached__mha_block_cached__near_ridge_kernel
  s_subb_u32 s61, s61, 0
  s_add_u32 s60, s60, s48
  s_addc_u32 s61, s61, 0
  v_lshlrev_b32 v96, 4, v0
  v_mov_b32 v97, s61
  v_add_co_u32 v96, vcc, s60, v96
  s_nop 1
  v_addc_co_u32 v97, vcc, 0, v97, vcc
  global_load_dwordx4 v[252:255], v[96:97], off
L_noipf:
  s_memrealtime s[46:47]
  s_waitcnt lgkmcnt(0)
  s_or_b32 s48, s2, s3
  s_cmp_eq_u32 s48, 0
  s_cbranch_scc0 L_nononce
  s_or_b32 s46, s46, 1
  v_mov_b32 v64, s46
  v_mov_b32 v65, s47
  v_mov_b32 v66, 0
  s_mov_b64 exec, 1
  global_store_dwordx2 v66, v[64:65], s[18:19] sc1
  s_mov_b64 exec, -1
L_nononce:
  s_mov_b32 s20, s14
  s_and_b32 s21, s15, 0xffff
  s_mov_b32 s22, 25493504
  s_mov_b32 s23, 0x20000
  s_mov_b32 s24, s16
  s_and_b32 s25, s17, 0xffff
  s_mov_b32 s26, 1966080
  s_mov_b32 s27, 0x20000
  v_lshrrev_b32 v1, 4, v0
  v_and_b32 v2, 15, v0
  v_bfe_u32 v3, v0, 2, 2
  v_and_b32 v4, 3, v0
  v_bfe_u32 v5, v0, 4, 1
  v_lshl_add_u32 v5, v5, 2, v3
  v_lshlrev_b32 v10, 4, v0
  s_lshl_b32 s46, s3, 5
  v_add_u32 v16, s46, v2
  v_bfe_u32 v17, v16, 1, 3
  v_xor_b32 v17, v17, v1
  v_lshlrev_b32 v16, 7, v16
  v_add_u32 v16, 16384, v16
  v_lshl_add_u32 v166, v17, 4, v16
  v_xor_b32 v167, 64, v166
  v_lshlrev_b32 v16, 5, v5
  v_lshl_add_u32 v16, v4, 3, v16
  v_lshl_add_u32 v17, v1, 3, v3
  v_lshl_add_u32 v165, v17, 8, v16
  v_lshl_add_u32 v17, v1, 2, v3
  v_lshl_add_u32 v164, v17, 8, v16
  v_add_u32 v164, 16896, v164
  v_mul_u32_u24 v8, 320, v17
  v_lshl_add_u32 v8, v4, 3, v8
  v_bfe_u32 v16, v0, 4, 1
  v_xor_b32 v18, 1, v16
  v_lshl_add_u32 v251, v18, 5, v8
  v_lshl_add_u32 v8, v16, 5, v8
  v_mul_u32_u24 v16, 1056, v3
  v_lshl_add_u32 v16, v4, 8, v16
  v_lshl_add_u32 v16, v1, 4, v16
  v_xor_b32 v18, 0, v4
  v_lshl_add_u32 v160, v18, 6, v16
  v_xor_b32 v18, 1, v4
  v_lshl_add_u32 v161, v18, 6, v16
  v_xor_b32 v18, 2, v4
  v_lshl_add_u32 v162, v18, 6, v16
  v_xor_b32 v18, 3, v4
  v_lshl_add_u32 v163, v18, 6, v16
  s_and_b32 s58, s2, 0xe7
  v_add_u32 v16, s40, v4
  v_add_u32 v16, 1, v16
  v_and_b32 v16, 3, v16
  v_lshlrev_b32 v16, 3, v16
  v_add_u32 v16, s58, v16
  v_mul_u32_u24 v16, 3, v16
  v_add_u32 v16, s3, v16
  v_mul_u32_u24 v7, 384, v16
  s_and_b32 s48, s2, 0xfc
  v_add_u32 v16, s48, v4
  v_mul_u32_u24 v16, 3, v16
  v_add_u32 v16, s3, v16
  v_mul_u32_u24 v11, 384, v16
  s_mul_i32 s57, s2, 3
  s_add_u32 s57, s57, s3
  s_mul_i32 s57, s57, 384
  s_add_u32 s57, s57, 25165824
  s_add_u32 s46, s41, 1
  s_and_b32 s46, s46, 3
  s_lshl_b32 s47, s2, 2
  s_add_u32 s47, s46, s47
  s_mul_i32 s47, s47, 3
  s_add_u32 s47, s47, s3
  s_mul_i32 s47, s47, 2560
  s_add_u32 s31, s47, 16777216
  s_add_u32 s46, s46, s48
  s_lshl_b32 s46, s46, 2
  s_add_u32 s46, s46, s41
  s_mul_i32 s46, s46, 3
  s_add_u32 s46, s46, s3
  s_mul_i32 s46, s46, 2560
  s_add_u32 s28, s46, 16777216
  s_add_u32 s46, s41, 2
  s_and_b32 s46, s46, 3
  s_lshl_b32 s47, s2, 2
  s_add_u32 s47, s46, s47
  s_mul_i32 s47, s47, 3
  s_add_u32 s47, s47, s3
  s_mul_i32 s47, s47, 2560
  s_add_u32 s32, s47, 16777216
  s_add_u32 s46, s46, s48
  s_lshl_b32 s46, s46, 2
  s_add_u32 s46, s46, s41
  s_mul_i32 s46, s46, 3
  s_add_u32 s46, s46, s3
  s_mul_i32 s46, s46, 2560
  s_add_u32 s29, s46, 16777216
  s_add_u32 s46, s41, 3
  s_and_b32 s46, s46, 3
  s_lshl_b32 s47, s2, 2
  s_add_u32 s47, s46, s47
  s_mul_i32 s47, s47, 3
  s_add_u32 s47, s47, s3
  s_mul_i32 s47, s47, 2560
  s_add_u32 s33, s47, 16777216
  s_add_u32 s46, s46, s48
  s_lshl_b32 s46, s46, 2
  s_add_u32 s46, s46, s41
  s_mul_i32 s46, s46, 3
  s_add_u32 s46, s46, s3
  s_mul_i32 s46, s46, 2560
  s_add_u32 s30, s46, 16777216
  s_mul_i32 s48, s42, 96
  s_lshl_b32 s46, s3, 5
  s_add_u32 s48, s48, s46
  s_mul_i32 s48, s48, 2560
  s_mul_i32 s46, s43, 1280
  s_add_u32 s48, s48, s46
  s_mul_i32 s46, s40, 320
  s_add_u32 s34, s48, s46
  v_mul_u32_u24 v249, 2560, v2
  v_lshl_add_u32 v249, v1, 3, v249
  v_lshlrev_b32 v248, 3, v0
  s_mov_b32 s54, 0x49800000
  s_mov_b32 s60, 0x3e0293ee
  s_mov_b32 s61, 0x3e0293ee
  s_mov_b32 s64, 0
  s_mov_b32 s50, 0
  s_mov_b32 s51, 0
  s_mul_i32 s55, s2, 49152
  s_lshl_b32 s46, s3, 13
  s_add_u32 s55, s55, s46
  s_barrier
  s_call_b64 s[66:67], L_wq_block
L_item:
  v_add_u32 v152, s50, v160
  v_add_u32 v153, s50, v161
  v_add_u32 v154, s50, v162
  v_add_u32 v155, s50, v163
  ds_read_b128 v[64:67], v152 offset:0
  ds_read_b128 v[68:71], v152 offset:4224
  ds_read_b128 v[72:75], v153 offset:0
  ds_read_b128 v[76:79], v153 offset:4224
  ds_read_b128 v[80:83], v154 offset:0
  ds_read_b128 v[84:87], v154 offset:4224
  ds_read_b128 v[88:91], v155 offset:0
  ds_read_b128 v[92:95], v155 offset:4224
  v_accvgpr_mov_b32 a64, a96
  v_accvgpr_mov_b32 a65, a97
  v_accvgpr_mov_b32 a66, a98
  v_accvgpr_mov_b32 a67, a99
  v_accvgpr_mov_b32 a68, a100
  v_accvgpr_mov_b32 a69, a101
  v_accvgpr_mov_b32 a70, a102
  v_accvgpr_mov_b32 a71, a103
  v_accvgpr_mov_b32 a72, a104
  v_accvgpr_mov_b32 a73, a105
  v_accvgpr_mov_b32 a74, a106
  v_accvgpr_mov_b32 a75, a107
  v_accvgpr_mov_b32 a76, a108
  v_accvgpr_mov_b32 a77, a109
  v_accvgpr_mov_b32 a78, a110
  v_accvgpr_mov_b32 a79, a111
  v_accvgpr_mov_b32 a80, a112
  v_accvgpr_mov_b32 a81, a113
  v_accvgpr_mov_b32 a82, a114
  v_accvgpr_mov_b32 a83, a115
  v_accvgpr_mov_b32 a84, a116
  v_accvgpr_mov_b32 a85, a117
  v_accvgpr_mov_b32 a86, a118
  v_accvgpr_mov_b32 a87, a119
  v_accvgpr_mov_b32 a88, a120
  v_accvgpr_mov_b32 a89, a121
  v_accvgpr_mov_b32 a90, a122
  v_accvgpr_mov_b32 a91, a123
  v_accvgpr_mov_b32 a92, a124
  v_accvgpr_mov_b32 a93, a125
  v_accvgpr_mov_b32 a94, a126
  v_accvgpr_mov_b32 a95, a127
  v_mov_b32 v150, 0
  v_mov_b32 v151, 0
  s_waitcnt lgkmcnt(0)
  v_mfma_f32_16x16x32_bf16 v[16:19], v[64:67], a[64:67], 0
  v_mfma_f32_16x16x32_bf16 v[24:27], v[64:67], a[68:71], 0
  v_mfma_f32_16x16x32_bf16 v[20:23], v[68:71], a[64:67], 0
  v_mfma_f32_16x16x32_bf16 v[28:31], v[68:71], a[68:71], 0
  v_mfma_f32_16x16x32_bf16 v[16:19], v[72:75], a[72:75], v[16:19]
  v_mfma_f32_16x16x32_bf16 v[24:27], v[72:75], a[76:79], v[24:27]
  v_mfma_f32_16x16x32_bf16 v[20:23], v[76:79], a[72:75], v[20:23]
  v_mfma_f32_16x16x32_bf16 v[28:31], v[76:79], a[76:79], v[28:31]
  v_mfma_f32_16x16x32_bf16 v[16:19], v[80:83], a[80:83], v[16:19]
  v_mfma_f32_16x16x32_bf16 v[24:27], v[80:83], a[84:87], v[24:27]
  v_mfma_f32_16x16x32_bf16 v[20:23], v[84:87], a[80:83], v[20:23]
  v_mfma_f32_16x16x32_bf16 v[28:31], v[84:87], a[84:87], v[28:31]
  v_mfma_f32_16x16x32_bf16 v[16:19], v[88:91], a[88:91], v[16:19]
  v_mfma_f32_16x16x32_bf16 v[24:27], v[88:91], a[92:95], v[24:27]
  v_mfma_f32_16x16x32_bf16 v[20:23], v[92:95], a[88:91], v[20:23]
  v_mfma_f32_16x16x32_bf16 v[28:31], v[92:95], a[92:95], v[28:31]
  ds_read_b128 v[64:67], v152 offset:8448
  ds_read_b128 v[68:71], v152 offset:12672
  ds_read_b128 v[72:75], v153 offset:8448
  ds_read_b128 v[76:79], v153 offset:12672
  ds_read_b128 v[80:83], v154 offset:8448
  ds_read_b128 v[84:87], v154 offset:12672
  ds_read_b128 v[88:91], v155 offset:8448
  ds_read_b128 v[92:95], v155 offset:12672
  s_add_u32 s50, s50, 40960
  s_cmp_eq_u32 s50, 163840
  s_cselect_b32 s50, 0, s50
  s_waitcnt lgkmcnt(0)
  v_mfma_f32_16x16x32_bf16 v[32:35], v[64:67], a[64:67], 0
  s_barrier
  v_mfma_f32_16x16x32_bf16 v[40:43], v[64:67], a[68:71], 0
  v_max3_f32 v158, v16, v17, v18
  v_max3_f32 v159, v24, v25, v26
  v_max3_f32 v158, v158, v19, v20
  v_mfma_f32_16x16x32_bf16 v[36:39], v[68:71], a[64:67], 0
  v_max3_f32 v159, v159, v27, v28
  v_max3_f32 v158, v158, v21, v22
  v_max3_f32 v159, v159, v29, v30
  v_mfma_f32_16x16x32_bf16 v[44:47], v[68:71], a[68:71], 0
  v_max_f32 v158, v158, v23
  v_max_f32 v159, v159, v31
  v_mov_b32 v240, v158
  v_mfma_f32_16x16x32_bf16 v[32:35], v[72:75], a[72:75], v[32:35]
  v_mov_b32 v241, v159
  s_nop 0
  v_permlane32_swap_b32 v158, v240
  v_mfma_f32_16x16x32_bf16 v[40:43], v[72:75], a[76:79], v[40:43]
  v_permlane32_swap_b32 v159, v241
  v_max_f32 v158, v158, v240
  v_max_f32 v159, v159, v241
  v_mfma_f32_16x16x32_bf16 v[36:39], v[76:79], a[72:75], v[36:39]
  v_mov_b32 v240, v158
  v_mov_b32 v241, v159
  s_nop 0
  v_mfma_f32_16x16x32_bf16 v[44:47], v[76:79], a[76:79], v[44:47]
  v_permlane16_swap_b32 v158, v240
  v_permlane16_swap_b32 v159, v241
  v_max_f32 v158, v158, v240
  v_mfma_f32_16x16x32_bf16 v[32:35], v[80:83], a[80:83], v[32:35]
  v_max_f32 v159, v159, v241
  v_sub_f32 v16, v16, v158
  v_sub_f32 v17, v17, v158
  v_sub_f32 v18, v18, v158
  v_mfma_f32_16x16x32_bf16 v[40:43], v[80:83], a[84:87], v[40:43]
  v_sub_f32 v19, v19, v158
  v_sub_f32 v20, v20, v158
  v_sub_f32 v21, v21, v158
  v_mfma_f32_16x16x32_bf16 v[36:39], v[84:87], a[80:83], v[36:39]
  v_sub_f32 v22, v22, v158
  v_sub_f32 v23, v23, v158
  v_sub_f32 v24, v24, v159
  v_mfma_f32_16x16x32_bf16 v[44:47], v[84:87], a[84:87], v[44:47]
  v_sub_f32 v25, v25, v159
  v_sub_f32 v26, v26, v159
  v_sub_f32 v27, v27, v159
  v_mfma_f32_16x16x32_bf16 v[32:35], v[88:91], a[88:91], v[32:35]
  v_sub_f32 v28, v28, v159
  v_sub_f32 v29, v29, v159
  v_sub_f32 v30, v30, v159
  v_mfma_f32_16x16x32_bf16 v[40:43], v[88:91], a[92:95], v[40:43]
  v_sub_f32 v31, v31, v159
  v_sub_f32 v48, 0, v158
  v_sub_f32 v49, 0, v158
  v_mfma_f32_16x16x32_bf16 v[36:39], v[92:95], a[88:91], v[36:39]
  v_sub_f32 v50, 0, v158
  v_sub_f32 v51, 0, v158
  v_sub_f32 v52, 0, v159
  v_mfma_f32_16x16x32_bf16 v[44:47], v[92:95], a[92:95], v[44:47]
  v_sub_f32 v53, 0, v159
  v_sub_f32 v54, 0, v159
  v_sub_f32 v55, 0, v159
  v_exp_f32 v144, v16
  v_exp_f32 v145, v17
  v_exp_f32 v146, v18
  v_exp_f32 v147, v19
  v_add_f32 v156, v144, v145
  v_cvt_pk_bf16_f32 v128, v144, v145
  v_exp_f32 v144, v20
  v_exp_f32 v145, v21
  v_add_f32 v156, v156, v146
  v_add_f32 v156, v156, v147
  v_cvt_pk_bf16_f32 v129, v146, v147
  v_exp_f32 v146, v22
  v_exp_f32 v147, v23
  v_add_f32 v156, v156, v144
  v_add_f32 v156, v156, v145
  v_cvt_pk_bf16_f32 v130, v144, v145
  v_exp_f32 v144, v24
  v_exp_f32 v145, v25
  v_add_f32 v156, v156, v146
  v_add_f32 v156, v156, v147
  v_cvt_pk_bf16_f32 v131, v146, v147
  v_add_f32 v148, v150, v156
  v_sub_f32 v32, v32, v158
  v_sub_f32 v33, v33, v158
  v_sub_f32 v34, v34, v158
  v_sub_f32 v35, v35, v158
  v_sub_f32 v36, v36, v158
  v_sub_f32 v37, v37, v158
  v_sub_f32 v38, v38, v158
  v_sub_f32 v39, v39, v158
  v_sub_f32 v40, v40, v159
  v_sub_f32 v41, v41, v159
  v_sub_f32 v42, v42, v159
  v_sub_f32 v43, v43, v159
  v_sub_f32 v44, v44, v159
  v_sub_f32 v45, v45, v159
  v_sub_f32 v46, v46, v159
  v_sub_f32 v47, v47, v159
  s_mov_b32 s51, 1
  s_mov_b32 s53, s64
  s_cmp_eq_u32 s64, 0
  s_cselect_b32 s52, s44, s45
  v_add_u32 v152, s50, v160
  v_add_u32 v153, s50, v161
  v_add_u32 v154, s50, v162
  v_add_u32 v155, s50, v163
  ds_read_b128 v[64:67], v152 offset:0
  ds_read_b128 v[68:71], v152 offset:4224
  ds_read_b128 v[72:75], v153 offset:0
  ds_read_b128 v[76:79], v153 offset:4224
  ds_read_b128 v[80:83], v154 offset:0
  ds_read_b128 v[84:87], v154 offset:4224
  ds_read_b128 v[88:91], v155 offset:0
  ds_read_b128 v[92:95], v155 offset:4224
  v_exp_f32 v146, v26
  v_exp_f32 v147, v27
  v_add_f32 v157, v144, v145
  v_cvt_pk_bf16_f32 v132, v144, v145
  v_exp_f32 v144, v28
  v_exp_f32 v145, v29
  v_add_f32 v157, v157, v146
  v_add_f32 v157, v157, v147
  v_cvt_pk_bf16_f32 v133, v146, v147
  v_exp_f32 v146, v30
  v_exp_f32 v147, v31
  v_add_f32 v157, v157, v144
  v_add_f32 v157, v157, v145
  v_cvt_pk_bf16_f32 v134, v144, v145
  v_add_f32 v157, v157, v146
  v_add_f32 v157, v157, v147
  v_cvt_pk_bf16_f32 v135, v146, v147
  v_add_f32 v149, v151, v157
  v_add_u32 v56, s50, v164
  v_xor_b32 v57, 32, v56
  v_xor_b32 v58, 64, v56
  v_xor_b32 v59, 96, v56
  v_xor_b32 v60, 128, v56
  v_xor_b32 v61, 160, v56
  v_xor_b32 v62, 192, v56
  v_xor_b32 v63, 224, v56
  s_waitcnt lgkmcnt(0)
  v_mfma_f32_16x16x32_bf16 v[16:19], v[64:67], a[64:67], v[48:51]
  ds_read_b64_tr_b16 v[96:97], v56 offset:0
  ds_read_b64_tr_b16 v[98:99], v56 offset:4096
  v_exp_f32 v144, v32
  v_mfma_f32_16x16x32_bf16 v[24:27], v[64:67], a[68:71], v[52:55]
  ds_read_b64_tr_b16 v[100:101], v57 offset:0
  v_exp_f32 v145, v33
  v_mfma_f32_16x16x32_bf16 v[20:23], v[68:71], a[64:67], v[48:51]
  ds_read_b64_tr_b16 v[102:103], v57 offset:4096
  v_exp_f32 v146, v34
  v_mfma_f32_16x16x32_bf16 v[28:31], v[68:71], a[68:71], v[52:55]
  ds_read_b64_tr_b16 v[104:105], v58 offset:0
  ds_read_b64_tr_b16 v[106:107], v58 offset:4096
  v_mfma_f32_16x16x32_bf16 v[16:19], v[72:75], a[72:75], v[16:19]
  ds_read_b64_tr_b16 v[108:109], v59 offset:0
  v_exp_f32 v147, v35
  v_mfma_f32_16x16x32_bf16 v[24:27], v[72:75], a[76:79], v[24:27]
  ds_read_b64_tr_b16 v[110:111], v59 offset:4096
  v_add_f32 v156, v144, v145
  v_cvt_pk_bf16_f32 v136, v144, v145
  v_mfma_f32_16x16x32_bf16 v[20:23], v[76:79], a[72:75], v[20:23]
  ds_read_b64_tr_b16 v[112:113], v60 offset:0
  ds_read_b64_tr_b16 v[114:115], v60 offset:4096
  v_exp_f32 v144, v36
  v_mfma_f32_16x16x32_bf16 v[28:31], v[76:79], a[76:79], v[28:31]
  ds_read_b64_tr_b16 v[116:117], v61 offset:0
  v_exp_f32 v145, v37
  v_mfma_f32_16x16x32_bf16 v[16:19], v[80:83], a[80:83], v[16:19]
  ds_read_b64_tr_b16 v[118:119], v61 offset:4096
  v_add_f32 v156, v156, v146
  v_mfma_f32_16x16x32_bf16 v[24:27], v[80:83], a[84:87], v[24:27]
  ds_read_b64_tr_b16 v[120:121], v62 offset:0
  ds_read_b64_tr_b16 v[122:123], v62 offset:4096
  v_add_f32 v156, v156, v147
  v_mfma_f32_16x16x32_bf16 v[20:23], v[84:87], a[80:83], v[20:23]
  ds_read_b64_tr_b16 v[124:125], v63 offset:0
  v_cvt_pk_bf16_f32 v137, v146, v147
  v_exp_f32 v146, v38
  v_mfma_f32_16x16x32_bf16 v[28:31], v[84:87], a[84:87], v[28:31]
  ds_read_b64_tr_b16 v[126:127], v63 offset:4096
  v_exp_f32 v147, v39
  v_mfma_f32_16x16x32_bf16 v[16:19], v[88:91], a[88:91], v[16:19]
  v_add_f32 v156, v156, v144
  v_add_f32 v156, v156, v145
  v_mfma_f32_16x16x32_bf16 v[24:27], v[88:91], a[92:95], v[24:27]
  v_cvt_pk_bf16_f32 v138, v144, v145
  v_exp_f32 v144, v40
  v_mfma_f32_16x16x32_bf16 v[20:23], v[92:95], a[88:91], v[20:23]
  v_exp_f32 v145, v41
  v_add_f32 v156, v156, v146
  v_mfma_f32_16x16x32_bf16 v[28:31], v[92:95], a[92:95], v[28:31]
  v_add_f32 v156, v156, v147
  v_cvt_pk_bf16_f32 v139, v146, v147
  v_add_f32 v150, v148, v156
  s_waitcnt lgkmcnt(0)
  v_mfma_f32_16x16x32_bf16 a[0:3], v[96:99], v[128:131], 0
  ds_read_b128 v[64:67], v152 offset:8448
  v_exp_f32 v146, v42
  v_mfma_f32_16x16x32_bf16 a[4:7], v[96:99], v[132:135], 0
  ds_read_b128 v[68:71], v152 offset:12672
  v_mfma_f32_16x16x32_bf16 a[8:11], v[100:103], v[128:131], 0
  v_exp_f32 v147, v43
  v_add_f32 v157, v144, v145
  v_mfma_f32_16x16x32_bf16 a[12:15], v[100:103], v[132:135], 0
  ds_read_b128 v[72:75], v153 offset:8448
  v_cvt_pk_bf16_f32 v140, v144, v145
  v_mfma_f32_16x16x32_bf16 a[16:19], v[104:107], v[128:131], 0
  ds_read_b128 v[76:79], v153 offset:12672
  v_exp_f32 v144, v44
  v_mfma_f32_16x16x32_bf16 a[20:23], v[104:107], v[132:135], 0
  v_exp_f32 v145, v45
  v_mfma_f32_16x16x32_bf16 a[24:27], v[108:111], v[128:131], 0
  ds_read_b128 v[80:83], v154 offset:8448
  v_mfma_f32_16x16x32_bf16 a[28:31], v[108:111], v[132:135], 0
  ds_read_b128 v[84:87], v154 offset:12672
  v_add_f32 v157, v157, v146
  v_add_f32 v157, v157, v147
  v_mfma_f32_16x16x32_bf16 a[32:35], v[112:115], v[128:131], 0
  v_cvt_pk_bf16_f32 v141, v146, v147
  v_mfma_f32_16x16x32_bf16 a[36:39], v[112:115], v[132:135], 0
  ds_read_b128 v[88:91], v155 offset:8448
  v_exp_f32 v146, v46
  v_mfma_f32_16x16x32_bf16 a[40:43], v[116:119], v[128:131], 0
  ds_read_b128 v[92:95], v155 offset:12672
  v_exp_f32 v147, v47
  v_mfma_f32_16x16x32_bf16 a[44:47], v[116:119], v[132:135], 0
  v_add_f32 v157, v157, v144
  v_mfma_f32_16x16x32_bf16 a[48:51], v[120:123], v[128:131], 0
  v_add_f32 v157, v157, v145
  v_cvt_pk_bf16_f32 v142, v144, v145
  v_add_f32 v157, v157, v146
  v_mfma_f32_16x16x32_bf16 a[52:55], v[120:123], v[132:135], 0
  v_add_f32 v157, v157, v147
  v_max_f32 v159, v156, v157
  v_mfma_f32_16x16x32_bf16 a[56:59], v[124:127], v[128:131], 0
  v_cmp_lt_f32 vcc, s54, v159
  v_cvt_pk_bf16_f32 v143, v146, v147
  v_mfma_f32_16x16x32_bf16 a[60:63], v[124:127], v[132:135], 0
  v_add_f32 v151, v149, v157
  s_cbranch_vccnz Lfb_29
Lbk_30:
  s_waitcnt lgkmcnt(0)
  v_mfma_f32_16x16x32_bf16 v[32:35], v[64:67], a[64:67], v[48:51]
  ds_read_b64_tr_b16 v[96:97], v56 offset:8192
  ds_read_b64_tr_b16 v[98:99], v56 offset:12288
  s_add_u32 s50, s50, 40960
  v_mfma_f32_16x16x32_bf16 v[40:43], v[64:67], a[68:71], v[52:55]
  ds_read_b64_tr_b16 v[100:101], v57 offset:8192
  s_cmp_eq_u32 s50, 163840
  s_cselect_b32 s50, 0, s50
  v_mfma_f32_16x16x32_bf16 v[36:39], v[68:71], a[64:67], v[48:51]
  ds_read_b64_tr_b16 v[102:103], v57 offset:12288
  v_exp_f32 v144, v16
  v_mfma_f32_16x16x32_bf16 v[44:47], v[68:71], a[68:71], v[52:55]
  ds_read_b64_tr_b16 v[104:105], v58 offset:8192
  ds_read_b64_tr_b16 v[106:107], v58 offset:12288
  v_exp_f32 v145, v17
  v_mfma_f32_16x16x32_bf16 v[32:35], v[72:75], a[72:75], v[32:35]
  ds_read_b64_tr_b16 v[108:109], v59 offset:8192
  v_exp_f32 v146, v18
  v_mfma_f32_16x16x32_bf16 v[40:43], v[72:75], a[76:79], v[40:43]
  ds_read_b64_tr_b16 v[110:111], v59 offset:12288
  v_exp_f32 v147, v19
  v_add_f32 v156, v144, v145
  v_mfma_f32_16x16x32_bf16 v[36:39], v[76:79], a[72:75], v[36:39]
  ds_read_b64_tr_b16 v[112:113], v60 offset:8192
  ds_read_b64_tr_b16 v[114:115], v60 offset:12288
  v_cvt_pk_bf16_f32 v128, v144, v145
  v_mfma_f32_16x16x32_bf16 v[44:47], v[76:79], a[76:79], v[44:47]
  ds_read_b64_tr_b16 v[116:117], v61 offset:8192
  v_exp_f32 v144, v20
  v_mfma_f32_16x16x32_bf16 v[32:35], v[80:83], a[80:83], v[32:35]
  ds_read_b64_tr_b16 v[118:119], v61 offset:12288
  v_exp_f32 v145, v21
  v_add_f32 v156, v156, v146
  v_mfma_f32_16x16x32_bf16 v[40:43], v[80:83], a[84:87], v[40:43]
  ds_read_b64_tr_b16 v[120:121], v62 offset:8192
  ds_read_b64_tr_b16 v[122:123], v62 offset:12288
  v_add_f32 v156, v156, v147
  v_mfma_f32_16x16x32_bf16 v[36:39], v[84:87], a[80:83], v[36:39]
  ds_read_b64_tr_b16 v[124:125], v63 offset:8192
  v_cvt_pk_bf16_f32 v129, v146, v147
  v_exp_f32 v146, v22
  v_mfma_f32_16x16x32_bf16 v[44:47], v[84:87], a[84:87], v[44:47]
  ds_read_b64_tr_b16 v[126:127], v63 offset:12288
  v_exp_f32 v147, v23
  v_mfma_f32_16x16x32_bf16 v[32:35], v[88:91], a[88:91], v[32:35]
  v_add_f32 v156, v156, v144
  v_add_f32 v156, v156, v145
  v_cvt_pk_bf16_f32 v130, v144, v145
  v_mfma_f32_16x16x32_bf16 v[40:43], v[88:91], a[92:95], v[40:43]
  v_exp_f32 v144, v24
  v_exp_f32 v145, v25
  v_mfma_f32_16x16x32_bf16 v[36:39], v[92:95], a[88:91], v[36:39]
  v_add_f32 v156, v156, v146
  v_add_f32 v156, v156, v147
  v_cvt_pk_bf16_f32 v131, v146, v147
  s_waitcnt lgkmcnt(0)
  v_mfma_f32_16x16x32_bf16 v[44:47], v[92:95], a[92:95], v[44:47]
  s_barrier
  v_add_f32 v148, v150, v156
  s_add_u32 s51, s51, 1
  s_cmp_lt_u32 s51, s52
.p2align 6
L_loop:
  v_mfma_f32_16x16x32_bf16 a[0:3], v[96:99], v[136:139], a[0:3]
  v_add_u32 v152, s50, v160
  v_add_u32 v153, s50, v161
  v_add_u32 v154, s50, v162
  v_add_u32 v155, s50, v163
  ds_read_b128 v[64:67], v152 offset:0
  v_mfma_f32_16x16x32_bf16 a[4:7], v[96:99], v[140:143], a[4:7]
  ds_read_b128 v[68:71], v152 offset:4224
  v_mfma_f32_16x16x32_bf16 a[8:11], v[100:103], v[136:139], a[8:11]
  v_exp_f32 v146, v26
  v_mfma_f32_16x16x32_bf16 a[12:15], v[100:103], v[140:143], a[12:15]
  ds_read_b128 v[72:75], v153 offset:0
  v_exp_f32 v147, v27
  v_mfma_f32_16x16x32_bf16 a[16:19], v[104:107], v[136:139], a[16:19]
  ds_read_b128 v[76:79], v153 offset:4224
  v_add_f32 v157, v144, v145
  v_cvt_pk_bf16_f32 v132, v144, v145
  v_mfma_f32_16x16x32_bf16 a[20:23], v[104:107], v[140:143], a[20:23]
  v_exp_f32 v144, v28
  v_exp_f32 v145, v29
  v_mfma_f32_16x16x32_bf16 a[24:27], v[108:111], v[136:139], a[24:27]
  ds_read_b128 v[80:83], v154 offset:0
  v_add_f32 v157, v157, v146
  v_mfma_f32_16x16x32_bf16 a[28:31], v[108:111], v[140:143], a[28:31]
  ds_read_b128 v[84:87], v154 offset:4224
  v_add_f32 v157, v157, v147
  v_cvt_pk_bf16_f32 v133, v146, v147
  v_mfma_f32_16x16x32_bf16 a[32:35], v[112:115], v[136:139], a[32:35]
  v_exp_f32 v146, v30
  v_mfma_f32_16x16x32_bf16 a[36:39], v[112:115], v[140:143], a[36:39]
  ds_read_b128 v[88:91], v155 offset:0
  v_exp_f32 v147, v31
  v_add_f32 v157, v157, v144
  v_mfma_f32_16x16x32_bf16 a[40:43], v[116:119], v[136:139], a[40:43]
  ds_read_b128 v[92:95], v155 offset:4224
  v_add_f32 v157, v157, v145
  v_cvt_pk_bf16_f32 v134, v144, v145
  v_mfma_f32_16x16x32_bf16 a[44:47], v[116:119], v[140:143], a[44:47]
  v_add_f32 v157, v157, v146
  v_add_f32 v157, v157, v147
  v_mfma_f32_16x16x32_bf16 a[48:51], v[120:123], v[136:139], a[48:51]
  v_max_f32 v159, v156, v157
  v_cmp_lt_f32 vcc, s54, v159
  v_cvt_pk_bf16_f32 v135, v146, v147
  v_mfma_f32_16x16x32_bf16 a[52:55], v[120:123], v[140:143], a[52:55]
  v_add_f32 v149, v151, v157
  v_add_u32 v56, s50, v164
  v_xor_b32 v57, 32, v56
  v_mfma_f32_16x16x32_bf16 a[56:59], v[124:127], v[136:139], a[56:59]
  v_xor_b32 v58, 64, v56
  v_xor_b32 v59, 96, v56
  v_xor_b32 v60, 128, v56
  v_mfma_f32_16x16x32_bf16 a[60:63], v[124:127], v[140:143], a[60:63]
  v_xor_b32 v61, 160, v56
  v_xor_b32 v62, 192, v56
  v_xor_b32 v63, 224, v56
  s_cbranch_vccnz Lfb_31
Lbk_32:
  s_waitcnt lgkmcnt(0)
  v_mfma_f32_16x16x32_bf16 v[16:19], v[64:67], a[64:67], v[48:51]
  ds_read_b64_tr_b16 v[96:97], v56 offset:0
  ds_read_b64_tr_b16 v[98:99], v56 offset:4096
  v_exp_f32 v144, v32
  v_mfma_f32_16x16x32_bf16 v[24:27], v[64:67], a[68:71], v[52:55]
  ds_read_b64_tr_b16 v[100:101], v57 offset:0
  v_exp_f32 v145, v33
  v_mfma_f32_16x16x32_bf16 v[20:23], v[68:71], a[64:67], v[48:51]
  ds_read_b64_tr_b16 v[102:103], v57 offset:4096
  v_exp_f32 v146, v34
  v_mfma_f32_16x16x32_bf16 v[28:31], v[68:71], a[68:71], v[52:55]
  ds_read_b64_tr_b16 v[104:105], v58 offset:0
  ds_read_b64_tr_b16 v[106:107], v58 offset:4096
  v_mfma_f32_16x16x32_bf16 v[16:19], v[72:75], a[72:75], v[16:19]
  ds_read_b64_tr_b16 v[108:109], v59 offset:0
  v_exp_f32 v147, v35
  v_mfma_f32_16x16x32_bf16 v[24:27], v[72:75], a[76:79], v[24:27]
  ds_read_b64_tr_b16 v[110:111], v59 offset:4096
  v_add_f32 v156, v144, v145
  v_cvt_pk_bf16_f32 v136, v144, v145
  v_mfma_f32_16x16x32_bf16 v[20:23], v[76:79], a[72:75], v[20:23]
  ds_read_b64_tr_b16 v[112:113], v60 offset:0
  ds_read_b64_tr_b16 v[114:115], v60 offset:4096
  v_exp_f32 v144, v36
  v_mfma_f32_16x16x32_bf16 v[28:31], v[76:79], a[76:79], v[28:31]
  ds_read_b64_tr_b16 v[116:117], v61 offset:0
  v_exp_f32 v145, v37
  v_mfma_f32_16x16x32_bf16 v[16:19], v[80:83], a[80:83], v[16:19]
  ds_read_b64_tr_b16 v[118:119], v61 offset:4096
  v_add_f32 v156, v156, v146
  v_mfma_f32_16x16x32_bf16 v[24:27], v[80:83], a[84:87], v[24:27]
  ds_read_b64_tr_b16 v[120:121], v62 offset:0
  ds_read_b64_tr_b16 v[122:123], v62 offset:4096
  v_add_f32 v156, v156, v147
  v_mfma_f32_16x16x32_bf16 v[20:23], v[84:87], a[80:83], v[20:23]
  ds_read_b64_tr_b16 v[124:125], v63 offset:0
  v_cvt_pk_bf16_f32 v137, v146, v147
  v_exp_f32 v146, v38
  v_mfma_f32_16x16x32_bf16 v[28:31], v[84:87], a[84:87], v[28:31]
  ds_read_b64_tr_b16 v[126:127], v63 offset:4096
  v_exp_f32 v147, v39
  v_mfma_f32_16x16x32_bf16 v[16:19], v[88:91], a[88:91], v[16:19]
  v_add_f32 v156, v156, v144
  v_add_f32 v156, v156, v145
  v_mfma_f32_16x16x32_bf16 v[24:27], v[88:91], a[92:95], v[24:27]
  v_cvt_pk_bf16_f32 v138, v144, v145
  v_exp_f32 v144, v40
  v_mfma_f32_16x16x32_bf16 v[20:23], v[92:95], a[88:91], v[20:23]
  v_exp_f32 v145, v41
  v_add_f32 v156, v156, v146
  v_mfma_f32_16x16x32_bf16 v[28:31], v[92:95], a[92:95], v[28:31]
  v_add_f32 v156, v156, v147
  v_cvt_pk_bf16_f32 v139, v146, v147
  v_add_f32 v150, v148, v156
  s_waitcnt lgkmcnt(0)
  v_mfma_f32_16x16x32_bf16 a[0:3], v[96:99], v[128:131], a[0:3]
  ds_read_b128 v[64:67], v152 offset:8448
  v_exp_f32 v146, v42
  v_mfma_f32_16x16x32_bf16 a[4:7], v[96:99], v[132:135], a[4:7]
  ds_read_b128 v[68:71], v152 offset:12672
  v_mfma_f32_16x16x32_bf16 a[8:11], v[100:103], v[128:131], a[8:11]
  v_exp_f32 v147, v43
  v_add_f32 v157, v144, v145
  v_mfma_f32_16x16x32_bf16 a[12:15], v[100:103], v[132:135], a[12:15]
  ds_read_b128 v[72:75], v153 offset:8448
  v_cvt_pk_bf16_f32 v140, v144, v145
  v_mfma_f32_16x16x32_bf16 a[16:19], v[104:107], v[128:131], a[16:19]
  ds_read_b128 v[76:79], v153 offset:12672
  v_exp_f32 v144, v44
  v_mfma_f32_16x16x32_bf16 a[20:23], v[104:107], v[132:135], a[20:23]
  v_exp_f32 v145, v45
  v_mfma_f32_16x16x32_bf16 a[24:27], v[108:111], v[128:131], a[24:27]
  ds_read_b128 v[80:83], v154 offset:8448
  v_mfma_f32_16x16x32_bf16 a[28:31], v[108:111], v[132:135], a[28:31]
  ds_read_b128 v[84:87], v154 offset:12672
  v_add_f32 v157, v157, v146
  v_add_f32 v157, v157, v147
  v_mfma_f32_16x16x32_bf16 a[32:35], v[112:115], v[128:131], a[32:35]
  v_cvt_pk_bf16_f32 v141, v146, v147
  v_mfma_f32_16x16x32_bf16 a[36:39], v[112:115], v[132:135], a[36:39]
  ds_read_b128 v[88:91], v155 offset:8448
  v_exp_f32 v146, v46
  v_mfma_f32_16x16x32_bf16 a[40:43], v[116:119], v[128:131], a[40:43]
  ds_read_b128 v[92:95], v155 offset:12672
  v_exp_f32 v147, v47
  v_mfma_f32_16x16x32_bf16 a[44:47], v[116:119], v[132:135], a[44:47]
  v_add_f32 v157, v157, v144
  v_mfma_f32_16x16x32_bf16 a[48:51], v[120:123], v[128:131], a[48:51]
  v_add_f32 v157, v157, v145
  v_cvt_pk_bf16_f32 v142, v144, v145
  v_add_f32 v157, v157, v146
  v_mfma_f32_16x16x32_bf16 a[52:55], v[120:123], v[132:135], a[52:55]
  v_add_f32 v157, v157, v147
  v_max_f32 v159, v156, v157
  v_mfma_f32_16x16x32_bf16 a[56:59], v[124:127], v[128:131], a[56:59]
  v_cmp_lt_f32 vcc, s54, v159
  v_cvt_pk_bf16_f32 v143, v146, v147
  v_mfma_f32_16x16x32_bf16 a[60:63], v[124:127], v[132:135], a[60:63]
  v_add_f32 v151, v149, v157
  s_cbranch_vccnz Lfb_33
Lbk_34:
  s_waitcnt lgkmcnt(0)
  v_mfma_f32_16x16x32_bf16 v[32:35], v[64:67], a[64:67], v[48:51]
  ds_read_b64_tr_b16 v[96:97], v56 offset:8192
  ds_read_b64_tr_b16 v[98:99], v56 offset:12288
  s_add_u32 s50, s50, 40960
  v_mfma_f32_16x16x32_bf16 v[40:43], v[64:67], a[68:71], v[52:55]
  ds_read_b64_tr_b16 v[100:101], v57 offset:8192
  s_cmp_eq_u32 s50, 163840
  s_cselect_b32 s50, 0, s50
  v_mfma_f32_16x16x32_bf16 v[36:39], v[68:71], a[64:67], v[48:51]
  ds_read_b64_tr_b16 v[102:103], v57 offset:12288
  v_exp_f32 v144, v16
  v_mfma_f32_16x16x32_bf16 v[44:47], v[68:71], a[68:71], v[52:55]
  ds_read_b64_tr_b16 v[104:105], v58 offset:8192
  ds_read_b64_tr_b16 v[106:107], v58 offset:12288
  v_exp_f32 v145, v17
  v_mfma_f32_16x16x32_bf16 v[32:35], v[72:75], a[72:75], v[32:35]
  ds_read_b64_tr_b16 v[108:109], v59 offset:8192
  v_exp_f32 v146, v18
  v_mfma_f32_16x16x32_bf16 v[40:43], v[72:75], a[76:79], v[40:43]
  ds_read_b64_tr_b16 v[110:111], v59 offset:12288
  v_exp_f32 v147, v19
  v_add_f32 v156, v144, v145
  v_mfma_f32_16x16x32_bf16 v[36:39], v[76:79], a[72:75], v[36:39]
  ds_read_b64_tr_b16 v[112:113], v60 offset:8192
  ds_read_b64_tr_b16 v[114:115], v60 offset:12288
  v_cvt_pk_bf16_f32 v128, v144, v145
  v_mfma_f32_16x16x32_bf16 v[44:47], v[76:79], a[76:79], v[44:47]
  ds_read_b64_tr_b16 v[116:117], v61 offset:8192
  v_exp_f32 v144, v20
  v_mfma_f32_16x16x32_bf16 v[32:35], v[80:83], a[80:83], v[32:35]
  ds_read_b64_tr_b16 v[118:119], v61 offset:12288
  v_exp_f32 v145, v21
  v_add_f32 v156, v156, v146
  v_mfma_f32_16x16x32_bf16 v[40:43], v[80:83], a[84:87], v[40:43]
  ds_read_b64_tr_b16 v[120:121], v62 offset:8192
  ds_read_b64_tr_b16 v[122:123], v62 offset:12288
  v_add_f32 v156, v156, v147
  v_mfma_f32_16x16x32_bf16 v[36:39], v[84:87], a[80:83], v[36:39]
  ds_read_b64_tr_b16 v[124:125], v63 offset:8192
  v_cvt_pk_bf16_f32 v129, v146, v147
  v_exp_f32 v146, v22
  v_mfma_f32_16x16x32_bf16 v[44:47], v[84:87], a[84:87], v[44:47]
  ds_read_b64_tr_b16 v[126:127], v63 offset:12288
  v_exp_f32 v147, v23
  v_mfma_f32_16x16x32_bf16 v[32:35], v[88:91], a[88:91], v[32:35]
  v_add_f32 v156, v156, v144
  v_add_f32 v156, v156, v145
  v_cvt_pk_bf16_f32 v130, v144, v145
  v_mfma_f32_16x16x32_bf16 v[40:43], v[88:91], a[92:95], v[40:43]
  v_exp_f32 v144, v24
  v_exp_f32 v145, v25
  v_mfma_f32_16x16x32_bf16 v[36:39], v[92:95], a[88:91], v[36:39]
  v_add_f32 v156, v156, v146
  v_add_f32 v156, v156, v147
  v_cvt_pk_bf16_f32 v131, v146, v147
  s_waitcnt lgkmcnt(0)
  v_mfma_f32_16x16x32_bf16 v[44:47], v[92:95], a[92:95], v[44:47]
  s_barrier
  v_add_f32 v148, v150, v156
  s_add_u32 s51, s51, 1
  s_cmp_lt_u32 s51, s52
  s_cbranch_scc1 L_loop
L_event:
  s_cmp_eq_u32 s53, 4
  s_cbranch_scc1 L_tail
  s_cmp_eq_u32 s53, 0
  s_cbranch_scc0 L_ev1
  s_call_b64 s[66:67], L_wq_block
  s_mov_b32 s53, 4
  s_mov_b32 s52, 16
  s_branch L_loop
L_ev1:
  s_cmp_eq_u32 s53, 1
  s_cbranch_scc0 L_ev2
  s_mov_b32 s46, 25165824
  buffer_load_dwordx4 v[244:247], v7, s[20:23], s46 offen sc1
  s_mov_b32 s53, 2
  s_add_u32 s52, s52, 1
  s_branch L_loop
L_ev2:
  s_cmp_eq_u32 s53, 2
  s_cbranch_scc0 L_ev3
  s_mov_b32 s59, 0
  s_branch L_ev2b
L_ev2a:
  s_mov_b32 s46, 25165824
  buffer_load_dwordx4 v[244:247], v7, s[20:23], s46 offen sc1
L_ev2b:
  s_getreg_b32 s46, hwreg(HW_REG_XCC_ID, 0, 4)
  s_waitcnt vmcnt(0)
  v_cmp_eq_u64 vcc, v[244:245], v[12:13]
  v_cmp_eq_u32 s[60:61], s46, v246
  s_nop 1
  s_and_b32 s49, vcc_lo, 7
  s_and_b32 s60, s60, 7
  s_add_u32 s59, s59, 1
  s_cmp_ge_u32 s59, 0x200000
  s_cbranch_scc1 L_ev2c
  s_cmp_eq_u32 s49, 7
  s_cbranch_scc0 L_ev2a
L_ev2c:
  s_add_u32 s46, s40, 1
  s_and_b32 s46, s46, 3
  s_lshl_b32 s46, s46, 3
  s_add_u32 s46, s46, s58
  s_mul_i32 s46, s46, 49152
  s_lshl_b32 s47, s3, 13
  s_add_u32 s46, s46, s47
  s_add_u32 s47, s46, 4096
  buffer_load_dwordx4 a[96:99], v10, s[20:23], s46 offen offset:0 sc1
  buffer_load_dwordx4 a[100:103], v10, s[20:23], s46 offen offset:1024 sc1
  buffer_load_dwordx4 a[104:107], v10, s[20:23], s46 offen offset:2048 sc1
  buffer_load_dwordx4 a[108:111], v10, s[20:23], s46 offen offset:3072 sc1
  buffer_load_dwordx4 a[112:115], v10, s[20:23], s47 offen offset:0 sc1
  buffer_load_dwordx4 a[116:119], v10, s[20:23], s47 offen offset:1024 sc1
  buffer_load_dwordx4 a[120:123], v10, s[20:23], s47 offen offset:2048 sc1
  buffer_load_dwordx4 a[124:127], v10, s[20:23], s47 offen offset:3072 sc1
  s_add_u32 s46, s40, 2
  s_and_b32 s46, s46, 3
  s_lshl_b32 s46, s46, 3
  s_add_u32 s46, s46, s58
  s_mul_i32 s46, s46, 49152
  s_lshl_b32 s47, s3, 13
  s_add_u32 s46, s46, s47
  s_add_u32 s47, s46, 4096
  buffer_load_dwordx4 v[208:211], v10, s[20:23], s46 offen offset:0 sc1
  buffer_load_dwordx4 v[212:215], v10, s[20:23], s46 offen offset:1024 sc1
  buffer_load_dwordx4 v[216:219], v10, s[20:23], s46 offen offset:2048 sc1
  buffer_load_dwordx4 v[220:223], v10, s[20:23], s46 offen offset:3072 sc1
  buffer_load_dwordx4 v[224:227], v10, s[20:23], s47 offen offset:0 sc1
  buffer_load_dwordx4 v[228:231], v10, s[20:23], s47 offen offset:1024 sc1
  buffer_load_dwordx4 v[232:235], v10, s[20:23], s47 offen offset:2048 sc1
  buffer_load_dwordx4 v[236:239], v10, s[20:23], s47 offen offset:3072 sc1
  s_mov_b32 s53, 3
  s_add_u32 s52, s52, 1
  s_branch L_loop
L_ev3:
  s_add_u32 s46, s40, 3
  s_and_b32 s46, s46, 3
  s_lshl_b32 s46, s46, 3
  s_add_u32 s46, s46, s58
  s_mul_i32 s46, s46, 49152
  s_lshl_b32 s47, s3, 13
  s_add_u32 s46, s46, s47
  s_add_u32 s47, s46, 4096
  buffer_load_dwordx4 v[64:67], v10, s[20:23], s46 offen offset:0 sc1
  buffer_load_dwordx4 v[68:71], v10, s[20:23], s46 offen offset:1024 sc1
  buffer_load_dwordx4 v[72:75], v10, s[20:23], s46 offen offset:2048 sc1
  buffer_load_dwordx4 v[76:79], v10, s[20:23], s46 offen offset:3072 sc1
  buffer_load_dwordx4 v[80:83], v10, s[20:23], s47 offen offset:0 sc1
  buffer_load_dwordx4 v[84:87], v10, s[20:23], s47 offen offset:1024 sc1
  buffer_load_dwordx4 v[88:91], v10, s[20:23], s47 offen offset:2048 sc1
  buffer_load_dwordx4 v[92:95], v10, s[20:23], s47 offen offset:3072 sc1
  v_add_u32 v9, s50, v8
  v_add_u32 v250, s50, v251
  ds_read_b64_tr_b16 v[176:177], v9 offset:0
  ds_read_b64_tr_b16 v[178:179], v9 offset:5120
  ds_read_b64_tr_b16 v[180:181], v250 offset:0
  ds_read_b64_tr_b16 v[182:183], v250 offset:5120
  ds_read_b64_tr_b16 v[184:185], v9 offset:64
  ds_read_b64_tr_b16 v[186:187], v9 offset:5184
  ds_read_b64_tr_b16 v[188:189], v250 offset:64
  ds_read_b64_tr_b16 v[190:191], v250 offset:5184
  ds_read_b64_tr_b16 v[192:193], v9 offset:128
  ds_read_b64_tr_b16 v[194:195], v9 offset:5248
  ds_read_b64_tr_b16 v[196:197], v250 offset:128
  ds_read_b64_tr_b16 v[198:199], v250 offset:5248
  s_waitcnt lgkmcnt(10)
  v_mfma_f32_16x16x32_bf16 a[128:131], v[176:179], a[208:211], 0
  ds_read_b64_tr_b16 v[200:201], v9 offset:192
  v_mfma_f32_16x16x32_bf16 a[132:135], v[176:179], a[212:215], 0
  ds_read_b64_tr_b16 v[202:203], v9 offset:5312
  s_waitcnt lgkmcnt(10)
  v_mfma_f32_16x16x32_bf16 a[136:139], v[180:183], a[208:211], 0
  ds_read_b64_tr_b16 v[204:205], v250 offset:192
  v_mfma_f32_16x16x32_bf16 a[140:143], v[180:183], a[212:215], 0
  ds_read_b64_tr_b16 v[206:207], v250 offset:5312
  s_waitcnt lgkmcnt(10)
  v_mfma_f32_16x16x32_bf16 a[144:147], v[184:187], a[208:211], 0
  ds_read_b64_tr_b16 v[176:177], v9 offset:256
  v_mfma_f32_16x16x32_bf16 a[148:151], v[184:187], a[212:215], 0
  ds_read_b64_tr_b16 v[178:179], v9 offset:5376
  s_waitcnt lgkmcnt(10)
  v_mfma_f32_16x16x32_bf16 a[152:155], v[188:191], a[208:211], 0
  ds_read_b64_tr_b16 v[180:181], v250 offset:256
  v_mfma_f32_16x16x32_bf16 a[156:159], v[188:191], a[212:215], 0
  ds_read_b64_tr_b16 v[182:183], v250 offset:5376
  s_waitcnt lgkmcnt(10)
  v_mfma_f32_16x16x32_bf16 a[160:163], v[192:195], a[208:211], 0
  ds_read_b64_tr_b16 v[184:185], v9 offset:10240
  v_mfma_f32_16x16x32_bf16 a[164:167], v[192:195], a[212:215], 0
  ds_read_b64_tr_b16 v[186:187], v9 offset:15360
  s_waitcnt lgkmcnt(10)
  v_mfma_f32_16x16x32_bf16 a[168:171], v[196:199], a[208:211], 0
  ds_read_b64_tr_b16 v[188:189], v250 offset:10240
  v_mfma_f32_16x16x32_bf16 a[172:175], v[196:199], a[212:215], 0
  ds_read_b64_tr_b16 v[190:191], v250 offset:15360
  s_waitcnt lgkmcnt(10)
  v_mfma_f32_16x16x32_bf16 a[176:179], v[200:203], a[208:211], 0
  ds_read_b64_tr_b16 v[192:193], v9 offset:10304
  v_mfma_f32_16x16x32_bf16 a[180:183], v[200:203], a[212:215], 0
  ds_read_b64_tr_b16 v[194:195], v9 offset:15424
  s_waitcnt lgkmcnt(10)
  v_mfma_f32_16x16x32_bf16 a[184:187], v[204:207], a[208:211], 0
  ds_read_b64_tr_b16 v[196:197], v250 offset:10304
  v_mfma_f32_16x16x32_bf16 a[188:191], v[204:207], a[212:215], 0
  ds_read_b64_tr_b16 v[198:199], v250 offset:15424
  s_waitcnt lgkmcnt(10)
  v_mfma_f32_16x16x32_bf16 a[192:195], v[176:179], a[208:211], 0
  ds_read_b64_tr_b16 v[200:201], v9 offset:10368
  v_mfma_f32_16x16x32_bf16 a[196:199], v[176:179], a[212:215], 0
  ds_read_b64_tr_b16 v[202:203], v9 offset:15488
  s_waitcnt lgkmcnt(10)
  v_mfma_f32_16x16x32_bf16 a[200:203], v[180:183], a[208:211], 0
  ds_read_b64_tr_b16 v[204:205], v250 offset:10368
  v_mfma_f32_16x16x32_bf16 a[204:207], v[180:183], a[212:215], 0
  ds_read_b64_tr_b16 v[206:207], v250 offset:15488
  s_waitcnt lgkmcnt(10)
  v_mfma_f32_16x16x32_bf16 a[128:131], v[184:187], a[216:219], a[128:131]
  ds_read_b64_tr_b16 v[176:177], v9 offset:10432
  v_mfma_f32_16x16x32_bf16 a[132:135], v[184:187], a[220:223], a[132:135]
  ds_read_b64_tr_b16 v[178:179], v9 offset:15552
  s_waitcnt lgkmcnt(10)
  v_mfma_f32_16x16x32_bf16 a[136:139], v[188:191], a[216:219], a[136:139]
  ds_read_b64_tr_b16 v[180:181], v250 offset:10432
  v_mfma_f32_16x16x32_bf16 a[140:143], v[188:191], a[220:223], a[140:143]
  ds_read_b64_tr_b16 v[182:183], v250 offset:15552
  s_waitcnt lgkmcnt(10)
  v_mfma_f32_16x16x32_bf16 a[144:147], v[192:195], a[216:219], a[144:147]
  ds_read_b64_tr_b16 v[184:185], v9 offset:10496
  v_mfma_f32_16x16x32_bf16 a[148:151], v[192:195], a[220:223], a[148:151]
  ds_read_b64_tr_b16 v[186:187], v9 offset:15616
  s_waitcnt lgkmcnt(10)
  v_mfma_f32_16x16x32_bf16 a[152:155], v[196:199], a[216:219], a[152:155]
  ds_read_b64_tr_b16 v[188:189], v250 offset:10496
  v_mfma_f32_16x16x32_bf16 a[156:159], v[196:199], a[220:223], a[156:159]
  ds_read_b64_tr_b16 v[190:191], v250 offset:15616
  s_waitcnt lgkmcnt(10)
  v_mfma_f32_16x16x32_bf16 a[160:163], v[200:203], a[216:219], a[160:163]
  ds_read_b64_tr_b16 v[192:193], v9 offset:20480
  v_mfma_f32_16x16x32_bf16 a[164:167], v[200:203], a[220:223], a[164:167]
  ds_read_b64_tr_b16 v[194:195], v9 offset:25600
  s_waitcnt lgkmcnt(10)
  v_mfma_f32_16x16x32_bf16 a[168:171], v[204:207], a[216:219], a[168:171]
  ds_read_b64_tr_b16 v[196:197], v250 offset:20480
  v_mfma_f32_16x16x32_bf16 a[172:175], v[204:207], a[220:223], a[172:175]
  ds_read_b64_tr_b16 v[198:199], v250 offset:25600
  s_waitcnt lgkmcnt(10)
  v_mfma_f32_16x16x32_bf16 a[176:179], v[176:179], a[216:219], a[176:179]
  ds_read_b64_tr_b16 v[200:201], v9 offset:20544
  v_mfma_f32_16x16x32_bf16 a[180:183], v[176:179], a[220:223], a[180:183]
  ds_read_b64_tr_b16 v[202:203], v9 offset:25664
  s_waitcnt lgkmcnt(10)
  v_mfma_f32_16x16x32_bf16 a[184:187], v[180:183], a[216:219], a[184:187]
  ds_read_b64_tr_b16 v[204:205], v250 offset:20544
  v_mfma_f32_16x16x32_bf16 a[188:191], v[180:183], a[220:223], a[188:191]
  ds_read_b64_tr_b16 v[206:207], v250 offset:25664
  s_waitcnt lgkmcnt(10)
  v_mfma_f32_16x16x32_bf16 a[192:195], v[184:187], a[216:219], a[192:195]
  ds_read_b64_tr_b16 v[176:177], v9 offset:20608
  v_mfma_f32_16x16x32_bf16 a[196:199], v[184:187], a[220:223], a[196:199]
  ds_read_b64_tr_b16 v[178:179], v9 offset:25728
  s_waitcnt lgkmcnt(10)
  v_mfma_f32_16x16x32_bf16 a[200:203], v[188:191], a[216:219], a[200:203]
  ds_read_b64_tr_b16 v[180:181], v250 offset:20608
  v_mfma_f32_16x16x32_bf16 a[204:207], v[188:191], a[220:223], a[204:207]
  ds_read_b64_tr_b16 v[182:183], v250 offset:25728
  s_waitcnt lgkmcnt(10)
  v_mfma_f32_16x16x32_bf16 a[128:131], v[192:195], a[224:227], a[128:131]
  ds_read_b64_tr_b16 v[184:185], v9 offset:20672
  v_mfma_f32_16x16x32_bf16 a[132:135], v[192:195], a[228:231], a[132:135]
  ds_read_b64_tr_b16 v[186:187], v9 offset:25792
  s_waitcnt lgkmcnt(10)
  v_mfma_f32_16x16x32_bf16 a[136:139], v[196:199], a[224:227], a[136:139]
  ds_read_b64_tr_b16 v[188:189], v250 offset:20672
  v_mfma_f32_16x16x32_bf16 a[140:143], v[196:199], a[228:231], a[140:143]
  ds_read_b64_tr_b16 v[190:191], v250 offset:25792
  s_waitcnt lgkmcnt(10)
  v_mfma_f32_16x16x32_bf16 a[144:147], v[200:203], a[224:227], a[144:147]
  ds_read_b64_tr_b16 v[192:193], v9 offset:20736
  v_mfma_f32_16x16x32_bf16 a[148:151], v[200:203], a[228:231], a[148:151]
  ds_read_b64_tr_b16 v[194:195], v9 offset:25856
  s_waitcnt lgkmcnt(10)
  v_mfma_f32_16x16x32_bf16 a[152:155], v[204:207], a[224:227], a[152:155]
  ds_read_b64_tr_b16 v[196:197], v250 offset:20736
  v_mfma_f32_16x16x32_bf16 a[156:159], v[204:207], a[228:231], a[156:159]
  ds_read_b64_tr_b16 v[198:199], v250 offset:25856
  s_waitcnt lgkmcnt(10)
  v_mfma_f32_16x16x32_bf16 a[160:163], v[176:179], a[224:227], a[160:163]
  ds_read_b64_tr_b16 v[200:201], v9 offset:30720
  v_mfma_f32_16x16x32_bf16 a[164:167], v[176:179], a[228:231], a[164:167]
  ds_read_b64_tr_b16 v[202:203], v9 offset:35840
  s_waitcnt lgkmcnt(10)
  v_mfma_f32_16x16x32_bf16 a[168:171], v[180:183], a[224:227], a[168:171]
  ds_read_b64_tr_b16 v[204:205], v250 offset:30720
  v_mfma_f32_16x16x32_bf16 a[172:175], v[180:183], a[228:231], a[172:175]
  ds_read_b64_tr_b16 v[206:207], v250 offset:35840
  s_waitcnt lgkmcnt(10)
  v_mfma_f32_16x16x32_bf16 a[176:179], v[184:187], a[224:227], a[176:179]
  ds_read_b64_tr_b16 v[176:177], v9 offset:30784
  v_mfma_f32_16x16x32_bf16 a[180:183], v[184:187], a[228:231], a[180:183]
  ds_read_b64_tr_b16 v[178:179], v9 offset:35904
  s_waitcnt lgkmcnt(10)
  v_mfma_f32_16x16x32_bf16 a[184:187], v[188:191], a[224:227], a[184:187]
  ds_read_b64_tr_b16 v[180:181], v250 offset:30784
  v_mfma_f32_16x16x32_bf16 a[188:191], v[188:191], a[228:231], a[188:191]
  ds_read_b64_tr_b16 v[182:183], v250 offset:35904
  s_waitcnt lgkmcnt(10)
  v_mfma_f32_16x16x32_bf16 a[192:195], v[192:195], a[224:227], a[192:195]
  ds_read_b64_tr_b16 v[184:185], v9 offset:30848
  v_mfma_f32_16x16x32_bf16 a[196:199], v[192:195], a[228:231], a[196:199]
  ds_read_b64_tr_b16 v[186:187], v9 offset:35968
  s_waitcnt lgkmcnt(10)
  v_mfma_f32_16x16x32_bf16 a[200:203], v[196:199], a[224:227], a[200:203]
  ds_read_b64_tr_b16 v[188:189], v250 offset:30848
  v_mfma_f32_16x16x32_bf16 a[204:207], v[196:199], a[228:231], a[204:207]
  ds_read_b64_tr_b16 v[190:191], v250 offset:35968
  s_waitcnt lgkmcnt(10)
  v_mfma_f32_16x16x32_bf16 a[128:131], v[200:203], a[232:235], a[128:131]
  ds_read_b64_tr_b16 v[192:193], v9 offset:30912
  v_mfma_f32_16x16x32_bf16 a[132:135], v[200:203], a[236:239], a[132:135]
  ds_read_b64_tr_b16 v[194:195], v9 offset:36032
  s_waitcnt lgkmcnt(10)
  v_mfma_f32_16x16x32_bf16 a[136:139], v[204:207], a[232:235], a[136:139]
  ds_read_b64_tr_b16 v[196:197], v250 offset:30912
  v_mfma_f32_16x16x32_bf16 a[140:143], v[204:207], a[236:239], a[140:143]
  ds_read_b64_tr_b16 v[198:199], v250 offset:36032
  s_waitcnt lgkmcnt(10)
  v_mfma_f32_16x16x32_bf16 a[144:147], v[176:179], a[232:235], a[144:147]
  ds_read_b64_tr_b16 v[200:201], v9 offset:30976
  v_mfma_f32_16x16x32_bf16 a[148:151], v[176:179], a[236:239], a[148:151]
  ds_read_b64_tr_b16 v[202:203], v9 offset:36096
  s_waitcnt lgkmcnt(10)
  v_mfma_f32_16x16x32_bf16 a[152:155], v[180:183], a[232:235], a[152:155]
  ds_read_b64_tr_b16 v[204:205], v250 offset:30976
  v_mfma_f32_16x16x32_bf16 a[156:159], v[180:183], a[236:239], a[156:159]
  ds_read_b64_tr_b16 v[206:207], v250 offset:36096
  s_waitcnt lgkmcnt(10)
  v_mfma_f32_16x16x32_bf16 a[160:163], v[184:187], a[232:235], a[160:163]
  v_mfma_f32_16x16x32_bf16 a[164:167], v[184:187], a[236:239], a[164:167]
  s_waitcnt lgkmcnt(8)
  v_mfma_f32_16x16x32_bf16 a[168:171], v[188:191], a[232:235], a[168:171]
  v_mfma_f32_16x16x32_bf16 a[172:175], v[188:191], a[236:239], a[172:175]
  s_waitcnt lgkmcnt(0)
  s_barrier
  s_add_u32 s50, s50, 40960
  s_cmp_eq_u32 s50, 163840
  s_cselect_b32 s50, 0, s50
  v_add_u32 v9, s50, v8
  v_add_u32 v250, s50, v251
  ds_read_b64_tr_b16 v[176:177], v9 offset:0
  ds_read_b64_tr_b16 v[178:179], v9 offset:5120
  v_mfma_f32_16x16x32_bf16 a[176:179], v[192:195], a[232:235], a[176:179]
  ds_read_b64_tr_b16 v[180:181], v250 offset:0
  v_mfma_f32_16x16x32_bf16 a[180:183], v[192:195], a[236:239], a[180:183]
  ds_read_b64_tr_b16 v[182:183], v250 offset:5120
  ds_read_b64_tr_b16 v[184:185], v9 offset:64
  v_mfma_f32_16x16x32_bf16 a[184:187], v[196:199], a[232:235], a[184:187]
  ds_read_b64_tr_b16 v[186:187], v9 offset:5184
  v_mfma_f32_16x16x32_bf16 a[188:191], v[196:199], a[236:239], a[188:191]
  ds_read_b64_tr_b16 v[188:189], v250 offset:64
  ds_read_b64_tr_b16 v[190:191], v250 offset:5184
  v_mfma_f32_16x16x32_bf16 a[192:195], v[200:203], a[232:235], a[192:195]
  ds_read_b64_tr_b16 v[192:193], v9 offset:128
  v_mfma_f32_16x16x32_bf16 a[196:199], v[200:203], a[236:239], a[196:199]
  ds_read_b64_tr_b16 v[194:195], v9 offset:5248
  ds_read_b64_tr_b16 v[196:197], v250 offset:128
  v_mfma_f32_16x16x32_bf16 a[200:203], v[204:207], a[232:235], a[200:203]
  ds_read_b64_tr_b16 v[198:199], v250 offset:5248
  v_mfma_f32_16x16x32_bf16 a[204:207], v[204:207], a[236:239], a[204:207]
  s_waitcnt vmcnt(16)
  s_waitcnt lgkmcnt(10)
  v_mfma_f32_16x16x32_bf16 a[128:131], v[176:179], a[96:99], a[128:131]
  ds_read_b64_tr_b16 v[200:201], v9 offset:192
  v_mfma_f32_16x16x32_bf16 a[132:135], v[176:179], a[100:103], a[132:135]
  ds_read_b64_tr_b16 v[202:203], v9 offset:5312
  s_waitcnt lgkmcnt(10)
  v_mfma_f32_16x16x32_bf16 a[136:139], v[180:183], a[96:99], a[136:139]
  ds_read_b64_tr_b16 v[204:205], v250 offset:192
  v_mfma_f32_16x16x32_bf16 a[140:143], v[180:183], a[100:103], a[140:143]
  ds_read_b64_tr_b16 v[206:207], v250 offset:5312
  s_waitcnt lgkmcnt(10)
  v_mfma_f32_16x16x32_bf16 a[144:147], v[184:187], a[96:99], a[144:147]
  ds_read_b64_tr_b16 v[176:177], v9 offset:256
  v_mfma_f32_16x16x32_bf16 a[148:151], v[184:187], a[100:103], a[148:151]
  ds_read_b64_tr_b16 v[178:179], v9 offset:5376
  s_waitcnt lgkmcnt(10)
  v_mfma_f32_16x16x32_bf16 a[152:155], v[188:191], a[96:99], a[152:155]
  ds_read_b64_tr_b16 v[180:181], v250 offset:256
  v_mfma_f32_16x16x32_bf16 a[156:159], v[188:191], a[100:103], a[156:159]
  ds_read_b64_tr_b16 v[182:183], v250 offset:5376
  s_waitcnt lgkmcnt(10)
  v_mfma_f32_16x16x32_bf16 a[160:163], v[192:195], a[96:99], a[160:163]
  ds_read_b64_tr_b16 v[184:185], v9 offset:10240
  v_mfma_f32_16x16x32_bf16 a[164:167], v[192:195], a[100:103], a[164:167]
  ds_read_b64_tr_b16 v[186:187], v9 offset:15360
  s_waitcnt lgkmcnt(10)
  v_mfma_f32_16x16x32_bf16 a[168:171], v[196:199], a[96:99], a[168:171]
  ds_read_b64_tr_b16 v[188:189], v250 offset:10240
  v_mfma_f32_16x16x32_bf16 a[172:175], v[196:199], a[100:103], a[172:175]
  ds_read_b64_tr_b16 v[190:191], v250 offset:15360
  s_waitcnt lgkmcnt(10)
  v_mfma_f32_16x16x32_bf16 a[176:179], v[200:203], a[96:99], a[176:179]
  ds_read_b64_tr_b16 v[192:193], v9 offset:10304
  v_mfma_f32_16x16x32_bf16 a[180:183], v[200:203], a[100:103], a[180:183]
  ds_read_b64_tr_b16 v[194:195], v9 offset:15424
  s_waitcnt lgkmcnt(10)
  v_mfma_f32_16x16x32_bf16 a[184:187], v[204:207], a[96:99], a[184:187]
  ds_read_b64_tr_b16 v[196:197], v250 offset:10304
  v_mfma_f32_16x16x32_bf16 a[188:191], v[204:207], a[100:103], a[188:191]
  ds_read_b64_tr_b16 v[198:199], v250 offset:15424
  s_waitcnt lgkmcnt(10)
  v_mfma_f32_16x16x32_bf16 a[192:195], v[176:179], a[96:99], a[192:195]
  ds_read_b64_tr_b16 v[200:201], v9 offset:10368
  v_mfma_f32_16x16x32_bf16 a[196:199], v[176:179], a[100:103], a[196:199]
  ds_read_b64_tr_b16 v[202:203], v9 offset:15488
  s_waitcnt lgkmcnt(10)
  v_mfma_f32_16x16x32_bf16 a[200:203], v[180:183], a[96:99], a[200:203]
  ds_read_b64_tr_b16 v[204:205], v250 offset:10368
  v_mfma_f32_16x16x32_bf16 a[204:207], v[180:183], a[100:103], a[204:207]
  ds_read_b64_tr_b16 v[206:207], v250 offset:15488
  s_waitcnt lgkmcnt(10)
  v_mfma_f32_16x16x32_bf16 a[128:131], v[184:187], a[104:107], a[128:131]
  ds_read_b64_tr_b16 v[176:177], v9 offset:10432
  v_mfma_f32_16x16x32_bf16 a[132:135], v[184:187], a[108:111], a[132:135]
  ds_read_b64_tr_b16 v[178:179], v9 offset:15552
  s_waitcnt lgkmcnt(10)
  v_mfma_f32_16x16x32_bf16 a[136:139], v[188:191], a[104:107], a[136:139]
  ds_read_b64_tr_b16 v[180:181], v250 offset:10432
  v_mfma_f32_16x16x32_bf16 a[140:143], v[188:191], a[108:111], a[140:143]
  ds_read_b64_tr_b16 v[182:183], v250 offset:15552
  s_waitcnt lgkmcnt(10)
  v_mfma_f32_16x16x32_bf16 a[144:147], v[192:195], a[104:107], a[144:147]
  ds_read_b64_tr_b16 v[184:185], v9 offset:10496
  v_mfma_f32_16x16x32_bf16 a[148:151], v[192:195], a[108:111], a[148:151]
  ds_read_b64_tr_b16 v[186:187], v9 offset:15616
  s_waitcnt lgkmcnt(10)
  v_mfma_f32_16x16x32_bf16 a[152:155], v[196:199], a[104:107], a[152:155]
  ds_read_b64_tr_b16 v[188:189], v250 offset:10496
  v_mfma_f32_16x16x32_bf16 a[156:159], v[196:199], a[108:111], a[156:159]
  ds_read_b64_tr_b16 v[190:191], v250 offset:15616
  s_waitcnt lgkmcnt(10)
  v_mfma_f32_16x16x32_bf16 a[160:163], v[200:203], a[104:107], a[160:163]
  ds_read_b64_tr_b16 v[192:193], v9 offset:20480
  v_mfma_f32_16x16x32_bf16 a[164:167], v[200:203], a[108:111], a[164:167]
  ds_read_b64_tr_b16 v[194:195], v9 offset:25600
  s_waitcnt lgkmcnt(10)
  v_mfma_f32_16x16x32_bf16 a[168:171], v[204:207], a[104:107], a[168:171]
  ds_read_b64_tr_b16 v[196:197], v250 offset:20480
  v_mfma_f32_16x16x32_bf16 a[172:175], v[204:207], a[108:111], a[172:175]
  ds_read_b64_tr_b16 v[198:199], v250 offset:25600
  s_waitcnt lgkmcnt(10)
  v_mfma_f32_16x16x32_bf16 a[176:179], v[176:179], a[104:107], a[176:179]
  ds_read_b64_tr_b16 v[200:201], v9 offset:20544
  v_mfma_f32_16x16x32_bf16 a[180:183], v[176:179], a[108:111], a[180:183]
  ds_read_b64_tr_b16 v[202:203], v9 offset:25664
  s_waitcnt lgkmcnt(10)
  v_mfma_f32_16x16x32_bf16 a[184:187], v[180:183], a[104:107], a[184:187]
  ds_read_b64_tr_b16 v[204:205], v250 offset:20544
  v_mfma_f32_16x16x32_bf16 a[188:191], v[180:183], a[108:111], a[188:191]
  ds_read_b64_tr_b16 v[206:207], v250 offset:25664
  s_waitcnt lgkmcnt(10)
  v_mfma_f32_16x16x32_bf16 a[192:195], v[184:187], a[104:107], a[192:195]
  ds_read_b64_tr_b16 v[176:177], v9 offset:20608
  v_mfma_f32_16x16x32_bf16 a[196:199], v[184:187], a[108:111], a[196:199]
  ds_read_b64_tr_b16 v[178:179], v9 offset:25728
  s_waitcnt lgkmcnt(10)
  v_mfma_f32_16x16x32_bf16 a[200:203], v[188:191], a[104:107], a[200:203]
  ds_read_b64_tr_b16 v[180:181], v250 offset:20608
  v_mfma_f32_16x16x32_bf16 a[204:207], v[188:191], a[108:111], a[204:207]
  ds_read_b64_tr_b16 v[182:183], v250 offset:25728
  s_waitcnt lgkmcnt(10)
  v_mfma_f32_16x16x32_bf16 a[128:131], v[192:195], a[112:115], a[128:131]
  ds_read_b64_tr_b16 v[184:185], v9 offset:20672
  v_mfma_f32_16x16x32_bf16 a[132:135], v[192:195], a[116:119], a[132:135]
  ds_read_b64_tr_b16 v[186:187], v9 offset:25792
  s_waitcnt lgkmcnt(10)
  v_mfma_f32_16x16x32_bf16 a[136:139], v[196:199], a[112:115], a[136:139]
  ds_read_b64_tr_b16 v[188:189], v250 offset:20672
  v_mfma_f32_16x16x32_bf16 a[140:143], v[196:199], a[116:119], a[140:143]
  ds_read_b64_tr_b16 v[190:191], v250 offset:25792
  s_waitcnt lgkmcnt(10)
  v_mfma_f32_16x16x32_bf16 a[144:147], v[200:203], a[112:115], a[144:147]
  ds_read_b64_tr_b16 v[192:193], v9 offset:20736
  v_mfma_f32_16x16x32_bf16 a[148:151], v[200:203], a[116:119], a[148:151]
  ds_read_b64_tr_b16 v[194:195], v9 offset:25856
  s_waitcnt lgkmcnt(10)
  v_mfma_f32_16x16x32_bf16 a[152:155], v[204:207], a[112:115], a[152:155]
  ds_read_b64_tr_b16 v[196:197], v250 offset:20736
  v_mfma_f32_16x16x32_bf16 a[156:159], v[204:207], a[116:119], a[156:159]
  ds_read_b64_tr_b16 v[198:199], v250 offset:25856
  s_waitcnt lgkmcnt(10)
  v_mfma_f32_16x16x32_bf16 a[160:163], v[176:179], a[112:115], a[160:163]
  ds_read_b64_tr_b16 v[200:201], v9 offset:30720
  v_mfma_f32_16x16x32_bf16 a[164:167], v[176:179], a[116:119], a[164:167]
  ds_read_b64_tr_b16 v[202:203], v9 offset:35840
  s_waitcnt lgkmcnt(10)
  v_mfma_f32_16x16x32_bf16 a[168:171], v[180:183], a[112:115], a[168:171]
  ds_read_b64_tr_b16 v[204:205], v250 offset:30720
  v_mfma_f32_16x16x32_bf16 a[172:175], v[180:183], a[116:119], a[172:175]
  ds_read_b64_tr_b16 v[206:207], v250 offset:35840
  s_waitcnt lgkmcnt(10)
  v_mfma_f32_16x16x32_bf16 a[176:179], v[184:187], a[112:115], a[176:179]
  ds_read_b64_tr_b16 v[176:177], v9 offset:30784
  v_mfma_f32_16x16x32_bf16 a[180:183], v[184:187], a[116:119], a[180:183]
  ds_read_b64_tr_b16 v[178:179], v9 offset:35904
  s_waitcnt lgkmcnt(10)
  v_mfma_f32_16x16x32_bf16 a[184:187], v[188:191], a[112:115], a[184:187]
  ds_read_b64_tr_b16 v[180:181], v250 offset:30784
  v_mfma_f32_16x16x32_bf16 a[188:191], v[188:191], a[116:119], a[188:191]
  ds_read_b64_tr_b16 v[182:183], v250 offset:35904
  s_waitcnt lgkmcnt(10)
  v_mfma_f32_16x16x32_bf16 a[192:195], v[192:195], a[112:115], a[192:195]
  ds_read_b64_tr_b16 v[184:185], v9 offset:30848
  v_mfma_f32_16x16x32_bf16 a[196:199], v[192:195], a[116:119], a[196:199]
  ds_read_b64_tr_b16 v[186:187], v9 offset:35968
  s_waitcnt lgkmcnt(10)
  v_mfma_f32_16x16x32_bf16 a[200:203], v[196:199], a[112:115], a[200:203]
  ds_read_b64_tr_b16 v[188:189], v250 offset:30848
  v_mfma_f32_16x16x32_bf16 a[204:207], v[196:199], a[116:119], a[204:207]
  ds_read_b64_tr_b16 v[190:191], v250 offset:35968
  s_waitcnt lgkmcnt(10)
  v_mfma_f32_16x16x32_bf16 a[128:131], v[200:203], a[120:123], a[128:131]
  ds_read_b64_tr_b16 v[192:193], v9 offset:30912
  v_mfma_f32_16x16x32_bf16 a[132:135], v[200:203], a[124:127], a[132:135]
  ds_read_b64_tr_b16 v[194:195], v9 offset:36032
  s_waitcnt lgkmcnt(10)
  v_mfma_f32_16x16x32_bf16 a[136:139], v[204:207], a[120:123], a[136:139]
  ds_read_b64_tr_b16 v[196:197], v250 offset:30912
  v_mfma_f32_16x16x32_bf16 a[140:143], v[204:207], a[124:127], a[140:143]
  ds_read_b64_tr_b16 v[198:199], v250 offset:36032
  s_waitcnt lgkmcnt(10)
  v_mfma_f32_16x16x32_bf16 a[144:147], v[176:179], a[120:123], a[144:147]
  ds_read_b64_tr_b16 v[200:201], v9 offset:30976
  v_mfma_f32_16x16x32_bf16 a[148:151], v[176:179], a[124:127], a[148:151]
  ds_read_b64_tr_b16 v[202:203], v9 offset:36096
  s_waitcnt lgkmcnt(10)
  v_mfma_f32_16x16x32_bf16 a[152:155], v[180:183], a[120:123], a[152:155]
  ds_read_b64_tr_b16 v[204:205], v250 offset:30976
  v_mfma_f32_16x16x32_bf16 a[156:159], v[180:183], a[124:127], a[156:159]
  ds_read_b64_tr_b16 v[206:207], v250 offset:36096
  s_waitcnt lgkmcnt(10)
  v_mfma_f32_16x16x32_bf16 a[160:163], v[184:187], a[120:123], a[160:163]
  v_mfma_f32_16x16x32_bf16 a[164:167], v[184:187], a[124:127], a[164:167]
  s_waitcnt lgkmcnt(8)
  v_mfma_f32_16x16x32_bf16 a[168:171], v[188:191], a[120:123], a[168:171]
  v_mfma_f32_16x16x32_bf16 a[172:175], v[188:191], a[124:127], a[172:175]
  s_waitcnt lgkmcnt(0)
  s_barrier
  s_add_u32 s50, s50, 40960
  s_cmp_eq_u32 s50, 163840
  s_cselect_b32 s50, 0, s50
  v_add_u32 v9, s50, v8
  v_add_u32 v250, s50, v251
  ds_read_b64_tr_b16 v[176:177], v9 offset:0
  ds_read_b64_tr_b16 v[178:179], v9 offset:5120
  v_mfma_f32_16x16x32_bf16 a[176:179], v[192:195], a[120:123], a[176:179]
  ds_read_b64_tr_b16 v[180:181], v250 offset:0
  v_mfma_f32_16x16x32_bf16 a[180:183], v[192:195], a[124:127], a[180:183]
  ds_read_b64_tr_b16 v[182:183], v250 offset:5120
  ds_read_b64_tr_b16 v[184:185], v9 offset:64
  v_mfma_f32_16x16x32_bf16 a[184:187], v[196:199], a[120:123], a[184:187]
  ds_read_b64_tr_b16 v[186:187], v9 offset:5184
  v_mfma_f32_16x16x32_bf16 a[188:191], v[196:199], a[124:127], a[188:191]
  ds_read_b64_tr_b16 v[188:189], v250 offset:64
  ds_read_b64_tr_b16 v[190:191], v250 offset:5184
  v_mfma_f32_16x16x32_bf16 a[192:195], v[200:203], a[120:123], a[192:195]
  ds_read_b64_tr_b16 v[192:193], v9 offset:128
  v_mfma_f32_16x16x32_bf16 a[196:199], v[200:203], a[124:127], a[196:199]
  ds_read_b64_tr_b16 v[194:195], v9 offset:5248
  ds_read_b64_tr_b16 v[196:197], v250 offset:128
  v_mfma_f32_16x16x32_bf16 a[200:203], v[204:207], a[120:123], a[200:203]
  ds_read_b64_tr_b16 v[198:199], v250 offset:5248
  v_mfma_f32_16x16x32_bf16 a[204:207], v[204:207], a[124:127], a[204:207]
  s_waitcnt vmcnt(8)
  s_waitcnt lgkmcnt(10)
  v_mfma_f32_16x16x32_bf16 a[128:131], v[176:179], v[208:211], a[128:131]
  ds_read_b64_tr_b16 v[200:201], v9 offset:192
  v_mfma_f32_16x16x32_bf16 a[132:135], v[176:179], v[212:215], a[132:135]
  ds_read_b64_tr_b16 v[202:203], v9 offset:5312
  s_waitcnt lgkmcnt(10)
  v_mfma_f32_16x16x32_bf16 a[136:139], v[180:183], v[208:211], a[136:139]
  ds_read_b64_tr_b16 v[204:205], v250 offset:192
  v_mfma_f32_16x16x32_bf16 a[140:143], v[180:183], v[212:215], a[140:143]
  ds_read_b64_tr_b16 v[206:207], v250 offset:5312
  s_waitcnt lgkmcnt(10)
  v_mfma_f32_16x16x32_bf16 a[144:147], v[184:187], v[208:211], a[144:147]
  ds_read_b64_tr_b16 v[176:177], v9 offset:256
  v_mfma_f32_16x16x32_bf16 a[148:151], v[184:187], v[212:215], a[148:151]
  ds_read_b64_tr_b16 v[178:179], v9 offset:5376
  s_waitcnt lgkmcnt(10)
  v_mfma_f32_16x16x32_bf16 a[152:155], v[188:191], v[208:211], a[152:155]
  ds_read_b64_tr_b16 v[180:181], v250 offset:256
  v_mfma_f32_16x16x32_bf16 a[156:159], v[188:191], v[212:215], a[156:159]
  ds_read_b64_tr_b16 v[182:183], v250 offset:5376
  s_waitcnt lgkmcnt(10)
  v_mfma_f32_16x16x32_bf16 a[160:163], v[192:195], v[208:211], a[160:163]
  ds_read_b64_tr_b16 v[184:185], v9 offset:10240
  v_mfma_f32_16x16x32_bf16 a[164:167], v[192:195], v[212:215], a[164:167]
  ds_read_b64_tr_b16 v[186:187], v9 offset:15360
  s_waitcnt lgkmcnt(10)
  v_mfma_f32_16x16x32_bf16 a[168:171], v[196:199], v[208:211], a[168:171]
  ds_read_b64_tr_b16 v[188:189], v250 offset:10240
  v_mfma_f32_16x16x32_bf16 a[172:175], v[196:199], v[212:215], a[172:175]
  ds_read_b64_tr_b16 v[190:191], v250 offset:15360
  s_waitcnt lgkmcnt(10)
  v_mfma_f32_16x16x32_bf16 a[176:179], v[200:203], v[208:211], a[176:179]
  ds_read_b64_tr_b16 v[192:193], v9 offset:10304
  v_mfma_f32_16x16x32_bf16 a[180:183], v[200:203], v[212:215], a[180:183]
  ds_read_b64_tr_b16 v[194:195], v9 offset:15424
  s_waitcnt lgkmcnt(10)
  v_mfma_f32_16x16x32_bf16 a[184:187], v[204:207], v[208:211], a[184:187]
  ds_read_b64_tr_b16 v[196:197], v250 offset:10304
  v_mfma_f32_16x16x32_bf16 a[188:191], v[204:207], v[212:215], a[188:191]
  ds_read_b64_tr_b16 v[198:199], v250 offset:15424
  s_waitcnt lgkmcnt(10)
  v_mfma_f32_16x16x32_bf16 a[192:195], v[176:179], v[208:211], a[192:195]
  ds_read_b64_tr_b16 v[200:201], v9 offset:10368
  v_mfma_f32_16x16x32_bf16 a[196:199], v[176:179], v[212:215], a[196:199]
  ds_read_b64_tr_b16 v[202:203], v9 offset:15488
  s_waitcnt lgkmcnt(10)
  v_mfma_f32_16x16x32_bf16 a[200:203], v[180:183], v[208:211], a[200:203]
  ds_read_b64_tr_b16 v[204:205], v250 offset:10368
  v_mfma_f32_16x16x32_bf16 a[204:207], v[180:183], v[212:215], a[204:207]
  ds_read_b64_tr_b16 v[206:207], v250 offset:15488
  s_waitcnt lgkmcnt(10)
  v_mfma_f32_16x16x32_bf16 a[128:131], v[184:187], v[216:219], a[128:131]
  ds_read_b64_tr_b16 v[176:177], v9 offset:10432
  v_mfma_f32_16x16x32_bf16 a[132:135], v[184:187], v[220:223], a[132:135]
  ds_read_b64_tr_b16 v[178:179], v9 offset:15552
  s_waitcnt lgkmcnt(10)
  v_mfma_f32_16x16x32_bf16 a[136:139], v[188:191], v[216:219], a[136:139]
  ds_read_b64_tr_b16 v[180:181], v250 offset:10432
  v_mfma_f32_16x16x32_bf16 a[140:143], v[188:191], v[220:223], a[140:143]
  ds_read_b64_tr_b16 v[182:183], v250 offset:15552
  s_waitcnt lgkmcnt(10)
  v_mfma_f32_16x16x32_bf16 a[144:147], v[192:195], v[216:219], a[144:147]
  ds_read_b64_tr_b16 v[184:185], v9 offset:10496
  v_mfma_f32_16x16x32_bf16 a[148:151], v[192:195], v[220:223], a[148:151]
  ds_read_b64_tr_b16 v[186:187], v9 offset:15616
  s_waitcnt lgkmcnt(10)
  v_mfma_f32_16x16x32_bf16 a[152:155], v[196:199], v[216:219], a[152:155]
  ds_read_b64_tr_b16 v[188:189], v250 offset:10496
  v_mfma_f32_16x16x32_bf16 a[156:159], v[196:199], v[220:223], a[156:159]
  ds_read_b64_tr_b16 v[190:191], v250 offset:15616
  s_waitcnt lgkmcnt(10)
  v_mfma_f32_16x16x32_bf16 a[160:163], v[200:203], v[216:219], a[160:163]
  ds_read_b64_tr_b16 v[192:193], v9 offset:20480
  v_mfma_f32_16x16x32_bf16 a[164:167], v[200:203], v[220:223], a[164:167]
  ds_read_b64_tr_b16 v[194:195], v9 offset:25600
  s_waitcnt lgkmcnt(10)
  v_mfma_f32_16x16x32_bf16 a[168:171], v[204:207], v[216:219], a[168:171]
  ds_read_b64_tr_b16 v[196:197], v250 offset:20480
  v_mfma_f32_16x16x32_bf16 a[172:175], v[204:207], v[220:223], a[172:175]
  ds_read_b64_tr_b16 v[198:199], v250 offset:25600
  s_waitcnt lgkmcnt(10)
  v_mfma_f32_16x16x32_bf16 a[176:179], v[176:179], v[216:219], a[176:179]
  ds_read_b64_tr_b16 v[200:201], v9 offset:20544
  v_mfma_f32_16x16x32_bf16 a[180:183], v[176:179], v[220:223], a[180:183]
  ds_read_b64_tr_b16 v[202:203], v9 offset:25664
  s_waitcnt lgkmcnt(10)
  v_mfma_f32_16x16x32_bf16 a[184:187], v[180:183], v[216:219], a[184:187]
  ds_read_b64_tr_b16 v[204:205], v250 offset:20544
  v_mfma_f32_16x16x32_bf16 a[188:191], v[180:183], v[220:223], a[188:191]
  ds_read_b64_tr_b16 v[206:207], v250 offset:25664
  s_waitcnt lgkmcnt(10)
  v_mfma_f32_16x16x32_bf16 a[192:195], v[184:187], v[216:219], a[192:195]
  ds_read_b64_tr_b16 v[176:177], v9 offset:20608
  v_mfma_f32_16x16x32_bf16 a[196:199], v[184:187], v[220:223], a[196:199]
  ds_read_b64_tr_b16 v[178:179], v9 offset:25728
  s_waitcnt lgkmcnt(10)
  v_mfma_f32_16x16x32_bf16 a[200:203], v[188:191], v[216:219], a[200:203]
  ds_read_b64_tr_b16 v[180:181], v250 offset:20608
  v_mfma_f32_16x16x32_bf16 a[204:207], v[188:191], v[220:223], a[204:207]
  ds_read_b64_tr_b16 v[182:183], v250 offset:25728
  s_waitcnt lgkmcnt(10)
  v_mfma_f32_16x16x32_bf16 a[128:131], v[192:195], v[224:227], a[128:131]
  ds_read_b64_tr_b16 v[184:185], v9 offset:20672
  v_mfma_f32_16x16x32_bf16 a[132:135], v[192:195], v[228:231], a[132:135]
  ds_read_b64_tr_b16 v[186:187], v9 offset:25792
  s_waitcnt lgkmcnt(10)
  v_mfma_f32_16x16x32_bf16 a[136:139], v[196:199], v[224:227], a[136:139]
  ds_read_b64_tr_b16 v[188:189], v250 offset:20672
  v_mfma_f32_16x16x32_bf16 a[140:143], v[196:199], v[228:231], a[140:143]
  ds_read_b64_tr_b16 v[190:191], v250 offset:25792
  s_waitcnt lgkmcnt(10)
  v_mfma_f32_16x16x32_bf16 a[144:147], v[200:203], v[224:227], a[144:147]
  ds_read_b64_tr_b16 v[192:193], v9 offset:20736
  v_mfma_f32_16x16x32_bf16 a[148:151], v[200:203], v[228:231], a[148:151]
  ds_read_b64_tr_b16 v[194:195], v9 offset:25856
  s_waitcnt lgkmcnt(10)
  v_mfma_f32_16x16x32_bf16 a[152:155], v[204:207], v[224:227], a[152:155]
  ds_read_b64_tr_b16 v[196:197], v250 offset:20736
  v_mfma_f32_16x16x32_bf16 a[156:159], v[204:207], v[228:231], a[156:159]
  ds_read_b64_tr_b16 v[198:199], v250 offset:25856
  s_waitcnt lgkmcnt(10)
  v_mfma_f32_16x16x32_bf16 a[160:163], v[176:179], v[224:227], a[160:163]
  ds_read_b64_tr_b16 v[200:201], v9 offset:30720
  v_mfma_f32_16x16x32_bf16 a[164:167], v[176:179], v[228:231], a[164:167]
  ds_read_b64_tr_b16 v[202:203], v9 offset:35840
  s_waitcnt lgkmcnt(10)
  v_mfma_f32_16x16x32_bf16 a[168:171], v[180:183], v[224:227], a[168:171]
  ds_read_b64_tr_b16 v[204:205], v250 offset:30720
  v_mfma_f32_16x16x32_bf16 a[172:175], v[180:183], v[228:231], a[172:175]
  ds_read_b64_tr_b16 v[206:207], v250 offset:35840
  s_waitcnt lgkmcnt(10)
  v_mfma_f32_16x16x32_bf16 a[176:179], v[184:187], v[224:227], a[176:179]
  ds_read_b64_tr_b16 v[176:177], v9 offset:30784
  v_mfma_f32_16x16x32_bf16 a[180:183], v[184:187], v[228:231], a[180:183]
  ds_read_b64_tr_b16 v[178:179], v9 offset:35904
  s_waitcnt lgkmcnt(10)
  v_mfma_f32_16x16x32_bf16 a[184:187], v[188:191], v[224:227], a[184:187]
  ds_read_b64_tr_b16 v[180:181], v250 offset:30784
  v_mfma_f32_16x16x32_bf16 a[188:191], v[188:191], v[228:231], a[188:191]
  ds_read_b64_tr_b16 v[182:183], v250 offset:35904
  s_waitcnt lgkmcnt(10)
  v_mfma_f32_16x16x32_bf16 a[192:195], v[192:195], v[224:227], a[192:195]
  ds_read_b64_tr_b16 v[184:185], v9 offset:30848
  v_mfma_f32_16x16x32_bf16 a[196:199], v[192:195], v[228:231], a[196:199]
  ds_read_b64_tr_b16 v[186:187], v9 offset:35968
  s_waitcnt lgkmcnt(10)
  v_mfma_f32_16x16x32_bf16 a[200:203], v[196:199], v[224:227], a[200:203]
  ds_read_b64_tr_b16 v[188:189], v250 offset:30848
  v_mfma_f32_16x16x32_bf16 a[204:207], v[196:199], v[228:231], a[204:207]
  ds_read_b64_tr_b16 v[190:191], v250 offset:35968
  s_waitcnt lgkmcnt(10)
  v_mfma_f32_16x16x32_bf16 a[128:131], v[200:203], v[232:235], a[128:131]
  ds_read_b64_tr_b16 v[192:193], v9 offset:30912
  v_mfma_f32_16x16x32_bf16 a[132:135], v[200:203], v[236:239], a[132:135]
  ds_read_b64_tr_b16 v[194:195], v9 offset:36032
  s_waitcnt lgkmcnt(10)
  v_mfma_f32_16x16x32_bf16 a[136:139], v[204:207], v[232:235], a[136:139]
  ds_read_b64_tr_b16 v[196:197], v250 offset:30912
  v_mfma_f32_16x16x32_bf16 a[140:143], v[204:207], v[236:239], a[140:143]
  ds_read_b64_tr_b16 v[198:199], v250 offset:36032
  s_waitcnt lgkmcnt(10)
  v_mfma_f32_16x16x32_bf16 a[144:147], v[176:179], v[232:235], a[144:147]
  ds_read_b64_tr_b16 v[200:201], v9 offset:30976
  v_mfma_f32_16x16x32_bf16 a[148:151], v[176:179], v[236:239], a[148:151]
  ds_read_b64_tr_b16 v[202:203], v9 offset:36096
  s_waitcnt lgkmcnt(10)
  v_mfma_f32_16x16x32_bf16 a[152:155], v[180:183], v[232:235], a[152:155]
  ds_read_b64_tr_b16 v[204:205], v250 offset:30976
  v_mfma_f32_16x16x32_bf16 a[156:159], v[180:183], v[236:239], a[156:159]
  ds_read_b64_tr_b16 v[206:207], v250 offset:36096
  s_waitcnt lgkmcnt(10)
  v_mfma_f32_16x16x32_bf16 a[160:163], v[184:187], v[232:235], a[160:163]
  v_mfma_f32_16x16x32_bf16 a[164:167], v[184:187], v[236:239], a[164:167]
  s_waitcnt lgkmcnt(8)
  v_mfma_f32_16x16x32_bf16 a[168:171], v[188:191], v[232:235], a[168:171]
  v_mfma_f32_16x16x32_bf16 a[172:175], v[188:191], v[236:239], a[172:175]
  s_waitcnt lgkmcnt(0)
  s_barrier
  s_add_u32 s50, s50, 40960
  s_cmp_eq_u32 s50, 163840
  s_cselect_b32 s50, 0, s50
  v_add_u32 v9, s50, v8
  v_add_u32 v250, s50, v251
  ds_read_b64_tr_b16 v[176:177], v9 offset:0
  ds_read_b64_tr_b16 v[178:179], v9 offset:5120
  v_mfma_f32_16x16x32_bf16 a[176:179], v[192:195], v[232:235], a[176:179]
  ds_read_b64_tr_b16 v[180:181], v250 offset:0
  v_mfma_f32_16x16x32_bf16 a[180:183], v[192:195], v[236:239], a[180:183]
  ds_read_b64_tr_b16 v[182:183], v250 offset:5120
  ds_read_b64_tr_b16 v[184:185], v9 offset:64
  v_mfma_f32_16x16x32_bf16 a[184:187], v[196:199], v[232:235], a[184:187]
  ds_read_b64_tr_b16 v[186:187], v9 offset:5184
  v_mfma_f32_16x16x32_bf16 a[188:191], v[196:199], v[236:239], a[188:191]
  ds_read_b64_tr_b16 v[188:189], v250 offset:64
  ds_read_b64_tr_b16 v[190:191], v250 offset:5184
  v_mfma_f32_16x16x32_bf16 a[192:195], v[200:203], v[232:235], a[192:195]
  ds_read_b64_tr_b16 v[192:193], v9 offset:128
  v_mfma_f32_16x16x32_bf16 a[196:199], v[200:203], v[236:239], a[196:199]
  ds_read_b64_tr_b16 v[194:195], v9 offset:5248
  ds_read_b64_tr_b16 v[196:197], v250 offset:128
  v_mfma_f32_16x16x32_bf16 a[200:203], v[204:207], v[232:235], a[200:203]
  ds_read_b64_tr_b16 v[198:199], v250 offset:5248
  v_mfma_f32_16x16x32_bf16 a[204:207], v[204:207], v[236:239], a[204:207]
  s_waitcnt vmcnt(0)
  s_waitcnt lgkmcnt(10)
  v_mfma_f32_16x16x32_bf16 a[128:131], v[176:179], v[64:67], a[128:131]
  ds_read_b64_tr_b16 v[200:201], v9 offset:192
  v_mfma_f32_16x16x32_bf16 a[132:135], v[176:179], v[68:71], a[132:135]
  ds_read_b64_tr_b16 v[202:203], v9 offset:5312
  s_waitcnt lgkmcnt(10)
  v_mfma_f32_16x16x32_bf16 a[136:139], v[180:183], v[64:67], a[136:139]
  ds_read_b64_tr_b16 v[204:205], v250 offset:192
  v_mfma_f32_16x16x32_bf16 a[140:143], v[180:183], v[68:71], a[140:143]
  ds_read_b64_tr_b16 v[206:207], v250 offset:5312
  s_waitcnt lgkmcnt(10)
  v_mfma_f32_16x16x32_bf16 a[144:147], v[184:187], v[64:67], a[144:147]
  ds_read_b64_tr_b16 v[176:177], v9 offset:256
  v_mfma_f32_16x16x32_bf16 a[148:151], v[184:187], v[68:71], a[148:151]
  ds_read_b64_tr_b16 v[178:179], v9 offset:5376
  s_waitcnt lgkmcnt(10)
  v_mfma_f32_16x16x32_bf16 a[152:155], v[188:191], v[64:67], a[152:155]
  ds_read_b64_tr_b16 v[180:181], v250 offset:256
  v_mfma_f32_16x16x32_bf16 a[156:159], v[188:191], v[68:71], a[156:159]
  ds_read_b64_tr_b16 v[182:183], v250 offset:5376
  s_waitcnt lgkmcnt(10)
  v_mfma_f32_16x16x32_bf16 a[160:163], v[192:195], v[64:67], a[160:163]
  ds_read_b64_tr_b16 v[184:185], v9 offset:10240
  v_mfma_f32_16x16x32_bf16 a[164:167], v[192:195], v[68:71], a[164:167]
  ds_read_b64_tr_b16 v[186:187], v9 offset:15360
  s_waitcnt lgkmcnt(10)
  v_mfma_f32_16x16x32_bf16 a[168:171], v[196:199], v[64:67], a[168:171]
  ds_read_b64_tr_b16 v[188:189], v250 offset:10240
  v_mfma_f32_16x16x32_bf16 a[172:175], v[196:199], v[68:71], a[172:175]
  ds_read_b64_tr_b16 v[190:191], v250 offset:15360
  s_waitcnt lgkmcnt(10)
  v_mfma_f32_16x16x32_bf16 a[176:179], v[200:203], v[64:67], a[176:179]
  ds_read_b64_tr_b16 v[192:193], v9 offset:10304
  v_mfma_f32_16x16x32_bf16 a[180:183], v[200:203], v[68:71], a[180:183]
  ds_read_b64_tr_b16 v[194:195], v9 offset:15424
  s_waitcnt lgkmcnt(10)
  v_mfma_f32_16x16x32_bf16 a[184:187], v[204:207], v[64:67], a[184:187]
  ds_read_b64_tr_b16 v[196:197], v250 offset:10304
  v_mfma_f32_16x16x32_bf16 a[188:191], v[204:207], v[68:71], a[188:191]
  ds_read_b64_tr_b16 v[198:199], v250 offset:15424
  s_waitcnt lgkmcnt(10)
  v_mfma_f32_16x16x32_bf16 a[192:195], v[176:179], v[64:67], a[192:195]
  ds_read_b64_tr_b16 v[200:201], v9 offset:10368
  v_mfma_f32_16x16x32_bf16 a[196:199], v[176:179], v[68:71], a[196:199]
  ds_read_b64_tr_b16 v[202:203], v9 offset:15488
  s_waitcnt lgkmcnt(10)
  v_mfma_f32_16x16x32_bf16 a[200:203], v[180:183], v[64:67], a[200:203]
  ds_read_b64_tr_b16 v[204:205], v250 offset:10368
  v_mfma_f32_16x16x32_bf16 a[204:207], v[180:183], v[68:71], a[204:207]
  ds_read_b64_tr_b16 v[206:207], v250 offset:15488
  s_waitcnt lgkmcnt(10)
  v_mfma_f32_16x16x32_bf16 a[128:131], v[184:187], v[72:75], a[128:131]
  ds_read_b64_tr_b16 v[176:177], v9 offset:10432
  v_mfma_f32_16x16x32_bf16 a[132:135], v[184:187], v[76:79], a[132:135]
  ds_read_b64_tr_b16 v[178:179], v9 offset:15552
  s_waitcnt lgkmcnt(10)
  v_mfma_f32_16x16x32_bf16 a[136:139], v[188:191], v[72:75], a[136:139]
  ds_read_b64_tr_b16 v[180:181], v250 offset:10432
  v_mfma_f32_16x16x32_bf16 a[140:143], v[188:191], v[76:79], a[140:143]
  ds_read_b64_tr_b16 v[182:183], v250 offset:15552
  s_waitcnt lgkmcnt(10)
  v_mfma_f32_16x16x32_bf16 a[144:147], v[192:195], v[72:75], a[144:147]
  ds_read_b64_tr_b16 v[184:185], v9 offset:10496
  v_mfma_f32_16x16x32_bf16 a[148:151], v[192:195], v[76:79], a[148:151]
  ds_read_b64_tr_b16 v[186:187], v9 offset:15616
  s_waitcnt lgkmcnt(10)
  v_mfma_f32_16x16x32_bf16 a[152:155], v[196:199], v[72:75], a[152:155]
  ds_read_b64_tr_b16 v[188:189], v250 offset:10496
  v_mfma_f32_16x16x32_bf16 a[156:159], v[196:199], v[76:79], a[156:159]
  ds_read_b64_tr_b16 v[190:191], v250 offset:15616
  s_waitcnt lgkmcnt(10)
  v_mfma_f32_16x16x32_bf16 a[160:163], v[200:203], v[72:75], a[160:163]
  ds_read_b64_tr_b16 v[192:193], v9 offset:20480
  v_mfma_f32_16x16x32_bf16 a[164:167], v[200:203], v[76:79], a[164:167]
  ds_read_b64_tr_b16 v[194:195], v9 offset:25600
  s_waitcnt lgkmcnt(10)
  v_mfma_f32_16x16x32_bf16 a[168:171], v[204:207], v[72:75], a[168:171]
  ds_read_b64_tr_b16 v[196:197], v250 offset:20480
  v_mfma_f32_16x16x32_bf16 a[172:175], v[204:207], v[76:79], a[172:175]
  ds_read_b64_tr_b16 v[198:199], v250 offset:25600
  s_waitcnt lgkmcnt(10)
  v_mfma_f32_16x16x32_bf16 a[176:179], v[176:179], v[72:75], a[176:179]
  ds_read_b64_tr_b16 v[200:201], v9 offset:20544
  v_mfma_f32_16x16x32_bf16 a[180:183], v[176:179], v[76:79], a[180:183]
  ds_read_b64_tr_b16 v[202:203], v9 offset:25664
  s_waitcnt lgkmcnt(10)
  v_mfma_f32_16x16x32_bf16 a[184:187], v[180:183], v[72:75], a[184:187]
  ds_read_b64_tr_b16 v[204:205], v250 offset:20544
  v_mfma_f32_16x16x32_bf16 a[188:191], v[180:183], v[76:79], a[188:191]
  ds_read_b64_tr_b16 v[206:207], v250 offset:25664
  s_waitcnt lgkmcnt(10)
  v_mfma_f32_16x16x32_bf16 a[192:195], v[184:187], v[72:75], a[192:195]
  ds_read_b64_tr_b16 v[176:177], v9 offset:20608
  v_mfma_f32_16x16x32_bf16 a[196:199], v[184:187], v[76:79], a[196:199]
  ds_read_b64_tr_b16 v[178:179], v9 offset:25728
  s_waitcnt lgkmcnt(10)
  v_mfma_f32_16x16x32_bf16 a[200:203], v[188:191], v[72:75], a[200:203]
  ds_read_b64_tr_b16 v[180:181], v250 offset:20608
  v_mfma_f32_16x16x32_bf16 a[204:207], v[188:191], v[76:79], a[204:207]
  ds_read_b64_tr_b16 v[182:183], v250 offset:25728
  s_waitcnt lgkmcnt(10)
  v_mfma_f32_16x16x32_bf16 a[128:131], v[192:195], v[80:83], a[128:131]
  ds_read_b64_tr_b16 v[184:185], v9 offset:20672
  v_mfma_f32_16x16x32_bf16 a[132:135], v[192:195], v[84:87], a[132:135]
  ds_read_b64_tr_b16 v[186:187], v9 offset:25792
  s_waitcnt lgkmcnt(10)
  v_mfma_f32_16x16x32_bf16 a[136:139], v[196:199], v[80:83], a[136:139]
  ds_read_b64_tr_b16 v[188:189], v250 offset:20672
  v_mfma_f32_16x16x32_bf16 a[140:143], v[196:199], v[84:87], a[140:143]
  ds_read_b64_tr_b16 v[190:191], v250 offset:25792
  s_waitcnt lgkmcnt(10)
  v_mfma_f32_16x16x32_bf16 a[144:147], v[200:203], v[80:83], a[144:147]
  ds_read_b64_tr_b16 v[192:193], v9 offset:20736
  v_mfma_f32_16x16x32_bf16 a[148:151], v[200:203], v[84:87], a[148:151]
  ds_read_b64_tr_b16 v[194:195], v9 offset:25856
  s_waitcnt lgkmcnt(10)
  v_mfma_f32_16x16x32_bf16 a[152:155], v[204:207], v[80:83], a[152:155]
  ds_read_b64_tr_b16 v[196:197], v250 offset:20736
  v_mfma_f32_16x16x32_bf16 a[156:159], v[204:207], v[84:87], a[156:159]
  ds_read_b64_tr_b16 v[198:199], v250 offset:25856
  s_waitcnt lgkmcnt(10)
  v_mfma_f32_16x16x32_bf16 a[160:163], v[176:179], v[80:83], a[160:163]
  ds_read_b64_tr_b16 v[200:201], v9 offset:30720
  v_mfma_f32_16x16x32_bf16 a[164:167], v[176:179], v[84:87], a[164:167]
  ds_read_b64_tr_b16 v[202:203], v9 offset:35840
  s_waitcnt lgkmcnt(10)
  v_mfma_f32_16x16x32_bf16 a[168:171], v[180:183], v[80:83], a[168:171]
  ds_read_b64_tr_b16 v[204:205], v250 offset:30720
  v_mfma_f32_16x16x32_bf16 a[172:175], v[180:183], v[84:87], a[172:175]
  ds_read_b64_tr_b16 v[206:207], v250 offset:35840
  s_waitcnt lgkmcnt(10)
  v_mfma_f32_16x16x32_bf16 a[176:179], v[184:187], v[80:83], a[176:179]
  ds_read_b64_tr_b16 v[176:177], v9 offset:30784
  v_mfma_f32_16x16x32_bf16 a[180:183], v[184:187], v[84:87], a[180:183]
  ds_read_b64_tr_b16 v[178:179], v9 offset:35904
  s_waitcnt lgkmcnt(10)
  v_mfma_f32_16x16x32_bf16 a[184:187], v[188:191], v[80:83], a[184:187]
  ds_read_b64_tr_b16 v[180:181], v250 offset:30784
  v_mfma_f32_16x16x32_bf16 a[188:191], v[188:191], v[84:87], a[188:191]
  ds_read_b64_tr_b16 v[182:183], v250 offset:35904
  s_waitcnt lgkmcnt(10)
  v_mfma_f32_16x16x32_bf16 a[192:195], v[192:195], v[80:83], a[192:195]
  ds_read_b64_tr_b16 v[184:185], v9 offset:30848
  v_mfma_f32_16x16x32_bf16 a[196:199], v[192:195], v[84:87], a[196:199]
  ds_read_b64_tr_b16 v[186:187], v9 offset:35968
  s_waitcnt lgkmcnt(10)
  v_mfma_f32_16x16x32_bf16 a[200:203], v[196:199], v[80:83], a[200:203]
  ds_read_b64_tr_b16 v[188:189], v250 offset:30848
  v_mfma_f32_16x16x32_bf16 a[204:207], v[196:199], v[84:87], a[204:207]
  ds_read_b64_tr_b16 v[190:191], v250 offset:35968
  s_waitcnt lgkmcnt(10)
  v_mfma_f32_16x16x32_bf16 a[128:131], v[200:203], v[88:91], a[128:131]
  ds_read_b64_tr_b16 v[192:193], v9 offset:30912
  v_mfma_f32_16x16x32_bf16 a[132:135], v[200:203], v[92:95], a[132:135]
  ds_read_b64_tr_b16 v[194:195], v9 offset:36032
  s_waitcnt lgkmcnt(10)
  v_mfma_f32_16x16x32_bf16 a[136:139], v[204:207], v[88:91], a[136:139]
  ds_read_b64_tr_b16 v[196:197], v250 offset:30912
  v_mfma_f32_16x16x32_bf16 a[140:143], v[204:207], v[92:95], a[140:143]
  ds_read_b64_tr_b16 v[198:199], v250 offset:36032
  s_waitcnt lgkmcnt(10)
  v_mfma_f32_16x16x32_bf16 a[144:147], v[176:179], v[88:91], a[144:147]
  ds_read_b64_tr_b16 v[200:201], v9 offset:30976
  v_mfma_f32_16x16x32_bf16 a[148:151], v[176:179], v[92:95], a[148:151]
  ds_read_b64_tr_b16 v[202:203], v9 offset:36096
  s_waitcnt lgkmcnt(10)
  v_mfma_f32_16x16x32_bf16 a[152:155], v[180:183], v[88:91], a[152:155]
  ds_read_b64_tr_b16 v[204:205], v250 offset:30976
  v_mfma_f32_16x16x32_bf16 a[156:159], v[180:183], v[92:95], a[156:159]
  ds_read_b64_tr_b16 v[206:207], v250 offset:36096
  s_waitcnt lgkmcnt(10)
  v_mfma_f32_16x16x32_bf16 a[160:163], v[184:187], v[88:91], a[160:163]
  v_mfma_f32_16x16x32_bf16 a[164:167], v[184:187], v[92:95], a[164:167]
  s_waitcnt lgkmcnt(8)
  v_mfma_f32_16x16x32_bf16 a[168:171], v[188:191], v[88:91], a[168:171]
  v_mfma_f32_16x16x32_bf16 a[172:175], v[188:191], v[92:95], a[172:175]
  s_waitcnt lgkmcnt(0)
  s_barrier
  s_add_u32 s50, s50, 40960
  s_cmp_eq_u32 s50, 163840
  s_cselect_b32 s50, 0, s50
  v_mfma_f32_16x16x32_bf16 a[176:179], v[192:195], v[88:91], a[176:179]
  v_mfma_f32_16x16x32_bf16 a[180:183], v[192:195], v[92:95], a[180:183]
  v_mfma_f32_16x16x32_bf16 a[184:187], v[196:199], v[88:91], a[184:187]
  v_mfma_f32_16x16x32_bf16 a[188:191], v[196:199], v[92:95], a[188:191]
  v_mfma_f32_16x16x32_bf16 a[192:195], v[200:203], v[88:91], a[192:195]
  v_mfma_f32_16x16x32_bf16 a[196:199], v[200:203], v[92:95], a[196:199]
  v_mfma_f32_16x16x32_bf16 a[200:203], v[204:207], v[88:91], a[200:203]
  v_mfma_f32_16x16x32_bf16 a[204:207], v[204:207], v[92:95], a[204:207]
  s_mov_b32 s53, 4
  s_mov_b32 s52, 16
  s_branch L_loop
L_tail:
  s_cmp_eq_u32 s64, 0
  s_cbranch_scc0 L_tail1
  v_mov_b32 v158, 40000
  ds_read_b64 v[12:13], v158
L_tail1:
  v_mfma_f32_16x16x32_bf16 a[0:3], v[96:99], v[136:139], a[0:3]
  v_add_u32 v56, s50, v164
  v_xor_b32 v57, 32, v56
  v_xor_b32 v58, 64, v56
  v_mfma_f32_16x16x32_bf16 a[4:7], v[96:99], v[140:143], a[4:7]
  v_xor_b32 v59, 96, v56
  v_xor_b32 v60, 128, v56
  v_xor_b32 v61, 160, v56
  v_xor_b32 v62, 192, v56
  v_mfma_f32_16x16x32_bf16 a[8:11], v[100:103], v[136:139], a[8:11]
  v_xor_b32 v63, 224, v56
  ds_read_b64_tr_b16 v[64:65], v56 offset:0
  ds_read_b64_tr_b16 v[66:67], v56 offset:4096
  v_mfma_f32_16x16x32_bf16 a[12:15], v[100:103], v[140:143], a[12:15]
  ds_read_b64_tr_b16 v[68:69], v57 offset:0
  ds_read_b64_tr_b16 v[70:71], v57 offset:4096
  ds_read_b64_tr_b16 v[72:73], v58 offset:0
  v_mfma_f32_16x16x32_bf16 a[16:19], v[104:107], v[136:139], a[16:19]
  ds_read_b64_tr_b16 v[74:75], v58 offset:4096
  ds_read_b64_tr_b16 v[76:77], v59 offset:0
  ds_read_b64_tr_b16 v[78:79], v59 offset:4096
  v_mfma_f32_16x16x32_bf16 a[20:23], v[104:107], v[140:143], a[20:23]
  ds_read_b64_tr_b16 v[80:81], v60 offset:0
  ds_read_b64_tr_b16 v[82:83], v60 offset:4096
  ds_read_b64_tr_b16 v[84:85], v61 offset:0
  ds_read_b64_tr_b16 v[86:87], v61 offset:4096
  v_mfma_f32_16x16x32_bf16 a[24:27], v[108:111], v[136:139], a[24:27]
  ds_read_b64_tr_b16 v[88:89], v62 offset:0
  ds_read_b64_tr_b16 v[90:91], v62 offset:4096
  ds_read_b64_tr_b16 v[92:93], v63 offset:0
  v_mfma_f32_16x16x32_bf16 a[28:31], v[108:111], v[140:143], a[28:31]
  ds_read_b64_tr_b16 v[94:95], v63 offset:4096
  v_exp_f32 v146, v26
  v_mfma_f32_16x16x32_bf16 a[32:35], v[112:115], v[136:139], a[32:35]
  v_exp_f32 v147, v27
  v_add_f32 v157, v144, v145
  v_mfma_f32_16x16x32_bf16 a[36:39], v[112:115], v[140:143], a[36:39]
  v_cvt_pk_bf16_f32 v132, v144, v145
  v_exp_f32 v144, v28
  v_mfma_f32_16x16x32_bf16 a[40:43], v[116:119], v[136:139], a[40:43]
  v_exp_f32 v145, v29
  v_add_f32 v157, v157, v146
  v_add_f32 v157, v157, v147
  v_mfma_f32_16x16x32_bf16 a[44:47], v[116:119], v[140:143], a[44:47]
  v_cvt_pk_bf16_f32 v133, v146, v147
  v_exp_f32 v146, v30
  v_mfma_f32_16x16x32_bf16 a[48:51], v[120:123], v[136:139], a[48:51]
  v_exp_f32 v147, v31
  v_add_f32 v157, v157, v144
  v_mfma_f32_16x16x32_bf16 a[52:55], v[120:123], v[140:143], a[52:55]
  v_add_f32 v157, v157, v145
  v_cvt_pk_bf16_f32 v134, v144, v145
  v_add_f32 v157, v157, v146
  v_add_f32 v157, v157, v147
  v_mfma_f32_16x16x32_bf16 a[56:59], v[124:127], v[136:139], a[56:59]
  v_max_f32 v159, v156, v157
  v_cmp_lt_f32 vcc, s54, v159
  v_cvt_pk_bf16_f32 v135, v146, v147
  v_mfma_f32_16x16x32_bf16 a[60:63], v[124:127], v[140:143], a[60:63]
  v_add_f32 v149, v151, v157
  s_cbranch_vccnz Lfb_35
Lbk_36:
  s_waitcnt lgkmcnt(0)
  v_mfma_f32_16x16x32_bf16 a[0:3], v[64:67], v[128:131], a[0:3]
  ds_read_b64_tr_b16 v[96:97], v56 offset:8192
  ds_read_b64_tr_b16 v[98:99], v56 offset:12288
  ds_read_b64_tr_b16 v[100:101], v57 offset:8192
  ds_read_b64_tr_b16 v[102:103], v57 offset:12288
  ds_read_b64_tr_b16 v[104:105], v58 offset:8192
  v_mfma_f32_16x16x32_bf16 a[4:7], v[64:67], v[132:135], a[4:7]
  ds_read_b64_tr_b16 v[106:107], v58 offset:12288
  ds_read_b64_tr_b16 v[108:109], v59 offset:8192
  ds_read_b64_tr_b16 v[110:111], v59 offset:12288
  ds_read_b64_tr_b16 v[112:113], v60 offset:8192
  ds_read_b64_tr_b16 v[114:115], v60 offset:12288
  v_mfma_f32_16x16x32_bf16 a[8:11], v[68:71], v[128:131], a[8:11]
  ds_read_b64_tr_b16 v[116:117], v61 offset:8192
  ds_read_b64_tr_b16 v[118:119], v61 offset:12288
  ds_read_b64_tr_b16 v[120:121], v62 offset:8192
  ds_read_b64_tr_b16 v[122:123], v62 offset:12288
  ds_read_b64_tr_b16 v[124:125], v63 offset:8192
  v_mfma_f32_16x16x32_bf16 a[12:15], v[68:71], v[132:135], a[12:15]
  ds_read_b64_tr_b16 v[126:127], v63 offset:12288
  v_exp_f32 v144, v32
  v_exp_f32 v145, v33
  v_mfma_f32_16x16x32_bf16 a[16:19], v[72:75], v[128:131], a[16:19]
  v_exp_f32 v146, v34
  v_exp_f32 v147, v35
  v_mfma_f32_16x16x32_bf16 a[20:23], v[72:75], v[132:135], a[20:23]
  v_add_f32 v156, v144, v145
  v_cvt_pk_bf16_f32 v136, v144, v145
  v_exp_f32 v144, v36
  v_exp_f32 v145, v37
  v_mfma_f32_16x16x32_bf16 a[24:27], v[76:79], v[128:131], a[24:27]
  v_add_f32 v156, v156, v146
  v_add_f32 v156, v156, v147
  v_cvt_pk_bf16_f32 v137, v146, v147
  v_exp_f32 v146, v38
  v_mfma_f32_16x16x32_bf16 a[28:31], v[76:79], v[132:135], a[28:31]
  v_exp_f32 v147, v39
  v_add_f32 v156, v156, v144
  v_add_f32 v156, v156, v145
  v_mfma_f32_16x16x32_bf16 a[32:35], v[80:83], v[128:131], a[32:35]
  v_cvt_pk_bf16_f32 v138, v144, v145
  v_exp_f32 v144, v40
  v_exp_f32 v145, v41
  v_mfma_f32_16x16x32_bf16 a[36:39], v[80:83], v[132:135], a[36:39]
  v_add_f32 v156, v156, v146
  v_add_f32 v156, v156, v147
  v_cvt_pk_bf16_f32 v139, v146, v147
  v_add_f32 v150, v148, v156
  v_mfma_f32_16x16x32_bf16 a[40:43], v[84:87], v[128:131], a[40:43]
  v_exp_f32 v146, v42
  v_exp_f32 v147, v43
  v_add_f32 v157, v144, v145
  v_cvt_pk_bf16_f32 v140, v144, v145
  v_mfma_f32_16x16x32_bf16 a[44:47], v[84:87], v[132:135], a[44:47]
  v_exp_f32 v144, v44
  v_exp_f32 v145, v45
  v_mfma_f32_16x16x32_bf16 a[48:51], v[88:91], v[128:131], a[48:51]
  v_add_f32 v157, v157, v146
  v_add_f32 v157, v157, v147
  v_cvt_pk_bf16_f32 v141, v146, v147
  v_exp_f32 v146, v46
  v_mfma_f32_16x16x32_bf16 a[52:55], v[88:91], v[132:135], a[52:55]
  v_exp_f32 v147, v47
  v_add_f32 v157, v157, v144
  v_add_f32 v157, v157, v145
  v_cvt_pk_bf16_f32 v142, v144, v145
  v_mfma_f32_16x16x32_bf16 a[56:59], v[92:95], v[128:131], a[56:59]
  v_add_f32 v157, v157, v146
  v_add_f32 v157, v157, v147
  v_max_f32 v159, v156, v157
  v_cmp_lt_f32 vcc, s54, v159
  v_cvt_pk_bf16_f32 v143, v146, v147
  v_mfma_f32_16x16x32_bf16 a[60:63], v[92:95], v[132:135], a[60:63]
  v_add_f32 v151, v149, v157
  s_cbranch_vccnz Lfb_37
Lbk_38:
  s_waitcnt lgkmcnt(0)
  v_mfma_f32_16x16x32_bf16 a[0:3], v[96:99], v[136:139], a[0:3]
  v_mov_b32 v240, v150
  v_mfma_f32_16x16x32_bf16 a[4:7], v[96:99], v[140:143], a[4:7]
  v_mov_b32 v241, v151
  s_nop 0
  v_mfma_f32_16x16x32_bf16 a[8:11], v[100:103], v[136:139], a[8:11]
  v_permlane32_swap_b32 v150, v240
  v_mfma_f32_16x16x32_bf16 a[12:15], v[100:103], v[140:143], a[12:15]
  v_permlane32_swap_b32 v151, v241
  v_mfma_f32_16x16x32_bf16 a[16:19], v[104:107], v[136:139], a[16:19]
  v_add_f32 v150, v150, v240
  v_mfma_f32_16x16x32_bf16 a[20:23], v[104:107], v[140:143], a[20:23]
  v_add_f32 v151, v151, v241
  v_mov_b32 v240, v150
  v_mfma_f32_16x16x32_bf16 a[24:27], v[108:111], v[136:139], a[24:27]
  v_mov_b32 v241, v151
  v_mfma_f32_16x16x32_bf16 a[28:31], v[108:111], v[140:143], a[28:31]
  s_nop 0
  v_mfma_f32_16x16x32_bf16 a[32:35], v[112:115], v[136:139], a[32:35]
  v_permlane16_swap_b32 v150, v240
  v_mfma_f32_16x16x32_bf16 a[36:39], v[112:115], v[140:143], a[36:39]
  v_permlane16_swap_b32 v151, v241
  v_add_f32 v150, v150, v240
  v_mfma_f32_16x16x32_bf16 a[40:43], v[116:119], v[136:139], a[40:43]
  v_add_f32 v151, v151, v241
  v_mfma_f32_16x16x32_bf16 a[44:47], v[116:119], v[140:143], a[44:47]
  v_rcp_f32 v144, v150
  v_mfma_f32_16x16x32_bf16 a[48:51], v[120:123], v[136:139], a[48:51]
  v_mfma_f32_16x16x32_bf16 a[52:55], v[120:123], v[140:143], a[52:55]
  v_rcp_f32 v146, v151
  v_mfma_f32_16x16x32_bf16 a[56:59], v[124:127], v[136:139], a[56:59]
  s_add_u32 s46, s55, 4096
  v_mfma_f32_16x16x32_bf16 a[60:63], v[124:127], v[140:143], a[60:63]
  s_cmp_eq_u32 s64, 0
  s_cbranch_scc0 L_final
  s_lshl_b32 s46, s3, 11
  s_add_u32 s46, s46, 33280
  v_add_u32 v56, s46, v10
  v_add_u32 v57, 81920, v56
  v_accvgpr_read_b32 v16, a0
  v_accvgpr_read_b32 v17, a1
  v_accvgpr_read_b32 v18, a2
  v_accvgpr_read_b32 v19, a3
  v_accvgpr_read_b32 v20, a8
  v_accvgpr_read_b32 v21, a9
  v_accvgpr_read_b32 v22, a10
  v_accvgpr_read_b32 v23, a11
  v_accvgpr_read_b32 v24, a4
  v_accvgpr_read_b32 v25, a5
  v_accvgpr_read_b32 v26, a6
  v_accvgpr_read_b32 v27, a7
  v_accvgpr_read_b32 v28, a12
  v_accvgpr_read_b32 v29, a13
  v_accvgpr_read_b32 v30, a14
  v_accvgpr_read_b32 v31, a15
  v_pk_mul_f32 v[16:17], v[16:17], v[144:145] op_sel_hi:[1,0]
  v_pk_mul_f32 v[18:19], v[18:19], v[144:145] op_sel_hi:[1,0]
  v_pk_mul_f32 v[20:21], v[20:21], v[144:145] op_sel_hi:[1,0]
  v_pk_mul_f32 v[22:23], v[22:23], v[144:145] op_sel_hi:[1,0]
  v_pk_mul_f32 v[24:25], v[24:25], v[146:147] op_sel_hi:[1,0]
  v_pk_mul_f32 v[26:27], v[26:27], v[146:147] op_sel_hi:[1,0]
  v_pk_mul_f32 v[28:29], v[28:29], v[146:147] op_sel_hi:[1,0]
  v_pk_mul_f32 v[30:31], v[30:31], v[146:147] op_sel_hi:[1,0]
  v_cvt_pk_bf16_f32 v96, v16, v17
  v_cvt_pk_bf16_f32 v97, v18, v19
  v_cvt_pk_bf16_f32 v98, v20, v21
  v_cvt_pk_bf16_f32 v99, v22, v23
  v_cvt_pk_bf16_f32 v100, v24, v25
  v_cvt_pk_bf16_f32 v101, v26, v27
  v_cvt_pk_bf16_f32 v102, v28, v29
  v_cvt_pk_bf16_f32 v103, v30, v31
  ds_write_b128 v56, v[96:99] offset:0
  ds_write_b128 v56, v[100:103] offset:1024
  v_accvgpr_write_b32 a208, v96
  v_accvgpr_write_b32 a209, v97
  v_accvgpr_write_b32 a210, v98
  v_accvgpr_write_b32 a211, v99
  v_accvgpr_write_b32 a212, v100
  v_accvgpr_write_b32 a213, v101
  v_accvgpr_write_b32 a214, v102
  v_accvgpr_write_b32 a215, v103
  v_accvgpr_read_b32 v32, a16
  v_accvgpr_read_b32 v33, a17
  v_accvgpr_read_b32 v34, a18
  v_accvgpr_read_b32 v35, a19
  v_accvgpr_read_b32 v36, a24
  v_accvgpr_read_b32 v37, a25
  v_accvgpr_read_b32 v38, a26
  v_accvgpr_read_b32 v39, a27
  v_accvgpr_read_b32 v40, a20
  v_accvgpr_read_b32 v41, a21
  v_accvgpr_read_b32 v42, a22
  v_accvgpr_read_b32 v43, a23
  v_accvgpr_read_b32 v44, a28
  v_accvgpr_read_b32 v45, a29
  v_accvgpr_read_b32 v46, a30
  v_accvgpr_read_b32 v47, a31
  v_pk_mul_f32 v[32:33], v[32:33], v[144:145] op_sel_hi:[1,0]
  v_pk_mul_f32 v[34:35], v[34:35], v[144:145] op_sel_hi:[1,0]
  v_pk_mul_f32 v[36:37], v[36:37], v[144:145] op_sel_hi:[1,0]
  v_pk_mul_f32 v[38:39], v[38:39], v[144:145] op_sel_hi:[1,0]
  v_pk_mul_f32 v[40:41], v[40:41], v[146:147] op_sel_hi:[1,0]
  v_pk_mul_f32 v[42:43], v[42:43], v[146:147] op_sel_hi:[1,0]
  v_pk_mul_f32 v[44:45], v[44:45], v[146:147] op_sel_hi:[1,0]
  v_pk_mul_f32 v[46:47], v[46:47], v[146:147] op_sel_hi:[1,0]
  v_cvt_pk_bf16_f32 v104, v32, v33
  v_cvt_pk_bf16_f32 v105, v34, v35
  v_cvt_pk_bf16_f32 v106, v36, v37
  v_cvt_pk_bf16_f32 v107, v38, v39
  v_cvt_pk_bf16_f32 v108, v40, v41
  v_cvt_pk_bf16_f32 v109, v42, v43
  v_cvt_pk_bf16_f32 v110, v44, v45
  v_cvt_pk_bf16_f32 v111, v46, v47
  ds_write_b128 v56, v[104:107] offset:40960
  ds_write_b128 v56, v[108:111] offset:41984
  v_accvgpr_write_b32 a216, v104
  v_accvgpr_write_b32 a217, v105
  v_accvgpr_write_b32 a218, v106
  v_accvgpr_write_b32 a219, v107
  v_accvgpr_write_b32 a220, v108
  v_accvgpr_write_b32 a221, v109
  v_accvgpr_write_b32 a222, v110
  v_accvgpr_write_b32 a223, v111
  v_accvgpr_read_b32 v16, a32
  v_accvgpr_read_b32 v17, a33
  v_accvgpr_read_b32 v18, a34
  v_accvgpr_read_b32 v19, a35
  v_accvgpr_read_b32 v20, a40
  v_accvgpr_read_b32 v21, a41
  v_accvgpr_read_b32 v22, a42
  v_accvgpr_read_b32 v23, a43
  v_accvgpr_read_b32 v24, a36
  v_accvgpr_read_b32 v25, a37
  v_accvgpr_read_b32 v26, a38
  v_accvgpr_read_b32 v27, a39
  v_accvgpr_read_b32 v28, a44
  v_accvgpr_read_b32 v29, a45
  v_accvgpr_read_b32 v30, a46
  v_accvgpr_read_b32 v31, a47
  v_pk_mul_f32 v[16:17], v[16:17], v[144:145] op_sel_hi:[1,0]
  v_pk_mul_f32 v[18:19], v[18:19], v[144:145] op_sel_hi:[1,0]
  v_pk_mul_f32 v[20:21], v[20:21], v[144:145] op_sel_hi:[1,0]
  v_pk_mul_f32 v[22:23], v[22:23], v[144:145] op_sel_hi:[1,0]
  v_pk_mul_f32 v[24:25], v[24:25], v[146:147] op_sel_hi:[1,0]
  v_pk_mul_f32 v[26:27], v[26:27], v[146:147] op_sel_hi:[1,0]
  v_pk_mul_f32 v[28:29], v[28:29], v[146:147] op_sel_hi:[1,0]
  v_pk_mul_f32 v[30:31], v[30:31], v[146:147] op_sel_hi:[1,0]
  v_cvt_pk_bf16_f32 v112, v16, v17
  v_cvt_pk_bf16_f32 v113, v18, v19
  v_cvt_pk_bf16_f32 v114, v20, v21
  v_cvt_pk_bf16_f32 v115, v22, v23
  v_cvt_pk_bf16_f32 v116, v24, v25
  v_cvt_pk_bf16_f32 v117, v26, v27
  v_cvt_pk_bf16_f32 v118, v28, v29
  v_cvt_pk_bf16_f32 v119, v30, v31
  ds_write_b128 v57, v[112:115] offset:0
  ds_write_b128 v57, v[116:119] offset:1024
  v_accvgpr_write_b32 a224, v112
  v_accvgpr_write_b32 a225, v113
  v_accvgpr_write_b32 a226, v114
  v_accvgpr_write_b32 a227, v115
  v_accvgpr_write_b32 a228, v116
  v_accvgpr_write_b32 a229, v117
  v_accvgpr_write_b32 a230, v118
  v_accvgpr_write_b32 a231, v119
  v_accvgpr_read_b32 v32, a48
  v_accvgpr_read_b32 v33, a49
  v_accvgpr_read_b32 v34, a50
  v_accvgpr_read_b32 v35, a51
  v_accvgpr_read_b32 v36, a56
  v_accvgpr_read_b32 v37, a57
  v_accvgpr_read_b32 v38, a58
  v_accvgpr_read_b32 v39, a59
  v_accvgpr_read_b32 v40, a52
  v_accvgpr_read_b32 v41, a53
  v_accvgpr_read_b32 v42, a54
  v_accvgpr_read_b32 v43, a55
  v_accvgpr_read_b32 v44, a60
  v_accvgpr_read_b32 v45, a61
  v_accvgpr_read_b32 v46, a62
  v_accvgpr_read_b32 v47, a63
  v_pk_mul_f32 v[32:33], v[32:33], v[144:145] op_sel_hi:[1,0]
  v_pk_mul_f32 v[34:35], v[34:35], v[144:145] op_sel_hi:[1,0]
  v_pk_mul_f32 v[36:37], v[36:37], v[144:145] op_sel_hi:[1,0]
  v_pk_mul_f32 v[38:39], v[38:39], v[144:145] op_sel_hi:[1,0]
  v_pk_mul_f32 v[40:41], v[40:41], v[146:147] op_sel_hi:[1,0]
  v_pk_mul_f32 v[42:43], v[42:43], v[146:147] op_sel_hi:[1,0]
  v_pk_mul_f32 v[44:45], v[44:45], v[146:147] op_sel_hi:[1,0]
  v_pk_mul_f32 v[46:47], v[46:47], v[146:147] op_sel_hi:[1,0]
  v_cvt_pk_bf16_f32 v120, v32, v33
  v_cvt_pk_bf16_f32 v121, v34, v35
  v_cvt_pk_bf16_f32 v122, v36, v37
  v_cvt_pk_bf16_f32 v123, v38, v39
  v_cvt_pk_bf16_f32 v124, v40, v41
  v_cvt_pk_bf16_f32 v125, v42, v43
  v_cvt_pk_bf16_f32 v126, v44, v45
  v_cvt_pk_bf16_f32 v127, v46, v47
  ds_write_b128 v57, v[120:123] offset:40960
  ds_write_b128 v57, v[124:127] offset:41984
  v_accvgpr_write_b32 a232, v120
  v_accvgpr_write_b32 a233, v121
  v_accvgpr_write_b32 a234, v122
  v_accvgpr_write_b32 a235, v123
  v_accvgpr_write_b32 a236, v124
  v_accvgpr_write_b32 a237, v125
  v_accvgpr_write_b32 a238, v126
  v_accvgpr_write_b32 a239, v127
  s_mov_b32 s64, 1
  s_add_u32 s55, s55, 24576
  s_branch L_item
L_final:
  s_add_u32 s50, s50, 40960
  s_cmp_eq_u32 s50, 163840
  s_cselect_b32 s50, 0, s50
  s_barrier
  s_cmp_eq_u32 s60, 7
  s_cbranch_scc1 L_finf
  v_accvgpr_read_b32 v16, a0
  v_accvgpr_read_b32 v17, a1
  v_accvgpr_read_b32 v18, a2
  v_accvgpr_read_b32 v19, a3
  v_accvgpr_read_b32 v20, a8
  v_accvgpr_read_b32 v21, a9
  v_accvgpr_read_b32 v22, a10
  v_accvgpr_read_b32 v23, a11
  v_accvgpr_read_b32 v24, a4
  v_accvgpr_read_b32 v25, a5
  v_accvgpr_read_b32 v26, a6
  v_accvgpr_read_b32 v27, a7
  v_accvgpr_read_b32 v28, a12
  v_accvgpr_read_b32 v29, a13
  v_accvgpr_read_b32 v30, a14
  v_accvgpr_read_b32 v31, a15
  v_pk_mul_f32 v[16:17], v[16:17], v[144:145] op_sel_hi:[1,0]
  v_pk_mul_f32 v[18:19], v[18:19], v[144:145] op_sel_hi:[1,0]
  v_pk_mul_f32 v[20:21], v[20:21], v[144:145] op_sel_hi:[1,0]
  v_pk_mul_f32 v[22:23], v[22:23], v[144:145] op_sel_hi:[1,0]
  v_pk_mul_f32 v[24:25], v[24:25], v[146:147] op_sel_hi:[1,0]
  v_pk_mul_f32 v[26:27], v[26:27], v[146:147] op_sel_hi:[1,0]
  v_pk_mul_f32 v[28:29], v[28:29], v[146:147] op_sel_hi:[1,0]
  v_pk_mul_f32 v[30:31], v[30:31], v[146:147] op_sel_hi:[1,0]
  v_cvt_pk_bf16_f32 v64, v16, v17
  v_cvt_pk_bf16_f32 v65, v18, v19
  v_cvt_pk_bf16_f32 v66, v20, v21
  v_cvt_pk_bf16_f32 v67, v22, v23
  v_cvt_pk_bf16_f32 v68, v24, v25
  v_cvt_pk_bf16_f32 v69, v26, v27
  v_cvt_pk_bf16_f32 v70, v28, v29
  v_cvt_pk_bf16_f32 v71, v30, v31
  buffer_store_dwordx4 v[64:67], v10, s[20:23], s55 offen offset:0 sc1
  buffer_store_dwordx4 v[68:71], v10, s[20:23], s55 offen offset:1024 sc1
  v_accvgpr_read_b32 v32, a16
  v_accvgpr_read_b32 v33, a17
  v_accvgpr_read_b32 v34, a18
  v_accvgpr_read_b32 v35, a19
  v_accvgpr_read_b32 v36, a24
  v_accvgpr_read_b32 v37, a25
  v_accvgpr_read_b32 v38, a26
  v_accvgpr_read_b32 v39, a27
  v_accvgpr_read_b32 v40, a20
  v_accvgpr_read_b32 v41, a21
  v_accvgpr_read_b32 v42, a22
  v_accvgpr_read_b32 v43, a23
  v_accvgpr_read_b32 v44, a28
  v_accvgpr_read_b32 v45, a29
  v_accvgpr_read_b32 v46, a30
  v_accvgpr_read_b32 v47, a31
  v_pk_mul_f32 v[32:33], v[32:33], v[144:145] op_sel_hi:[1,0]
  v_pk_mul_f32 v[34:35], v[34:35], v[144:145] op_sel_hi:[1,0]
  v_pk_mul_f32 v[36:37], v[36:37], v[144:145] op_sel_hi:[1,0]
  v_pk_mul_f32 v[38:39], v[38:39], v[144:145] op_sel_hi:[1,0]
  v_pk_mul_f32 v[40:41], v[40:41], v[146:147] op_sel_hi:[1,0]
  v_pk_mul_f32 v[42:43], v[42:43], v[146:147] op_sel_hi:[1,0]
  v_pk_mul_f32 v[44:45], v[44:45], v[146:147] op_sel_hi:[1,0]
  v_pk_mul_f32 v[46:47], v[46:47], v[146:147] op_sel_hi:[1,0]
  v_cvt_pk_bf16_f32 v72, v32, v33
  v_cvt_pk_bf16_f32 v73, v34, v35
  v_cvt_pk_bf16_f32 v74, v36, v37
  v_cvt_pk_bf16_f32 v75, v38, v39
  v_cvt_pk_bf16_f32 v76, v40, v41
  v_cvt_pk_bf16_f32 v77, v42, v43
  v_cvt_pk_bf16_f32 v78, v44, v45
  v_cvt_pk_bf16_f32 v79, v46, v47
  buffer_store_dwordx4 v[72:75], v10, s[20:23], s55 offen offset:2048 sc1
  buffer_store_dwordx4 v[76:79], v10, s[20:23], s55 offen offset:3072 sc1
  v_accvgpr_read_b32 v16, a32
  v_accvgpr_read_b32 v17, a33
  v_accvgpr_read_b32 v18, a34
  v_accvgpr_read_b32 v19, a35
  v_accvgpr_read_b32 v20, a40
  v_accvgpr_read_b32 v21, a41
  v_accvgpr_read_b32 v22, a42
  v_accvgpr_read_b32 v23, a43
  v_accvgpr_read_b32 v24, a36
  v_accvgpr_read_b32 v25, a37
  v_accvgpr_read_b32 v26, a38
  v_accvgpr_read_b32 v27, a39
  v_accvgpr_read_b32 v28, a44
  v_accvgpr_read_b32 v29, a45
  v_accvgpr_read_b32 v30, a46
  v_accvgpr_read_b32 v31, a47
  v_pk_mul_f32 v[16:17], v[16:17], v[144:145] op_sel_hi:[1,0]
  v_pk_mul_f32 v[18:19], v[18:19], v[144:145] op_sel_hi:[1,0]
  v_pk_mul_f32 v[20:21], v[20:21], v[144:145] op_sel_hi:[1,0]
  v_pk_mul_f32 v[22:23], v[22:23], v[144:145] op_sel_hi:[1,0]
  v_pk_mul_f32 v[24:25], v[24:25], v[146:147] op_sel_hi:[1,0]
  v_pk_mul_f32 v[26:27], v[26:27], v[146:147] op_sel_hi:[1,0]
  v_pk_mul_f32 v[28:29], v[28:29], v[146:147] op_sel_hi:[1,0]
  v_pk_mul_f32 v[30:31], v[30:31], v[146:147] op_sel_hi:[1,0]
  v_cvt_pk_bf16_f32 v80, v16, v17
  v_cvt_pk_bf16_f32 v81, v18, v19
  v_cvt_pk_bf16_f32 v82, v20, v21
  v_cvt_pk_bf16_f32 v83, v22, v23
  v_cvt_pk_bf16_f32 v84, v24, v25
  v_cvt_pk_bf16_f32 v85, v26, v27
  v_cvt_pk_bf16_f32 v86, v28, v29
  v_cvt_pk_bf16_f32 v87, v30, v31
  buffer_store_dwordx4 v[80:83], v10, s[20:23], s46 offen offset:0 sc1
  buffer_store_dwordx4 v[84:87], v10, s[20:23], s46 offen offset:1024 sc1
  v_accvgpr_read_b32 v32, a48
  v_accvgpr_read_b32 v33, a49
  v_accvgpr_read_b32 v34, a50
  v_accvgpr_read_b32 v35, a51
  v_accvgpr_read_b32 v36, a56
  v_accvgpr_read_b32 v37, a57
  v_accvgpr_read_b32 v38, a58
  v_accvgpr_read_b32 v39, a59
  v_accvgpr_read_b32 v40, a52
  v_accvgpr_read_b32 v41, a53
  v_accvgpr_read_b32 v42, a54
  v_accvgpr_read_b32 v43, a55
  v_accvgpr_read_b32 v44, a60
  v_accvgpr_read_b32 v45, a61
  v_accvgpr_read_b32 v46, a62
  v_accvgpr_read_b32 v47, a63
  v_pk_mul_f32 v[32:33], v[32:33], v[144:145] op_sel_hi:[1,0]
  v_pk_mul_f32 v[34:35], v[34:35], v[144:145] op_sel_hi:[1,0]
  v_pk_mul_f32 v[36:37], v[36:37], v[144:145] op_sel_hi:[1,0]
  v_pk_mul_f32 v[38:39], v[38:39], v[144:145] op_sel_hi:[1,0]
  v_pk_mul_f32 v[40:41], v[40:41], v[146:147] op_sel_hi:[1,0]
  v_pk_mul_f32 v[42:43], v[42:43], v[146:147] op_sel_hi:[1,0]
  v_pk_mul_f32 v[44:45], v[44:45], v[146:147] op_sel_hi:[1,0]
  v_pk_mul_f32 v[46:47], v[46:47], v[146:147] op_sel_hi:[1,0]
  v_cvt_pk_bf16_f32 v88, v32, v33
  v_cvt_pk_bf16_f32 v89, v34, v35
  v_cvt_pk_bf16_f32 v90, v36, v37
  v_cvt_pk_bf16_f32 v91, v38, v39
  v_cvt_pk_bf16_f32 v92, v40, v41
  v_cvt_pk_bf16_f32 v93, v42, v43
  v_cvt_pk_bf16_f32 v94, v44, v45
  v_cvt_pk_bf16_f32 v95, v46, v47
  buffer_store_dwordx4 v[88:91], v10, s[20:23], s46 offen offset:2048 sc1
  buffer_store_dwordx4 v[92:95], v10, s[20:23], s46 offen offset:3072 sc1
  s_branch L_fing
L_finf:
  v_accvgpr_read_b32 v16, a0
  v_accvgpr_read_b32 v17, a1
  v_accvgpr_read_b32 v18, a2
  v_accvgpr_read_b32 v19, a3
  v_accvgpr_read_b32 v20, a8
  v_accvgpr_read_b32 v21, a9
  v_accvgpr_read_b32 v22, a10
  v_accvgpr_read_b32 v23, a11
  v_accvgpr_read_b32 v24, a4
  v_accvgpr_read_b32 v25, a5
  v_accvgpr_read_b32 v26, a6
  v_accvgpr_read_b32 v27, a7
  v_accvgpr_read_b32 v28, a12
  v_accvgpr_read_b32 v29, a13
  v_accvgpr_read_b32 v30, a14
  v_accvgpr_read_b32 v31, a15
  v_pk_mul_f32 v[16:17], v[16:17], v[144:145] op_sel_hi:[1,0]
  v_pk_mul_f32 v[18:19], v[18:19], v[144:145] op_sel_hi:[1,0]
  v_pk_mul_f32 v[20:21], v[20:21], v[144:145] op_sel_hi:[1,0]
  v_pk_mul_f32 v[22:23], v[22:23], v[144:145] op_sel_hi:[1,0]
  v_pk_mul_f32 v[24:25], v[24:25], v[146:147] op_sel_hi:[1,0]
  v_pk_mul_f32 v[26:27], v[26:27], v[146:147] op_sel_hi:[1,0]
  v_pk_mul_f32 v[28:29], v[28:29], v[146:147] op_sel_hi:[1,0]
  v_pk_mul_f32 v[30:31], v[30:31], v[146:147] op_sel_hi:[1,0]
  v_cvt_pk_bf16_f32 v64, v16, v17
  v_cvt_pk_bf16_f32 v65, v18, v19
  v_cvt_pk_bf16_f32 v66, v20, v21
  v_cvt_pk_bf16_f32 v67, v22, v23
  v_cvt_pk_bf16_f32 v68, v24, v25
  v_cvt_pk_bf16_f32 v69, v26, v27
  v_cvt_pk_bf16_f32 v70, v28, v29
  v_cvt_pk_bf16_f32 v71, v30, v31
  buffer_store_dwordx4 v[64:67], v10, s[20:23], s55 offen offset:0
  buffer_store_dwordx4 v[68:71], v10, s[20:23], s55 offen offset:1024
  v_accvgpr_read_b32 v32, a16
  v_accvgpr_read_b32 v33, a17
  v_accvgpr_read_b32 v34, a18
  v_accvgpr_read_b32 v35, a19
  v_accvgpr_read_b32 v36, a24
  v_accvgpr_read_b32 v37, a25
  v_accvgpr_read_b32 v38, a26
  v_accvgpr_read_b32 v39, a27
  v_accvgpr_read_b32 v40, a20
  v_accvgpr_read_b32 v41, a21
  v_accvgpr_read_b32 v42, a22
  v_accvgpr_read_b32 v43, a23
  v_accvgpr_read_b32 v44, a28
  v_accvgpr_read_b32 v45, a29
  v_accvgpr_read_b32 v46, a30
  v_accvgpr_read_b32 v47, a31
  v_pk_mul_f32 v[32:33], v[32:33], v[144:145] op_sel_hi:[1,0]
  v_pk_mul_f32 v[34:35], v[34:35], v[144:145] op_sel_hi:[1,0]
  v_pk_mul_f32 v[36:37], v[36:37], v[144:145] op_sel_hi:[1,0]
  v_pk_mul_f32 v[38:39], v[38:39], v[144:145] op_sel_hi:[1,0]
  v_pk_mul_f32 v[40:41], v[40:41], v[146:147] op_sel_hi:[1,0]
  v_pk_mul_f32 v[42:43], v[42:43], v[146:147] op_sel_hi:[1,0]
  v_pk_mul_f32 v[44:45], v[44:45], v[146:147] op_sel_hi:[1,0]
  v_pk_mul_f32 v[46:47], v[46:47], v[146:147] op_sel_hi:[1,0]
  v_cvt_pk_bf16_f32 v72, v32, v33
  v_cvt_pk_bf16_f32 v73, v34, v35
  v_cvt_pk_bf16_f32 v74, v36, v37
  v_cvt_pk_bf16_f32 v75, v38, v39
  v_cvt_pk_bf16_f32 v76, v40, v41
  v_cvt_pk_bf16_f32 v77, v42, v43
  v_cvt_pk_bf16_f32 v78, v44, v45
  v_cvt_pk_bf16_f32 v79, v46, v47
  buffer_store_dwordx4 v[72:75], v10, s[20:23], s55 offen offset:2048
  buffer_store_dwordx4 v[76:79], v10, s[20:23], s55 offen offset:3072
  v_accvgpr_read_b32 v16, a32
  v_accvgpr_read_b32 v17, a33
  v_accvgpr_read_b32 v18, a34
  v_accvgpr_read_b32 v19, a35
  v_accvgpr_read_b32 v20, a40
  v_accvgpr_read_b32 v21, a41
  v_accvgpr_read_b32 v22, a42
  v_accvgpr_read_b32 v23, a43
  v_accvgpr_read_b32 v24, a36
  v_accvgpr_read_b32 v25, a37
  v_accvgpr_read_b32 v26, a38
  v_accvgpr_read_b32 v27, a39
  v_accvgpr_read_b32 v28, a44
  v_accvgpr_read_b32 v29, a45
  v_accvgpr_read_b32 v30, a46
  v_accvgpr_read_b32 v31, a47
  v_pk_mul_f32 v[16:17], v[16:17], v[144:145] op_sel_hi:[1,0]
  v_pk_mul_f32 v[18:19], v[18:19], v[144:145] op_sel_hi:[1,0]
  v_pk_mul_f32 v[20:21], v[20:21], v[144:145] op_sel_hi:[1,0]
  v_pk_mul_f32 v[22:23], v[22:23], v[144:145] op_sel_hi:[1,0]
  v_pk_mul_f32 v[24:25], v[24:25], v[146:147] op_sel_hi:[1,0]
  v_pk_mul_f32 v[26:27], v[26:27], v[146:147] op_sel_hi:[1,0]
  v_pk_mul_f32 v[28:29], v[28:29], v[146:147] op_sel_hi:[1,0]
  v_pk_mul_f32 v[30:31], v[30:31], v[146:147] op_sel_hi:[1,0]
  v_cvt_pk_bf16_f32 v80, v16, v17
  v_cvt_pk_bf16_f32 v81, v18, v19
  v_cvt_pk_bf16_f32 v82, v20, v21
  v_cvt_pk_bf16_f32 v83, v22, v23
  v_cvt_pk_bf16_f32 v84, v24, v25
  v_cvt_pk_bf16_f32 v85, v26, v27
  v_cvt_pk_bf16_f32 v86, v28, v29
  v_cvt_pk_bf16_f32 v87, v30, v31
  buffer_store_dwordx4 v[80:83], v10, s[20:23], s46 offen offset:0
  buffer_store_dwordx4 v[84:87], v10, s[20:23], s46 offen offset:1024
  v_accvgpr_read_b32 v32, a48
  v_accvgpr_read_b32 v33, a49
  v_accvgpr_read_b32 v34, a50
  v_accvgpr_read_b32 v35, a51
  v_accvgpr_read_b32 v36, a56
  v_accvgpr_read_b32 v37, a57
  v_accvgpr_read_b32 v38, a58
  v_accvgpr_read_b32 v39, a59
  v_accvgpr_read_b32 v40, a52
  v_accvgpr_read_b32 v41, a53
  v_accvgpr_read_b32 v42, a54
  v_accvgpr_read_b32 v43, a55
  v_accvgpr_read_b32 v44, a60
  v_accvgpr_read_b32 v45, a61
  v_accvgpr_read_b32 v46, a62
  v_accvgpr_read_b32 v47, a63
  v_pk_mul_f32 v[32:33], v[32:33], v[144:145] op_sel_hi:[1,0]
  v_pk_mul_f32 v[34:35], v[34:35], v[144:145] op_sel_hi:[1,0]
  v_pk_mul_f32 v[36:37], v[36:37], v[144:145] op_sel_hi:[1,0]
  v_pk_mul_f32 v[38:39], v[38:39], v[144:145] op_sel_hi:[1,0]
  v_pk_mul_f32 v[40:41], v[40:41], v[146:147] op_sel_hi:[1,0]
  v_pk_mul_f32 v[42:43], v[42:43], v[146:147] op_sel_hi:[1,0]
  v_pk_mul_f32 v[44:45], v[44:45], v[146:147] op_sel_hi:[1,0]
  v_pk_mul_f32 v[46:47], v[46:47], v[146:147] op_sel_hi:[1,0]
  v_cvt_pk_bf16_f32 v88, v32, v33
  v_cvt_pk_bf16_f32 v89, v34, v35
  v_cvt_pk_bf16_f32 v90, v36, v37
  v_cvt_pk_bf16_f32 v91, v38, v39
  v_cvt_pk_bf16_f32 v92, v40, v41
  v_cvt_pk_bf16_f32 v93, v42, v43
  v_cvt_pk_bf16_f32 v94, v44, v45
  v_cvt_pk_bf16_f32 v95, v46, v47
  buffer_store_dwordx4 v[88:91], v10, s[20:23], s46 offen offset:2048
  buffer_store_dwordx4 v[92:95], v10, s[20:23], s46 offen offset:3072
L_fing:
  s_mov_b32 s56, 0
  s_mov_b32 s59, 0
  s_mov_b32 s67, 0
  s_mov_b32 s64, 0
  v_add_u32 v9, s50, v8
  v_add_u32 v250, s50, v251
  ds_read_b64_tr_b16 v[176:177], v9 offset:0
  ds_read_b64_tr_b16 v[178:179], v9 offset:5120
  ds_read_b64_tr_b16 v[180:181], v250 offset:0
  ds_read_b64_tr_b16 v[182:183], v250 offset:5120
  ds_read_b64_tr_b16 v[184:185], v9 offset:64
  ds_read_b64_tr_b16 v[186:187], v9 offset:5184
  ds_read_b64_tr_b16 v[188:189], v250 offset:64
  ds_read_b64_tr_b16 v[190:191], v250 offset:5184
  ds_read_b64_tr_b16 v[192:193], v9 offset:128
  ds_read_b64_tr_b16 v[194:195], v9 offset:5248
  ds_read_b64_tr_b16 v[196:197], v250 offset:128
  ds_read_b64_tr_b16 v[198:199], v250 offset:5248
  ds_read_b64_tr_b16 v[200:201], v9 offset:192
  ds_read_b64_tr_b16 v[202:203], v9 offset:5312
  s_waitcnt lgkmcnt(12)
  v_mfma_f32_16x16x32_bf16 a[128:131], v[176:179], v[64:67], a[128:131]
  ds_read_b64_tr_b16 v[204:205], v250 offset:192
  v_mfma_f32_16x16x32_bf16 a[132:135], v[176:179], v[68:71], a[132:135]
  ds_read_b64_tr_b16 v[206:207], v250 offset:5312
  s_waitcnt lgkmcnt(12)
  v_mfma_f32_16x16x32_bf16 a[136:139], v[180:183], v[64:67], a[136:139]
  ds_read_b64_tr_b16 v[208:209], v9 offset:256
  v_mfma_f32_16x16x32_bf16 a[140:143], v[180:183], v[68:71], a[140:143]
  ds_read_b64_tr_b16 v[210:211], v9 offset:5376
  s_waitcnt lgkmcnt(12)
  v_mfma_f32_16x16x32_bf16 a[144:147], v[184:187], v[64:67], a[144:147]
  ds_read_b64_tr_b16 v[212:213], v250 offset:256
  v_mfma_f32_16x16x32_bf16 a[148:151], v[184:187], v[68:71], a[148:151]
  ds_read_b64_tr_b16 v[214:215], v250 offset:5376
  s_waitcnt lgkmcnt(12)
  v_mfma_f32_16x16x32_bf16 a[152:155], v[188:191], v[64:67], a[152:155]
  ds_read_b64_tr_b16 v[216:217], v9 offset:10240
  v_mfma_f32_16x16x32_bf16 a[156:159], v[188:191], v[68:71], a[156:159]
  ds_read_b64_tr_b16 v[218:219], v9 offset:15360
  s_waitcnt lgkmcnt(12)
  v_mfma_f32_16x16x32_bf16 a[160:163], v[192:195], v[64:67], a[160:163]
  ds_read_b64_tr_b16 v[220:221], v250 offset:10240
  v_mfma_f32_16x16x32_bf16 a[164:167], v[192:195], v[68:71], a[164:167]
  ds_read_b64_tr_b16 v[222:223], v250 offset:15360
  s_waitcnt lgkmcnt(12)
  v_mfma_f32_16x16x32_bf16 a[168:171], v[196:199], v[64:67], a[168:171]
  ds_read_b64_tr_b16 v[224:225], v9 offset:10304
  v_mfma_f32_16x16x32_bf16 a[172:175], v[196:199], v[68:71], a[172:175]
  ds_read_b64_tr_b16 v[226:227], v9 offset:15424
  s_waitcnt vmcnt(0)
  s_mov_b64 exec, 1
  v_mov_b32 v158, 0
  s_cmp_eq_u32 s60, 7
  s_cbranch_scc1 Lpa_39
  buffer_store_dwordx2 v[12:13], v158, s[20:23], s57 offen offset:128 sc1
  s_branch Lpb_40
Lpa_39:
  buffer_store_dwordx2 v[12:13], v158, s[20:23], s57 offen offset:128
Lpb_40:
  s_mov_b64 exec, -1
  s_waitcnt lgkmcnt(12)
  v_mfma_f32_16x16x32_bf16 a[176:179], v[200:203], v[64:67], a[176:179]
  ds_read_b64_tr_b16 v[228:229], v250 offset:10304
  v_mfma_f32_16x16x32_bf16 a[180:183], v[200:203], v[68:71], a[180:183]
  ds_read_b64_tr_b16 v[230:231], v250 offset:15424
  s_waitcnt lgkmcnt(12)
  v_mfma_f32_16x16x32_bf16 a[184:187], v[204:207], v[64:67], a[184:187]
  ds_read_b64_tr_b16 v[232:233], v9 offset:10368
  v_mfma_f32_16x16x32_bf16 a[188:191], v[204:207], v[68:71], a[188:191]
  ds_read_b64_tr_b16 v[234:235], v9 offset:15488
  s_waitcnt lgkmcnt(12)
  v_mfma_f32_16x16x32_bf16 a[192:195], v[208:211], v[64:67], a[192:195]
  ds_read_b64_tr_b16 v[236:237], v250 offset:10368
  v_mfma_f32_16x16x32_bf16 a[196:199], v[208:211], v[68:71], a[196:199]
  ds_read_b64_tr_b16 v[238:239], v250 offset:15488
  s_waitcnt lgkmcnt(12)
  v_mfma_f32_16x16x32_bf16 a[200:203], v[212:215], v[64:67], a[200:203]
  ds_read_b64_tr_b16 v[176:177], v9 offset:10432
  v_mfma_f32_16x16x32_bf16 a[204:207], v[212:215], v[68:71], a[204:207]
  ds_read_b64_tr_b16 v[178:179], v9 offset:15552
  s_waitcnt lgkmcnt(12)
  v_mfma_f32_16x16x32_bf16 a[128:131], v[216:219], v[72:75], a[128:131]
  ds_read_b64_tr_b16 v[180:181], v250 offset:10432
  v_mfma_f32_16x16x32_bf16 a[132:135], v[216:219], v[76:79], a[132:135]
  ds_read_b64_tr_b16 v[182:183], v250 offset:15552
  s_waitcnt lgkmcnt(12)
  v_mfma_f32_16x16x32_bf16 a[136:139], v[220:223], v[72:75], a[136:139]
  ds_read_b64_tr_b16 v[184:185], v9 offset:10496
  v_mfma_f32_16x16x32_bf16 a[140:143], v[220:223], v[76:79], a[140:143]
  ds_read_b64_tr_b16 v[186:187], v9 offset:15616
  s_waitcnt lgkmcnt(12)
  v_mfma_f32_16x16x32_bf16 a[144:147], v[224:227], v[72:75], a[144:147]
  ds_read_b64_tr_b16 v[188:189], v250 offset:10496
  v_mfma_f32_16x16x32_bf16 a[148:151], v[224:227], v[76:79], a[148:151]
  ds_read_b64_tr_b16 v[190:191], v250 offset:15616
  s_waitcnt lgkmcnt(12)
  v_mfma_f32_16x16x32_bf16 a[152:155], v[228:231], v[72:75], a[152:155]
  ds_read_b64_tr_b16 v[192:193], v9 offset:20480
  v_mfma_f32_16x16x32_bf16 a[156:159], v[228:231], v[76:79], a[156:159]
  ds_read_b64_tr_b16 v[194:195], v9 offset:25600
  s_waitcnt lgkmcnt(12)
  v_mfma_f32_16x16x32_bf16 a[160:163], v[232:235], v[72:75], a[160:163]
  ds_read_b64_tr_b16 v[196:197], v250 offset:20480
  v_mfma_f32_16x16x32_bf16 a[164:167], v[232:235], v[76:79], a[164:167]
  ds_read_b64_tr_b16 v[198:199], v250 offset:25600
  s_waitcnt lgkmcnt(12)
  v_mfma_f32_16x16x32_bf16 a[168:171], v[236:239], v[72:75], a[168:171]
  ds_read_b64_tr_b16 v[200:201], v9 offset:20544
  v_mfma_f32_16x16x32_bf16 a[172:175], v[236:239], v[76:79], a[172:175]
  ds_read_b64_tr_b16 v[202:203], v9 offset:25664
  s_waitcnt lgkmcnt(12)
  v_mfma_f32_16x16x32_bf16 a[176:179], v[176:179], v[72:75], a[176:179]
  ds_read_b64_tr_b16 v[204:205], v250 offset:20544
  v_mfma_f32_16x16x32_bf16 a[180:183], v[176:179], v[76:79], a[180:183]
  ds_read_b64_tr_b16 v[206:207], v250 offset:25664
  s_waitcnt lgkmcnt(12)
  v_mfma_f32_16x16x32_bf16 a[184:187], v[180:183], v[72:75], a[184:187]
  ds_read_b64_tr_b16 v[208:209], v9 offset:20608
  v_mfma_f32_16x16x32_bf16 a[188:191], v[180:183], v[76:79], a[188:191]
  ds_read_b64_tr_b16 v[210:211], v9 offset:25728
  s_waitcnt lgkmcnt(12)
  v_mfma_f32_16x16x32_bf16 a[192:195], v[184:187], v[72:75], a[192:195]
  ds_read_b64_tr_b16 v[212:213], v250 offset:20608
  v_mfma_f32_16x16x32_bf16 a[196:199], v[184:187], v[76:79], a[196:199]
  ds_read_b64_tr_b16 v[214:215], v250 offset:25728
  s_waitcnt lgkmcnt(12)
  v_mfma_f32_16x16x32_bf16 a[200:203], v[188:191], v[72:75], a[200:203]
  ds_read_b64_tr_b16 v[216:217], v9 offset:20672
  v_mfma_f32_16x16x32_bf16 a[204:207], v[188:191], v[76:79], a[204:207]
  ds_read_b64_tr_b16 v[218:219], v9 offset:25792
  s_waitcnt lgkmcnt(12)
  v_mfma_f32_16x16x32_bf16 a[128:131], v[192:195], v[80:83], a[128:131]
  ds_read_b64_tr_b16 v[220:221], v250 offset:20672
  v_mfma_f32_16x16x32_bf16 a[132:135], v[192:195], v[84:87], a[132:135]
  ds_read_b64_tr_b16 v[222:223], v250 offset:25792
  s_waitcnt lgkmcnt(12)
  v_mfma_f32_16x16x32_bf16 a[136:139], v[196:199], v[80:83], a[136:139]
  ds_read_b64_tr_b16 v[224:225], v9 offset:20736
  v_mfma_f32_16x16x32_bf16 a[140:143], v[196:199], v[84:87], a[140:143]
  ds_read_b64_tr_b16 v[226:227], v9 offset:25856
  s_waitcnt lgkmcnt(12)
  v_mfma_f32_16x16x32_bf16 a[144:147], v[200:203], v[80:83], a[144:147]
  ds_read_b64_tr_b16 v[228:229], v250 offset:20736
  v_mfma_f32_16x16x32_bf16 a[148:151], v[200:203], v[84:87], a[148:151]
  ds_read_b64_tr_b16 v[230:231], v250 offset:25856
  s_waitcnt lgkmcnt(12)
  v_mfma_f32_16x16x32_bf16 a[152:155], v[204:207], v[80:83], a[152:155]
  ds_read_b64_tr_b16 v[232:233], v9 offset:30720
  v_mfma_f32_16x16x32_bf16 a[156:159], v[204:207], v[84:87], a[156:159]
  ds_read_b64_tr_b16 v[234:235], v9 offset:35840
  s_waitcnt lgkmcnt(12)
  v_mfma_f32_16x16x32_bf16 a[160:163], v[208:211], v[80:83], a[160:163]
  ds_read_b64_tr_b16 v[236:237], v250 offset:30720
  v_mfma_f32_16x16x32_bf16 a[164:167], v[208:211], v[84:87], a[164:167]
  ds_read_b64_tr_b16 v[238:239], v250 offset:35840
  s_waitcnt lgkmcnt(12)
  v_mfma_f32_16x16x32_bf16 a[168:171], v[212:215], v[80:83], a[168:171]
  ds_read_b64_tr_b16 v[176:177], v9 offset:30784
  v_mfma_f32_16x16x32_bf16 a[172:175], v[212:215], v[84:87], a[172:175]
  ds_read_b64_tr_b16 v[178:179], v9 offset:35904
  s_waitcnt lgkmcnt(12)
  v_mfma_f32_16x16x32_bf16 a[176:179], v[216:219], v[80:83], a[176:179]
  ds_read_b64_tr_b16 v[180:181], v250 offset:30784
  v_mfma_f32_16x16x32_bf16 a[180:183], v[216:219], v[84:87], a[180:183]
  ds_read_b64_tr_b16 v[182:183], v250 offset:35904
  s_waitcnt lgkmcnt(12)
  v_mfma_f32_16x16x32_bf16 a[184:187], v[220:223], v[80:83], a[184:187]
  ds_read_b64_tr_b16 v[184:185], v9 offset:30848
  v_mfma_f32_16x16x32_bf16 a[188:191], v[220:223], v[84:87], a[188:191]
  ds_read_b64_tr_b16 v[186:187], v9 offset:35968
  s_mov_b32 s46, 25165952
  buffer_load_dwordx2 v[14:15], v7, s[20:23], s46 offen sc1
  s_waitcnt lgkmcnt(12)
  v_mfma_f32_16x16x32_bf16 a[192:195], v[224:227], v[80:83], a[192:195]
  ds_read_b64_tr_b16 v[188:189], v250 offset:30848
  v_mfma_f32_16x16x32_bf16 a[196:199], v[224:227], v[84:87], a[196:199]
  ds_read_b64_tr_b16 v[190:191], v250 offset:35968
  s_waitcnt lgkmcnt(12)
  v_mfma_f32_16x16x32_bf16 a[200:203], v[228:231], v[80:83], a[200:203]
  ds_read_b64_tr_b16 v[192:193], v9 offset:30912
  v_mfma_f32_16x16x32_bf16 a[204:207], v[228:231], v[84:87], a[204:207]
  ds_read_b64_tr_b16 v[194:195], v9 offset:36032
  s_waitcnt lgkmcnt(12)
  v_mfma_f32_16x16x32_bf16 a[128:131], v[232:235], v[88:91], a[128:131]
  ds_read_b64_tr_b16 v[196:197], v250 offset:30912
  v_mfma_f32_16x16x32_bf16 a[132:135], v[232:235], v[92:95], a[132:135]
  ds_read_b64_tr_b16 v[198:199], v250 offset:36032
  s_waitcnt lgkmcnt(12)
  v_mfma_f32_16x16x32_bf16 a[136:139], v[236:239], v[88:91], a[136:139]
  ds_read_b64_tr_b16 v[200:201], v9 offset:30976
  v_mfma_f32_16x16x32_bf16 a[140:143], v[236:239], v[92:95], a[140:143]
  ds_read_b64_tr_b16 v[202:203], v9 offset:36096
  s_waitcnt lgkmcnt(12)
  v_mfma_f32_16x16x32_bf16 a[144:147], v[176:179], v[88:91], a[144:147]
  ds_read_b64_tr_b16 v[204:205], v250 offset:30976
  v_mfma_f32_16x16x32_bf16 a[148:151], v[176:179], v[92:95], a[148:151]
  ds_read_b64_tr_b16 v[206:207], v250 offset:36096
  s_waitcnt lgkmcnt(12)
  v_mfma_f32_16x16x32_bf16 a[152:155], v[180:183], v[88:91], a[152:155]
  v_mfma_f32_16x16x32_bf16 a[156:159], v[180:183], v[92:95], a[156:159]
  s_waitcnt lgkmcnt(10)
  v_mfma_f32_16x16x32_bf16 a[160:163], v[184:187], v[88:91], a[160:163]
  v_mfma_f32_16x16x32_bf16 a[164:167], v[184:187], v[92:95], a[164:167]
  s_waitcnt lgkmcnt(0)
  s_barrier
  s_barrier
  s_barrier
  s_add_u32 s50, s50, 40960
  s_cmp_eq_u32 s50, 163840
  s_cselect_b32 s50, 0, s50
  v_mfma_f32_16x16x32_bf16 a[168:171], v[188:191], v[88:91], a[168:171]
  v_mfma_f32_16x16x32_bf16 a[172:175], v[188:191], v[92:95], a[172:175]
  v_mfma_f32_16x16x32_bf16 a[176:179], v[192:195], v[88:91], a[176:179]
  v_mfma_f32_16x16x32_bf16 a[180:183], v[192:195], v[92:95], a[180:183]
  v_mfma_f32_16x16x32_bf16 a[184:187], v[196:199], v[88:91], a[184:187]
  v_mfma_f32_16x16x32_bf16 a[188:191], v[196:199], v[92:95], a[188:191]
  v_mfma_f32_16x16x32_bf16 a[192:195], v[200:203], v[88:91], a[192:195]
  v_mfma_f32_16x16x32_bf16 a[196:199], v[200:203], v[92:95], a[196:199]
  v_mfma_f32_16x16x32_bf16 a[200:203], v[204:207], v[88:91], a[200:203]
  v_mfma_f32_16x16x32_bf16 a[204:207], v[204:207], v[92:95], a[204:207]
  s_waitcnt vmcnt(0)
  v_cmp_eq_u64 vcc, v[14:15], v[12:13]
  s_nop 1
  s_and_b32 s64, vcc_lo, 7
  s_cmp_eq_u32 s67, 0
  s_cbranch_scc0 Lfl_41
  s_andn2_b32 s48, s64, s56
  s_cbranch_scc0 Lfl_41
  s_ff1_i32_b32 s51, s48
  s_bitset1_b32 s56, s51
  s_add_u32 s66, s51, 1
  s_add_u32 s67, s67, 1
  s_add_u32 s46, s40, s66
  s_and_b32 s46, s46, 3
  s_lshl_b32 s46, s46, 3
  s_add_u32 s46, s46, s58
  s_mul_i32 s46, s46, 49152
  s_lshl_b32 s47, s3, 13
  s_add_u32 s46, s46, s47
  s_add_u32 s46, s46, 24576
  s_add_u32 s47, s46, 4096
  buffer_load_dwordx4 a[0:3], v10, s[20:23], s46 offen offset:0 sc1
  buffer_load_dwordx4 a[4:7], v10, s[20:23], s46 offen offset:1024 sc1
  buffer_load_dwordx4 a[8:11], v10, s[20:23], s46 offen offset:2048 sc1
  buffer_load_dwordx4 a[12:15], v10, s[20:23], s46 offen offset:3072 sc1
  buffer_load_dwordx4 a[16:19], v10, s[20:23], s47 offen offset:0 sc1
  buffer_load_dwordx4 a[20:23], v10, s[20:23], s47 offen offset:1024 sc1
  buffer_load_dwordx4 a[24:27], v10, s[20:23], s47 offen offset:2048 sc1
  buffer_load_dwordx4 a[28:31], v10, s[20:23], s47 offen offset:3072 sc1
Lfl_41:
  s_cmp_eq_u32 s67, 1
  s_cbranch_scc0 Lfl_42
  s_andn2_b32 s48, s64, s56
  s_cbranch_scc0 Lfl_42
  s_ff1_i32_b32 s52, s48
  s_bitset1_b32 s56, s52
  s_add_u32 s66, s52, 1
  s_add_u32 s67, s67, 1
  s_add_u32 s46, s40, s66
  s_and_b32 s46, s46, 3
  s_lshl_b32 s46, s46, 3
  s_add_u32 s46, s46, s58
  s_mul_i32 s46, s46, 49152
  s_lshl_b32 s47, s3, 13
  s_add_u32 s46, s46, s47
  s_add_u32 s46, s46, 24576
  s_add_u32 s47, s46, 4096
  buffer_load_dwordx4 a[32:35], v10, s[20:23], s46 offen offset:0 sc1
  buffer_load_dwordx4 a[36:39], v10, s[20:23], s46 offen offset:1024 sc1
  buffer_load_dwordx4 a[40:43], v10, s[20:23], s46 offen offset:2048 sc1
  buffer_load_dwordx4 a[44:47], v10, s[20:23], s46 offen offset:3072 sc1
  buffer_load_dwordx4 a[48:51], v10, s[20:23], s47 offen offset:0 sc1
  buffer_load_dwordx4 a[52:55], v10, s[20:23], s47 offen offset:1024 sc1
  buffer_load_dwordx4 a[56:59], v10, s[20:23], s47 offen offset:2048 sc1
  buffer_load_dwordx4 a[60:63], v10, s[20:23], s47 offen offset:3072 sc1
Lfl_42:
  s_cmp_eq_u32 s67, 2
  s_cbranch_scc0 Lfl_43
  s_andn2_b32 s48, s64, s56
  s_cbranch_scc0 Lfl_43
  s_ff1_i32_b32 s53, s48
  s_bitset1_b32 s56, s53
  s_add_u32 s66, s53, 1
  s_add_u32 s67, s67, 1
  s_add_u32 s46, s40, s66
  s_and_b32 s46, s46, 3
  s_lshl_b32 s46, s46, 3
  s_add_u32 s46, s46, s58
  s_mul_i32 s46, s46, 49152
  s_lshl_b32 s47, s3, 13
  s_add_u32 s46, s46, s47
  s_add_u32 s46, s46, 24576
  s_add_u32 s47, s46, 4096
  buffer_load_dwordx4 v[96:99], v10, s[20:23], s46 offen offset:0 sc1
  buffer_load_dwordx4 v[100:103], v10, s[20:23], s46 offen offset:1024 sc1
  buffer_load_dwordx4 v[104:107], v10, s[20:23], s46 offen offset:2048 sc1
  buffer_load_dwordx4 v[108:111], v10, s[20:23], s46 offen offset:3072 sc1
  buffer_load_dwordx4 v[112:115], v10, s[20:23], s47 offen offset:0 sc1
  buffer_load_dwordx4 v[116:119], v10, s[20:23], s47 offen offset:1024 sc1
  buffer_load_dwordx4 v[120:123], v10, s[20:23], s47 offen offset:2048 sc1
  buffer_load_dwordx4 v[124:127], v10, s[20:23], s47 offen offset:3072 sc1
Lfl_43:
  s_cmp_gt_u32 s67, 0
  s_cbranch_scc0 Lna_44
Lnb_45:
  s_mul_i32 s46, s51, 40960
  s_add_u32 s46, s46, s50
  s_cmp_ge_u32 s46, 163840
  s_cselect_b32 s47, 163840, 0
  s_sub_u32 s46, s46, s47
  v_add_u32 v9, s46, v8
  v_add_u32 v250, s46, v251
  s_mov_b32 s49, s67
  ds_read_b64_tr_b16 v[176:177], v9 offset:0
  ds_read_b64_tr_b16 v[178:179], v9 offset:5120
  ds_read_b64_tr_b16 v[180:181], v250 offset:0
  ds_read_b64_tr_b16 v[182:183], v250 offset:5120
  ds_read_b64_tr_b16 v[184:185], v9 offset:64
  ds_read_b64_tr_b16 v[186:187], v9 offset:5184
  ds_read_b64_tr_b16 v[188:189], v250 offset:64
  ds_read_b64_tr_b16 v[190:191], v250 offset:5184
  ds_read_b64_tr_b16 v[192:193], v9 offset:128
  ds_read_b64_tr_b16 v[194:195], v9 offset:5248
  ds_read_b64_tr_b16 v[196:197], v250 offset:128
  ds_read_b64_tr_b16 v[198:199], v250 offset:5248
  ds_read_b64_tr_b16 v[200:201], v9 offset:192
  ds_read_b64_tr_b16 v[202:203], v9 offset:5312
  s_cmp_eq_u32 s49, 3
  s_cbranch_scc0 Laa_53
  s_waitcnt vmcnt(16)
Lab_54:
  s_waitcnt lgkmcnt(12)
  v_mfma_f32_16x16x32_bf16 a[128:131], v[176:179], a[0:3], a[128:131]
  ds_read_b64_tr_b16 v[204:205], v250 offset:192
  v_mfma_f32_16x16x32_bf16 a[132:135], v[176:179], a[4:7], a[132:135]
  ds_read_b64_tr_b16 v[206:207], v250 offset:5312
  s_waitcnt lgkmcnt(12)
  v_mfma_f32_16x16x32_bf16 a[136:139], v[180:183], a[0:3], a[136:139]
  ds_read_b64_tr_b16 v[208:209], v9 offset:256
  v_mfma_f32_16x16x32_bf16 a[140:143], v[180:183], a[4:7], a[140:143]
  ds_read_b64_tr_b16 v[210:211], v9 offset:5376
  s_waitcnt lgkmcnt(12)
  v_mfma_f32_16x16x32_bf16 a[144:147], v[184:187], a[0:3], a[144:147]
  ds_read_b64_tr_b16 v[212:213], v250 offset:256
  v_mfma_f32_16x16x32_bf16 a[148:151], v[184:187], a[4:7], a[148:151]
  ds_read_b64_tr_b16 v[214:215], v250 offset:5376
  s_waitcnt lgkmcnt(12)
  v_mfma_f32_16x16x32_bf16 a[152:155], v[188:191], a[0:3], a[152:155]
  ds_read_b64_tr_b16 v[216:217], v9 offset:10240
  v_mfma_f32_16x16x32_bf16 a[156:159], v[188:191], a[4:7], a[156:159]
  ds_read_b64_tr_b16 v[218:219], v9 offset:15360
  s_waitcnt lgkmcnt(12)
  v_mfma_f32_16x16x32_bf16 a[160:163], v[192:195], a[0:3], a[160:163]
  ds_read_b64_tr_b16 v[220:221], v250 offset:10240
  v_mfma_f32_16x16x32_bf16 a[164:167], v[192:195], a[4:7], a[164:167]
  ds_read_b64_tr_b16 v[222:223], v250 offset:15360
  s_cmp_eq_u32 s67, 3
  s_cbranch_scc1 Lag_55
  s_mov_b32 s46, 25165952
  buffer_load_dwordx2 v[14:15], v7, s[20:23], s46 offen sc1
Lag_55:
  s_waitcnt lgkmcnt(12)
  v_mfma_f32_16x16x32_bf16 a[168:171], v[196:199], a[0:3], a[168:171]
  ds_read_b64_tr_b16 v[224:225], v9 offset:10304
  v_mfma_f32_16x16x32_bf16 a[172:175], v[196:199], a[4:7], a[172:175]
  ds_read_b64_tr_b16 v[226:227], v9 offset:15424
  s_waitcnt lgkmcnt(12)
  v_mfma_f32_16x16x32_bf16 a[176:179], v[200:203], a[0:3], a[176:179]
  ds_read_b64_tr_b16 v[228:229], v250 offset:10304
  v_mfma_f32_16x16x32_bf16 a[180:183], v[200:203], a[4:7], a[180:183]
  ds_read_b64_tr_b16 v[230:231], v250 offset:15424
  s_waitcnt lgkmcnt(12)
  v_mfma_f32_16x16x32_bf16 a[184:187], v[204:207], a[0:3], a[184:187]
  ds_read_b64_tr_b16 v[232:233], v9 offset:10368
  v_mfma_f32_16x16x32_bf16 a[188:191], v[204:207], a[4:7], a[188:191]
  ds_read_b64_tr_b16 v[234:235], v9 offset:15488
  s_waitcnt lgkmcnt(12)
  v_mfma_f32_16x16x32_bf16 a[192:195], v[208:211], a[0:3], a[192:195]
  ds_read_b64_tr_b16 v[236:237], v250 offset:10368
  v_mfma_f32_16x16x32_bf16 a[196:199], v[208:211], a[4:7], a[196:199]
  ds_read_b64_tr_b16 v[238:239], v250 offset:15488
  s_waitcnt lgkmcnt(12)
  v_mfma_f32_16x16x32_bf16 a[200:203], v[212:215], a[0:3], a[200:203]
  ds_read_b64_tr_b16 v[176:177], v9 offset:10432
  v_mfma_f32_16x16x32_bf16 a[204:207], v[212:215], a[4:7], a[204:207]
  ds_read_b64_tr_b16 v[178:179], v9 offset:15552
  s_waitcnt lgkmcnt(12)
  v_mfma_f32_16x16x32_bf16 a[128:131], v[216:219], a[8:11], a[128:131]
  ds_read_b64_tr_b16 v[180:181], v250 offset:10432
  v_mfma_f32_16x16x32_bf16 a[132:135], v[216:219], a[12:15], a[132:135]
  ds_read_b64_tr_b16 v[182:183], v250 offset:15552
  s_waitcnt lgkmcnt(12)
  v_mfma_f32_16x16x32_bf16 a[136:139], v[220:223], a[8:11], a[136:139]
  ds_read_b64_tr_b16 v[184:185], v9 offset:10496
  v_mfma_f32_16x16x32_bf16 a[140:143], v[220:223], a[12:15], a[140:143]
  ds_read_b64_tr_b16 v[186:187], v9 offset:15616
  s_waitcnt lgkmcnt(12)
  v_mfma_f32_16x16x32_bf16 a[144:147], v[224:227], a[8:11], a[144:147]
  ds_read_b64_tr_b16 v[188:189], v250 offset:10496
  v_mfma_f32_16x16x32_bf16 a[148:151], v[224:227], a[12:15], a[148:151]
  ds_read_b64_tr_b16 v[190:191], v250 offset:15616
  s_waitcnt lgkmcnt(12)
  v_mfma_f32_16x16x32_bf16 a[152:155], v[228:231], a[8:11], a[152:155]
  ds_read_b64_tr_b16 v[192:193], v9 offset:20480
  v_mfma_f32_16x16x32_bf16 a[156:159], v[228:231], a[12:15], a[156:159]
  ds_read_b64_tr_b16 v[194:195], v9 offset:25600
  s_waitcnt lgkmcnt(12)
  v_mfma_f32_16x16x32_bf16 a[160:163], v[232:235], a[8:11], a[160:163]
  ds_read_b64_tr_b16 v[196:197], v250 offset:20480
  v_mfma_f32_16x16x32_bf16 a[164:167], v[232:235], a[12:15], a[164:167]
  ds_read_b64_tr_b16 v[198:199], v250 offset:25600
  s_waitcnt lgkmcnt(12)
  v_mfma_f32_16x16x32_bf16 a[168:171], v[236:239], a[8:11], a[168:171]
  ds_read_b64_tr_b16 v[200:201], v9 offset:20544
  v_mfma_f32_16x16x32_bf16 a[172:175], v[236:239], a[12:15], a[172:175]
  ds_read_b64_tr_b16 v[202:203], v9 offset:25664
  s_waitcnt lgkmcnt(12)
  v_mfma_f32_16x16x32_bf16 a[176:179], v[176:179], a[8:11], a[176:179]
  ds_read_b64_tr_b16 v[204:205], v250 offset:20544
  v_mfma_f32_16x16x32_bf16 a[180:183], v[176:179], a[12:15], a[180:183]
  ds_read_b64_tr_b16 v[206:207], v250 offset:25664
  s_waitcnt lgkmcnt(12)
  v_mfma_f32_16x16x32_bf16 a[184:187], v[180:183], a[8:11], a[184:187]
  ds_read_b64_tr_b16 v[208:209], v9 offset:20608
  v_mfma_f32_16x16x32_bf16 a[188:191], v[180:183], a[12:15], a[188:191]
  ds_read_b64_tr_b16 v[210:211], v9 offset:25728
  s_waitcnt lgkmcnt(12)
  v_mfma_f32_16x16x32_bf16 a[192:195], v[184:187], a[8:11], a[192:195]
  ds_read_b64_tr_b16 v[212:213], v250 offset:20608
  v_mfma_f32_16x16x32_bf16 a[196:199], v[184:187], a[12:15], a[196:199]
  ds_read_b64_tr_b16 v[214:215], v250 offset:25728
  s_waitcnt lgkmcnt(12)
  v_mfma_f32_16x16x32_bf16 a[200:203], v[188:191], a[8:11], a[200:203]
  ds_read_b64_tr_b16 v[216:217], v9 offset:20672
  v_mfma_f32_16x16x32_bf16 a[204:207], v[188:191], a[12:15], a[204:207]
  ds_read_b64_tr_b16 v[218:219], v9 offset:25792
  s_waitcnt lgkmcnt(12)
  v_mfma_f32_16x16x32_bf16 a[128:131], v[192:195], a[16:19], a[128:131]
  ds_read_b64_tr_b16 v[220:221], v250 offset:20672
  v_mfma_f32_16x16x32_bf16 a[132:135], v[192:195], a[20:23], a[132:135]
  ds_read_b64_tr_b16 v[222:223], v250 offset:25792
  s_waitcnt lgkmcnt(12)
  v_mfma_f32_16x16x32_bf16 a[136:139], v[196:199], a[16:19], a[136:139]
  ds_read_b64_tr_b16 v[224:225], v9 offset:20736
  v_mfma_f32_16x16x32_bf16 a[140:143], v[196:199], a[20:23], a[140:143]
  ds_read_b64_tr_b16 v[226:227], v9 offset:25856
  s_waitcnt lgkmcnt(12)
  v_mfma_f32_16x16x32_bf16 a[144:147], v[200:203], a[16:19], a[144:147]
  ds_read_b64_tr_b16 v[228:229], v250 offset:20736
  v_mfma_f32_16x16x32_bf16 a[148:151], v[200:203], a[20:23], a[148:151]
  ds_read_b64_tr_b16 v[230:231], v250 offset:25856
  s_waitcnt lgkmcnt(12)
  v_mfma_f32_16x16x32_bf16 a[152:155], v[204:207], a[16:19], a[152:155]
  ds_read_b64_tr_b16 v[232:233], v9 offset:30720
  v_mfma_f32_16x16x32_bf16 a[156:159], v[204:207], a[20:23], a[156:159]
  ds_read_b64_tr_b16 v[234:235], v9 offset:35840
  s_waitcnt lgkmcnt(12)
  v_mfma_f32_16x16x32_bf16 a[160:163], v[208:211], a[16:19], a[160:163]
  ds_read_b64_tr_b16 v[236:237], v250 offset:30720
  v_mfma_f32_16x16x32_bf16 a[164:167], v[208:211], a[20:23], a[164:167]
  ds_read_b64_tr_b16 v[238:239], v250 offset:35840
  s_waitcnt lgkmcnt(12)
  v_mfma_f32_16x16x32_bf16 a[168:171], v[212:215], a[16:19], a[168:171]
  ds_read_b64_tr_b16 v[176:177], v9 offset:30784
  v_mfma_f32_16x16x32_bf16 a[172:175], v[212:215], a[20:23], a[172:175]
  ds_read_b64_tr_b16 v[178:179], v9 offset:35904
  s_waitcnt lgkmcnt(12)
  v_mfma_f32_16x16x32_bf16 a[176:179], v[216:219], a[16:19], a[176:179]
  ds_read_b64_tr_b16 v[180:181], v250 offset:30784
  v_mfma_f32_16x16x32_bf16 a[180:183], v[216:219], a[20:23], a[180:183]
  ds_read_b64_tr_b16 v[182:183], v250 offset:35904
  s_waitcnt lgkmcnt(12)
  v_mfma_f32_16x16x32_bf16 a[184:187], v[220:223], a[16:19], a[184:187]
  ds_read_b64_tr_b16 v[184:185], v9 offset:30848
  v_mfma_f32_16x16x32_bf16 a[188:191], v[220:223], a[20:23], a[188:191]
  ds_read_b64_tr_b16 v[186:187], v9 offset:35968
  s_cmp_eq_u32 s67, 3
  s_cbranch_scc1 Lag_56
  s_waitcnt vmcnt(0)
  v_cmp_eq_u64 vcc, v[14:15], v[12:13]
  s_nop 1
  s_and_b32 s64, vcc_lo, 7
  s_cmp_eq_u32 s67, 1
  s_cbranch_scc0 Lfl_57
  s_andn2_b32 s48, s64, s56
  s_cbranch_scc0 Lfl_57
  s_ff1_i32_b32 s52, s48
  s_bitset1_b32 s56, s52
  s_add_u32 s66, s52, 1
  s_add_u32 s67, s67, 1
  s_add_u32 s46, s40, s66
  s_and_b32 s46, s46, 3
  s_lshl_b32 s46, s46, 3
  s_add_u32 s46, s46, s58
  s_mul_i32 s46, s46, 49152
  s_lshl_b32 s47, s3, 13
  s_add_u32 s46, s46, s47
  s_add_u32 s46, s46, 24576
  s_add_u32 s47, s46, 4096
  buffer_load_dwordx4 a[32:35], v10, s[20:23], s46 offen offset:0 sc1
  buffer_load_dwordx4 a[36:39], v10, s[20:23], s46 offen offset:1024 sc1
  buffer_load_dwordx4 a[40:43], v10, s[20:23], s46 offen offset:2048 sc1
  buffer_load_dwordx4 a[44:47], v10, s[20:23], s46 offen offset:3072 sc1
  buffer_load_dwordx4 a[48:51], v10, s[20:23], s47 offen offset:0 sc1
  buffer_load_dwordx4 a[52:55], v10, s[20:23], s47 offen offset:1024 sc1
  buffer_load_dwordx4 a[56:59], v10, s[20:23], s47 offen offset:2048 sc1
  buffer_load_dwordx4 a[60:63], v10, s[20:23], s47 offen offset:3072 sc1
Lfl_57:
  s_cmp_eq_u32 s67, 2
  s_cbranch_scc0 Lfl_58
  s_andn2_b32 s48, s64, s56
  s_cbranch_scc0 Lfl_58
  s_ff1_i32_b32 s53, s48
  s_bitset1_b32 s56, s53
  s_add_u32 s66, s53, 1
  s_add_u32 s67, s67, 1
  s_add_u32 s46, s40, s66
  s_and_b32 s46, s46, 3
  s_lshl_b32 s46, s46, 3
  s_add_u32 s46, s46, s58
  s_mul_i32 s46, s46, 49152
  s_lshl_b32 s47, s3, 13
  s_add_u32 s46, s46, s47
  s_add_u32 s46, s46, 24576
  s_add_u32 s47, s46, 4096
  buffer_load_dwordx4 v[96:99], v10, s[20:23], s46 offen offset:0 sc1
  buffer_load_dwordx4 v[100:103], v10, s[20:23], s46 offen offset:1024 sc1
  buffer_load_dwordx4 v[104:107], v10, s[20:23], s46 offen offset:2048 sc1
  buffer_load_dwordx4 v[108:111], v10, s[20:23], s46 offen offset:3072 sc1
  buffer_load_dwordx4 v[112:115], v10, s[20:23], s47 offen offset:0 sc1
  buffer_load_dwordx4 v[116:119], v10, s[20:23], s47 offen offset:1024 sc1
  buffer_load_dwordx4 v[120:123], v10, s[20:23], s47 offen offset:2048 sc1
  buffer_load_dwordx4 v[124:127], v10, s[20:23], s47 offen offset:3072 sc1
Lfl_58:
Lag_56:
  s_waitcnt lgkmcnt(12)
  v_mfma_f32_16x16x32_bf16 a[192:195], v[224:227], a[16:19], a[192:195]
  ds_read_b64_tr_b16 v[188:189], v250 offset:30848
  v_mfma_f32_16x16x32_bf16 a[196:199], v[224:227], a[20:23], a[196:199]
  ds_read_b64_tr_b16 v[190:191], v250 offset:35968
  s_waitcnt lgkmcnt(12)
  v_mfma_f32_16x16x32_bf16 a[200:203], v[228:231], a[16:19], a[200:203]
  ds_read_b64_tr_b16 v[192:193], v9 offset:30912
  v_mfma_f32_16x16x32_bf16 a[204:207], v[228:231], a[20:23], a[204:207]
  ds_read_b64_tr_b16 v[194:195], v9 offset:36032
  s_waitcnt lgkmcnt(12)
  v_mfma_f32_16x16x32_bf16 a[128:131], v[232:235], a[24:27], a[128:131]
  ds_read_b64_tr_b16 v[196:197], v250 offset:30912
  v_mfma_f32_16x16x32_bf16 a[132:135], v[232:235], a[28:31], a[132:135]
  ds_read_b64_tr_b16 v[198:199], v250 offset:36032
  s_waitcnt lgkmcnt(12)
  v_mfma_f32_16x16x32_bf16 a[136:139], v[236:239], a[24:27], a[136:139]
  ds_read_b64_tr_b16 v[200:201], v9 offset:30976
  v_mfma_f32_16x16x32_bf16 a[140:143], v[236:239], a[28:31], a[140:143]
  ds_read_b64_tr_b16 v[202:203], v9 offset:36096
  s_waitcnt lgkmcnt(12)
  v_mfma_f32_16x16x32_bf16 a[144:147], v[176:179], a[24:27], a[144:147]
  ds_read_b64_tr_b16 v[204:205], v250 offset:30976
  v_mfma_f32_16x16x32_bf16 a[148:151], v[176:179], a[28:31], a[148:151]
  ds_read_b64_tr_b16 v[206:207], v250 offset:36096
  s_waitcnt lgkmcnt(12)
  v_mfma_f32_16x16x32_bf16 a[152:155], v[180:183], a[24:27], a[152:155]
  s_cmp_gt_u32 s67, 1
  s_cbranch_scc0 Lna_49
Lnb_50:
  s_mul_i32 s46, s52, 40960
  s_add_u32 s46, s46, s50
  s_cmp_ge_u32 s46, 163840
  s_cselect_b32 s47, 163840, 0
  s_sub_u32 s46, s46, s47
  v_add_u32 v9, s46, v8
  v_add_u32 v250, s46, v251
  ds_read_b64_tr_b16 v[208:209], v9 offset:0
  v_mfma_f32_16x16x32_bf16 a[156:159], v[180:183], a[28:31], a[156:159]
  ds_read_b64_tr_b16 v[210:211], v9 offset:5120
  s_waitcnt lgkmcnt(12)
  v_mfma_f32_16x16x32_bf16 a[160:163], v[184:187], a[24:27], a[160:163]
  ds_read_b64_tr_b16 v[212:213], v250 offset:0
  v_mfma_f32_16x16x32_bf16 a[164:167], v[184:187], a[28:31], a[164:167]
  ds_read_b64_tr_b16 v[214:215], v250 offset:5120
  s_waitcnt lgkmcnt(12)
  v_mfma_f32_16x16x32_bf16 a[168:171], v[188:191], a[24:27], a[168:171]
  ds_read_b64_tr_b16 v[216:217], v9 offset:64
  v_mfma_f32_16x16x32_bf16 a[172:175], v[188:191], a[28:31], a[172:175]
  ds_read_b64_tr_b16 v[218:219], v9 offset:5184
  s_waitcnt lgkmcnt(12)
  v_mfma_f32_16x16x32_bf16 a[176:179], v[192:195], a[24:27], a[176:179]
  ds_read_b64_tr_b16 v[220:221], v250 offset:64
  v_mfma_f32_16x16x32_bf16 a[180:183], v[192:195], a[28:31], a[180:183]
  ds_read_b64_tr_b16 v[222:223], v250 offset:5184
  s_waitcnt lgkmcnt(12)
  v_mfma_f32_16x16x32_bf16 a[184:187], v[196:199], a[24:27], a[184:187]
  ds_read_b64_tr_b16 v[224:225], v9 offset:128
  v_mfma_f32_16x16x32_bf16 a[188:191], v[196:199], a[28:31], a[188:191]
  ds_read_b64_tr_b16 v[226:227], v9 offset:5248
  s_waitcnt lgkmcnt(12)
  v_mfma_f32_16x16x32_bf16 a[192:195], v[200:203], a[24:27], a[192:195]
  ds_read_b64_tr_b16 v[228:229], v250 offset:128
  v_mfma_f32_16x16x32_bf16 a[196:199], v[200:203], a[28:31], a[196:199]
  ds_read_b64_tr_b16 v[230:231], v250 offset:5248
  s_waitcnt lgkmcnt(12)
  v_mfma_f32_16x16x32_bf16 a[200:203], v[204:207], a[24:27], a[200:203]
  ds_read_b64_tr_b16 v[232:233], v9 offset:192
  v_mfma_f32_16x16x32_bf16 a[204:207], v[204:207], a[28:31], a[204:207]
  ds_read_b64_tr_b16 v[234:235], v9 offset:5312
  s_cmp_eq_u32 s49, 3
  s_cbranch_scc0 Laa_59
  s_waitcnt vmcnt(8)
Lab_60:
  s_waitcnt lgkmcnt(12)
  v_mfma_f32_16x16x32_bf16 a[128:131], v[208:211], a[32:35], a[128:131]
  ds_read_b64_tr_b16 v[236:237], v250 offset:192
  v_mfma_f32_16x16x32_bf16 a[132:135], v[208:211], a[36:39], a[132:135]
  ds_read_b64_tr_b16 v[238:239], v250 offset:5312
  s_waitcnt lgkmcnt(12)
  v_mfma_f32_16x16x32_bf16 a[136:139], v[212:215], a[32:35], a[136:139]
  ds_read_b64_tr_b16 v[176:177], v9 offset:256
  v_mfma_f32_16x16x32_bf16 a[140:143], v[212:215], a[36:39], a[140:143]
  ds_read_b64_tr_b16 v[178:179], v9 offset:5376
  s_waitcnt lgkmcnt(12)
  v_mfma_f32_16x16x32_bf16 a[144:147], v[216:219], a[32:35], a[144:147]
  ds_read_b64_tr_b16 v[180:181], v250 offset:256
  v_mfma_f32_16x16x32_bf16 a[148:151], v[216:219], a[36:39], a[148:151]
  ds_read_b64_tr_b16 v[182:183], v250 offset:5376
  s_waitcnt lgkmcnt(12)
  v_mfma_f32_16x16x32_bf16 a[152:155], v[220:223], a[32:35], a[152:155]
  ds_read_b64_tr_b16 v[184:185], v9 offset:10240
  v_mfma_f32_16x16x32_bf16 a[156:159], v[220:223], a[36:39], a[156:159]
  ds_read_b64_tr_b16 v[186:187], v9 offset:15360
  s_waitcnt lgkmcnt(12)
  v_mfma_f32_16x16x32_bf16 a[160:163], v[224:227], a[32:35], a[160:163]
  ds_read_b64_tr_b16 v[188:189], v250 offset:10240
  v_mfma_f32_16x16x32_bf16 a[164:167], v[224:227], a[36:39], a[164:167]
  ds_read_b64_tr_b16 v[190:191], v250 offset:15360
  s_cmp_eq_u32 s67, 3
  s_cbranch_scc1 Lag_61
  s_mov_b32 s46, 25165952
  buffer_load_dwordx2 v[14:15], v7, s[20:23], s46 offen sc1
Lag_61:
  s_waitcnt lgkmcnt(12)
  v_mfma_f32_16x16x32_bf16 a[168:171], v[228:231], a[32:35], a[168:171]
  ds_read_b64_tr_b16 v[192:193], v9 offset:10304
  v_mfma_f32_16x16x32_bf16 a[172:175], v[228:231], a[36:39], a[172:175]
  ds_read_b64_tr_b16 v[194:195], v9 offset:15424
  s_waitcnt lgkmcnt(12)
  v_mfma_f32_16x16x32_bf16 a[176:179], v[232:235], a[32:35], a[176:179]
  ds_read_b64_tr_b16 v[196:197], v250 offset:10304
  v_mfma_f32_16x16x32_bf16 a[180:183], v[232:235], a[36:39], a[180:183]
  ds_read_b64_tr_b16 v[198:199], v250 offset:15424
  s_waitcnt lgkmcnt(12)
  v_mfma_f32_16x16x32_bf16 a[184:187], v[236:239], a[32:35], a[184:187]
  ds_read_b64_tr_b16 v[200:201], v9 offset:10368
  v_mfma_f32_16x16x32_bf16 a[188:191], v[236:239], a[36:39], a[188:191]
  ds_read_b64_tr_b16 v[202:203], v9 offset:15488
  s_waitcnt lgkmcnt(12)
  v_mfma_f32_16x16x32_bf16 a[192:195], v[176:179], a[32:35], a[192:195]
  ds_read_b64_tr_b16 v[204:205], v250 offset:10368
  v_mfma_f32_16x16x32_bf16 a[196:199], v[176:179], a[36:39], a[196:199]
  ds_read_b64_tr_b16 v[206:207], v250 offset:15488
  s_waitcnt lgkmcnt(12)
  v_mfma_f32_16x16x32_bf16 a[200:203], v[180:183], a[32:35], a[200:203]
  ds_read_b64_tr_b16 v[208:209], v9 offset:10432
  v_mfma_f32_16x16x32_bf16 a[204:207], v[180:183], a[36:39], a[204:207]
  ds_read_b64_tr_b16 v[210:211], v9 offset:15552
  s_waitcnt lgkmcnt(12)
  v_mfma_f32_16x16x32_bf16 a[128:131], v[184:187], a[40:43], a[128:131]
  ds_read_b64_tr_b16 v[212:213], v250 offset:10432
  v_mfma_f32_16x16x32_bf16 a[132:135], v[184:187], a[44:47], a[132:135]
  ds_read_b64_tr_b16 v[214:215], v250 offset:15552
  s_waitcnt lgkmcnt(12)
  v_mfma_f32_16x16x32_bf16 a[136:139], v[188:191], a[40:43], a[136:139]
  ds_read_b64_tr_b16 v[216:217], v9 offset:10496
  v_mfma_f32_16x16x32_bf16 a[140:143], v[188:191], a[44:47], a[140:143]
  ds_read_b64_tr_b16 v[218:219], v9 offset:15616
  s_waitcnt lgkmcnt(12)
  v_mfma_f32_16x16x32_bf16 a[144:147], v[192:195], a[40:43], a[144:147]
  ds_read_b64_tr_b16 v[220:221], v250 offset:10496
  v_mfma_f32_16x16x32_bf16 a[148:151], v[192:195], a[44:47], a[148:151]
  ds_read_b64_tr_b16 v[222:223], v250 offset:15616
  s_waitcnt lgkmcnt(12)
  v_mfma_f32_16x16x32_bf16 a[152:155], v[196:199], a[40:43], a[152:155]
  ds_read_b64_tr_b16 v[224:225], v9 offset:20480
  v_mfma_f32_16x16x32_bf16 a[156:159], v[196:199], a[44:47], a[156:159]
  ds_read_b64_tr_b16 v[226:227], v9 offset:25600
  s_waitcnt lgkmcnt(12)
  v_mfma_f32_16x16x32_bf16 a[160:163], v[200:203], a[40:43], a[160:163]
  ds_read_b64_tr_b16 v[228:229], v250 offset:20480
  v_mfma_f32_16x16x32_bf16 a[164:167], v[200:203], a[44:47], a[164:167]
  ds_read_b64_tr_b16 v[230:231], v250 offset:25600
  s_waitcnt lgkmcnt(12)
  v_mfma_f32_16x16x32_bf16 a[168:171], v[204:207], a[40:43], a[168:171]
  ds_read_b64_tr_b16 v[232:233], v9 offset:20544
  v_mfma_f32_16x16x32_bf16 a[172:175], v[204:207], a[44:47], a[172:175]
  ds_read_b64_tr_b16 v[234:235], v9 offset:25664
  s_waitcnt lgkmcnt(12)
  v_mfma_f32_16x16x32_bf16 a[176:179], v[208:211], a[40:43], a[176:179]
  ds_read_b64_tr_b16 v[236:237], v250 offset:20544
  v_mfma_f32_16x16x32_bf16 a[180:183], v[208:211], a[44:47], a[180:183]
  ds_read_b64_tr_b16 v[238:239], v250 offset:25664
  s_waitcnt lgkmcnt(12)
  v_mfma_f32_16x16x32_bf16 a[184:187], v[212:215], a[40:43], a[184:187]
  ds_read_b64_tr_b16 v[176:177], v9 offset:20608
  v_mfma_f32_16x16x32_bf16 a[188:191], v[212:215], a[44:47], a[188:191]
  ds_read_b64_tr_b16 v[178:179], v9 offset:25728
  s_waitcnt lgkmcnt(12)
  v_mfma_f32_16x16x32_bf16 a[192:195], v[216:219], a[40:43], a[192:195]
  ds_read_b64_tr_b16 v[180:181], v250 offset:20608
  v_mfma_f32_16x16x32_bf16 a[196:199], v[216:219], a[44:47], a[196:199]
  ds_read_b64_tr_b16 v[182:183], v250 offset:25728
  s_waitcnt lgkmcnt(12)
  v_mfma_f32_16x16x32_bf16 a[200:203], v[220:223], a[40:43], a[200:203]
  ds_read_b64_tr_b16 v[184:185], v9 offset:20672
  v_mfma_f32_16x16x32_bf16 a[204:207], v[220:223], a[44:47], a[204:207]
  ds_read_b64_tr_b16 v[186:187], v9 offset:25792
  s_waitcnt lgkmcnt(12)
  v_mfma_f32_16x16x32_bf16 a[128:131], v[224:227], a[48:51], a[128:131]
  ds_read_b64_tr_b16 v[188:189], v250 offset:20672
  v_mfma_f32_16x16x32_bf16 a[132:135], v[224:227], a[52:55], a[132:135]
  ds_read_b64_tr_b16 v[190:191], v250 offset:25792
  s_waitcnt lgkmcnt(12)
  v_mfma_f32_16x16x32_bf16 a[136:139], v[228:231], a[48:51], a[136:139]
  ds_read_b64_tr_b16 v[192:193], v9 offset:20736
  v_mfma_f32_16x16x32_bf16 a[140:143], v[228:231], a[52:55], a[140:143]
  ds_read_b64_tr_b16 v[194:195], v9 offset:25856
  s_waitcnt lgkmcnt(12)
  v_mfma_f32_16x16x32_bf16 a[144:147], v[232:235], a[48:51], a[144:147]
  ds_read_b64_tr_b16 v[196:197], v250 offset:20736
  v_mfma_f32_16x16x32_bf16 a[148:151], v[232:235], a[52:55], a[148:151]
  ds_read_b64_tr_b16 v[198:199], v250 offset:25856
  s_waitcnt lgkmcnt(12)
  v_mfma_f32_16x16x32_bf16 a[152:155], v[236:239], a[48:51], a[152:155]
  ds_read_b64_tr_b16 v[200:201], v9 offset:30720
  v_mfma_f32_16x16x32_bf16 a[156:159], v[236:239], a[52:55], a[156:159]
  ds_read_b64_tr_b16 v[202:203], v9 offset:35840
  s_waitcnt lgkmcnt(12)
  v_mfma_f32_16x16x32_bf16 a[160:163], v[176:179], a[48:51], a[160:163]
  ds_read_b64_tr_b16 v[204:205], v250 offset:30720
  v_mfma_f32_16x16x32_bf16 a[164:167], v[176:179], a[52:55], a[164:167]
  ds_read_b64_tr_b16 v[206:207], v250 offset:35840
  s_waitcnt lgkmcnt(12)
  v_mfma_f32_16x16x32_bf16 a[168:171], v[180:183], a[48:51], a[168:171]
  ds_read_b64_tr_b16 v[208:209], v9 offset:30784
  v_mfma_f32_16x16x32_bf16 a[172:175], v[180:183], a[52:55], a[172:175]
  ds_read_b64_tr_b16 v[210:211], v9 offset:35904
  s_waitcnt lgkmcnt(12)
  v_mfma_f32_16x16x32_bf16 a[176:179], v[184:187], a[48:51], a[176:179]
  ds_read_b64_tr_b16 v[212:213], v250 offset:30784
  v_mfma_f32_16x16x32_bf16 a[180:183], v[184:187], a[52:55], a[180:183]
  ds_read_b64_tr_b16 v[214:215], v250 offset:35904
  s_waitcnt lgkmcnt(12)
  v_mfma_f32_16x16x32_bf16 a[184:187], v[188:191], a[48:51], a[184:187]
  ds_read_b64_tr_b16 v[216:217], v9 offset:30848
  v_mfma_f32_16x16x32_bf16 a[188:191], v[188:191], a[52:55], a[188:191]
  ds_read_b64_tr_b16 v[218:219], v9 offset:35968
  s_cmp_eq_u32 s67, 3
  s_cbranch_scc1 Lag_62
  s_waitcnt vmcnt(0)
  v_cmp_eq_u64 vcc, v[14:15], v[12:13]
  s_nop 1
  s_and_b32 s64, vcc_lo, 7
  s_cmp_eq_u32 s67, 2
  s_cbranch_scc0 Lfl_63
  s_andn2_b32 s48, s64, s56
  s_cbranch_scc0 Lfl_63
  s_ff1_i32_b32 s53, s48
  s_bitset1_b32 s56, s53
  s_add_u32 s66, s53, 1
  s_add_u32 s67, s67, 1
  s_add_u32 s46, s40, s66
  s_and_b32 s46, s46, 3
  s_lshl_b32 s46, s46, 3
  s_add_u32 s46, s46, s58
  s_mul_i32 s46, s46, 49152
  s_lshl_b32 s47, s3, 13
  s_add_u32 s46, s46, s47
  s_add_u32 s46, s46, 24576
  s_add_u32 s47, s46, 4096
  buffer_load_dwordx4 v[96:99], v10, s[20:23], s46 offen offset:0 sc1
  buffer_load_dwordx4 v[100:103], v10, s[20:23], s46 offen offset:1024 sc1
  buffer_load_dwordx4 v[104:107], v10, s[20:23], s46 offen offset:2048 sc1
  buffer_load_dwordx4 v[108:111], v10, s[20:23], s46 offen offset:3072 sc1
  buffer_load_dwordx4 v[112:115], v10, s[20:23], s47 offen offset:0 sc1
  buffer_load_dwordx4 v[116:119], v10, s[20:23], s47 offen offset:1024 sc1
  buffer_load_dwordx4 v[120:123], v10, s[20:23], s47 offen offset:2048 sc1
  buffer_load_dwordx4 v[124:127], v10, s[20:23], s47 offen offset:3072 sc1
Lfl_63:
Lag_62:
  s_waitcnt lgkmcnt(12)
  v_mfma_f32_16x16x32_bf16 a[192:195], v[192:195], a[48:51], a[192:195]
  ds_read_b64_tr_b16 v[220:221], v250 offset:30848
  v_mfma_f32_16x16x32_bf16 a[196:199], v[192:195], a[52:55], a[196:199]
  ds_read_b64_tr_b16 v[222:223], v250 offset:35968
  s_waitcnt lgkmcnt(12)
  v_mfma_f32_16x16x32_bf16 a[200:203], v[196:199], a[48:51], a[200:203]
  ds_read_b64_tr_b16 v[224:225], v9 offset:30912
  v_mfma_f32_16x16x32_bf16 a[204:207], v[196:199], a[52:55], a[204:207]
  ds_read_b64_tr_b16 v[226:227], v9 offset:36032
  s_waitcnt lgkmcnt(12)
  v_mfma_f32_16x16x32_bf16 a[128:131], v[200:203], a[56:59], a[128:131]
  ds_read_b64_tr_b16 v[228:229], v250 offset:30912
  v_mfma_f32_16x16x32_bf16 a[132:135], v[200:203], a[60:63], a[132:135]
  ds_read_b64_tr_b16 v[230:231], v250 offset:36032
  s_waitcnt lgkmcnt(12)
  v_mfma_f32_16x16x32_bf16 a[136:139], v[204:207], a[56:59], a[136:139]
  ds_read_b64_tr_b16 v[232:233], v9 offset:30976
  v_mfma_f32_16x16x32_bf16 a[140:143], v[204:207], a[60:63], a[140:143]
  ds_read_b64_tr_b16 v[234:235], v9 offset:36096
  s_waitcnt lgkmcnt(12)
  v_mfma_f32_16x16x32_bf16 a[144:147], v[208:211], a[56:59], a[144:147]
  ds_read_b64_tr_b16 v[236:237], v250 offset:30976
  v_mfma_f32_16x16x32_bf16 a[148:151], v[208:211], a[60:63], a[148:151]
  ds_read_b64_tr_b16 v[238:239], v250 offset:36096
  s_waitcnt lgkmcnt(12)
  v_mfma_f32_16x16x32_bf16 a[152:155], v[212:215], a[56:59], a[152:155]
  s_cmp_eq_u32 s41, 1
  s_cbranch_scc1 L_last1
  s_cmp_eq_u32 s41, 2
  s_cbranch_scc1 L_last2
  s_cmp_eq_u32 s41, 3
  s_cbranch_scc1 L_last3
  s_cmp_gt_u32 s67, 2
  s_cbranch_scc0 Lna_64
Lnb_65:
  s_mul_i32 s46, s53, 40960
  s_add_u32 s46, s46, s50
  s_cmp_ge_u32 s46, 163840
  s_cselect_b32 s47, 163840, 0
  s_sub_u32 s46, s46, s47
  v_add_u32 v9, s46, v8
  v_add_u32 v250, s46, v251
  ds_read_b64_tr_b16 v[176:177], v9 offset:64
  v_mfma_f32_16x16x32_bf16 a[156:159], v[212:215], a[60:63], a[156:159]
  ds_read_b64_tr_b16 v[178:179], v9 offset:5184
  s_waitcnt lgkmcnt(12)
  v_mfma_f32_16x16x32_bf16 a[160:163], v[216:219], a[56:59], a[160:163]
  ds_read_b64_tr_b16 v[180:181], v9 offset:10304
  v_mfma_f32_16x16x32_bf16 a[164:167], v[216:219], a[60:63], a[164:167]
  ds_read_b64_tr_b16 v[182:183], v9 offset:15424
  s_waitcnt lgkmcnt(12)
  v_mfma_f32_16x16x32_bf16 a[168:171], v[220:223], a[56:59], a[168:171]
  ds_read_b64_tr_b16 v[184:185], v9 offset:20544
  v_mfma_f32_16x16x32_bf16 a[172:175], v[220:223], a[60:63], a[172:175]
  ds_read_b64_tr_b16 v[186:187], v9 offset:25664
  s_waitcnt lgkmcnt(12)
  v_mfma_f32_16x16x32_bf16 a[176:179], v[224:227], a[56:59], a[176:179]
  ds_read_b64_tr_b16 v[188:189], v9 offset:30784
  v_mfma_f32_16x16x32_bf16 a[180:183], v[224:227], a[60:63], a[180:183]
  ds_read_b64_tr_b16 v[190:191], v9 offset:35904
  s_waitcnt lgkmcnt(12)
  v_mfma_f32_16x16x32_bf16 a[184:187], v[228:231], a[56:59], a[184:187]
  ds_read_b64_tr_b16 v[192:193], v250 offset:64
  v_mfma_f32_16x16x32_bf16 a[188:191], v[228:231], a[60:63], a[188:191]
  ds_read_b64_tr_b16 v[194:195], v250 offset:5184
  s_waitcnt lgkmcnt(12)
  v_mfma_f32_16x16x32_bf16 a[192:195], v[232:235], a[56:59], a[192:195]
  ds_read_b64_tr_b16 v[196:197], v250 offset:10304
  v_mfma_f32_16x16x32_bf16 a[196:199], v[232:235], a[60:63], a[196:199]
  ds_read_b64_tr_b16 v[198:199], v250 offset:15424
  s_waitcnt lgkmcnt(12)
  v_mfma_f32_16x16x32_bf16 a[200:203], v[236:239], a[56:59], a[200:203]
  ds_read_b64_tr_b16 v[200:201], v250 offset:20544
  v_mfma_f32_16x16x32_bf16 a[204:207], v[236:239], a[60:63], a[204:207]
  ds_read_b64_tr_b16 v[202:203], v250 offset:25664
  s_waitcnt vmcnt(0)
  s_waitcnt lgkmcnt(12)
  v_mfma_f32_16x16x32_bf16 a[144:147], v[176:179], v[96:99], a[144:147]
  ds_read_b64_tr_b16 v[204:205], v250 offset:30784
  v_mfma_f32_16x16x32_bf16 a[148:151], v[176:179], v[100:103], a[148:151]
  ds_read_b64_tr_b16 v[206:207], v250 offset:35904
  s_waitcnt lgkmcnt(12)
  v_mfma_f32_16x16x32_bf16 a[144:147], v[180:183], v[104:107], a[144:147]
  ds_read_b64_tr_b16 v[208:209], v9 offset:128
  v_mfma_f32_16x16x32_bf16 a[148:151], v[180:183], v[108:111], a[148:151]
  ds_read_b64_tr_b16 v[210:211], v9 offset:5248
  s_waitcnt lgkmcnt(12)
  v_mfma_f32_16x16x32_bf16 a[144:147], v[184:187], v[112:115], a[144:147]
  ds_read_b64_tr_b16 v[212:213], v9 offset:10368
  v_mfma_f32_16x16x32_bf16 a[148:151], v[184:187], v[116:119], a[148:151]
  ds_read_b64_tr_b16 v[214:215], v9 offset:15488
  s_waitcnt lgkmcnt(12)
  v_mfma_f32_16x16x32_bf16 a[144:147], v[188:191], v[120:123], a[144:147]
  ds_read_b64_tr_b16 v[216:217], v9 offset:20608
  v_mfma_f32_16x16x32_bf16 a[148:151], v[188:191], v[124:127], a[148:151]
  ds_read_b64_tr_b16 v[218:219], v9 offset:25728
  s_waitcnt lgkmcnt(12)
  v_mfma_f32_16x16x32_bf16 a[152:155], v[192:195], v[96:99], a[152:155]
  ds_read_b64_tr_b16 v[220:221], v9 offset:30848
  v_mfma_f32_16x16x32_bf16 a[156:159], v[192:195], v[100:103], a[156:159]
  ds_read_b64_tr_b16 v[222:223], v9 offset:35968
  s_waitcnt lgkmcnt(12)
  v_mfma_f32_16x16x32_bf16 a[152:155], v[196:199], v[104:107], a[152:155]
  ds_read_b64_tr_b16 v[224:225], v250 offset:128
  v_mfma_f32_16x16x32_bf16 a[156:159], v[196:199], v[108:111], a[156:159]
  ds_read_b64_tr_b16 v[226:227], v250 offset:5248
  v_accvgpr_read_b32 v32, a144
  v_accvgpr_read_b32 v33, a145
  s_waitcnt lgkmcnt(12)
  v_mfma_f32_16x16x32_bf16 a[152:155], v[200:203], v[112:115], a[152:155]
  ds_read_b64_tr_b16 v[228:229], v250 offset:10368
  v_accvgpr_read_b32 v34, a146
  v_accvgpr_read_b32 v35, a147
  v_mfma_f32_16x16x32_bf16 a[156:159], v[200:203], v[116:119], a[156:159]
  ds_read_b64_tr_b16 v[230:231], v250 offset:15488
  v_accvgpr_read_b32 v40, a148
  v_accvgpr_read_b32 v41, a149
  s_waitcnt lgkmcnt(12)
  v_mfma_f32_16x16x32_bf16 a[152:155], v[204:207], v[120:123], a[152:155]
  ds_read_b64_tr_b16 v[232:233], v250 offset:20608
  v_accvgpr_read_b32 v42, a150
  v_accvgpr_read_b32 v43, a151
  v_mfma_f32_16x16x32_bf16 a[156:159], v[204:207], v[124:127], a[156:159]
  ds_read_b64_tr_b16 v[234:235], v250 offset:25728
  v_cvt_pk_bf16_f32 v48, v40, v41
  v_cvt_pk_bf16_f32 v49, v42, v43
  s_waitcnt lgkmcnt(12)
  v_mfma_f32_16x16x32_bf16 a[160:163], v[208:211], v[96:99], a[160:163]
  ds_read_b64_tr_b16 v[236:237], v250 offset:30848
  v_mfma_f32_16x16x32_bf16 a[164:167], v[208:211], v[100:103], a[164:167]
  ds_read_b64_tr_b16 v[238:239], v250 offset:35968
  s_waitcnt lgkmcnt(12)
  v_mfma_f32_16x16x32_bf16 a[160:163], v[212:215], v[104:107], a[160:163]
  ds_read_b64_tr_b16 v[176:177], v9 offset:192
  v_accvgpr_read_b32 v36, a152
  v_accvgpr_read_b32 v37, a153
  v_mfma_f32_16x16x32_bf16 a[164:167], v[212:215], v[108:111], a[164:167]
  ds_read_b64_tr_b16 v[178:179], v9 offset:5312
  v_accvgpr_read_b32 v38, a154
  v_accvgpr_read_b32 v39, a155
  s_waitcnt lgkmcnt(12)
  v_mfma_f32_16x16x32_bf16 a[160:163], v[216:219], v[112:115], a[160:163]
  ds_read_b64_tr_b16 v[180:181], v9 offset:10432
  v_cvt_pk_bf16_f32 v50, v36, v37
  v_cvt_pk_bf16_f32 v51, v38, v39
  v_mfma_f32_16x16x32_bf16 a[164:167], v[216:219], v[116:119], a[164:167]
  ds_read_b64_tr_b16 v[182:183], v9 offset:15552
  v_accvgpr_read_b32 v40, a156
  v_accvgpr_read_b32 v41, a157
  s_waitcnt lgkmcnt(12)
  v_mfma_f32_16x16x32_bf16 a[160:163], v[220:223], v[120:123], a[160:163]
  ds_read_b64_tr_b16 v[184:185], v9 offset:20672
  v_accvgpr_read_b32 v42, a158
  v_accvgpr_read_b32 v43, a159
  v_mfma_f32_16x16x32_bf16 a[164:167], v[220:223], v[124:127], a[164:167]
  ds_read_b64_tr_b16 v[186:187], v9 offset:25792
  v_cvt_pk_bf16_f32 v52, v40, v41
  v_cvt_pk_bf16_f32 v53, v42, v43
  s_waitcnt lgkmcnt(12)
  v_mfma_f32_16x16x32_bf16 a[168:171], v[224:227], v[96:99], a[168:171]
  ds_read_b64_tr_b16 v[188:189], v9 offset:30912
  buffer_store_dwordx4 v[48:51], v10, s[20:23], s28 offen sc1
  v_mfma_f32_16x16x32_bf16 a[172:175], v[224:227], v[100:103], a[172:175]
  ds_read_b64_tr_b16 v[190:191], v9 offset:36032
  s_waitcnt lgkmcnt(12)
  v_mfma_f32_16x16x32_bf16 a[168:171], v[228:231], v[104:107], a[168:171]
  ds_read_b64_tr_b16 v[192:193], v250 offset:192
  v_accvgpr_read_b32 v36, a160
  v_accvgpr_read_b32 v37, a161
  v_mfma_f32_16x16x32_bf16 a[172:175], v[228:231], v[108:111], a[172:175]
  ds_read_b64_tr_b16 v[194:195], v250 offset:5312
  v_accvgpr_read_b32 v38, a162
  v_accvgpr_read_b32 v39, a163
  s_waitcnt lgkmcnt(12)
  v_mfma_f32_16x16x32_bf16 a[168:171], v[232:235], v[112:115], a[168:171]
  ds_read_b64_tr_b16 v[196:197], v250 offset:10432
  v_cvt_pk_bf16_f32 v54, v36, v37
  v_cvt_pk_bf16_f32 v55, v38, v39
  v_mfma_f32_16x16x32_bf16 a[172:175], v[232:235], v[116:119], a[172:175]
  ds_read_b64_tr_b16 v[198:199], v250 offset:15552
  v_accvgpr_read_b32 v40, a164
  v_accvgpr_read_b32 v41, a165
  s_waitcnt lgkmcnt(12)
  v_mfma_f32_16x16x32_bf16 a[168:171], v[236:239], v[120:123], a[168:171]
  ds_read_b64_tr_b16 v[200:201], v250 offset:20672
  v_accvgpr_read_b32 v42, a166
  v_accvgpr_read_b32 v43, a167
  v_mfma_f32_16x16x32_bf16 a[172:175], v[236:239], v[124:127], a[172:175]
  ds_read_b64_tr_b16 v[202:203], v250 offset:25792
  v_cvt_pk_bf16_f32 v56, v40, v41
  v_cvt_pk_bf16_f32 v57, v42, v43
  s_waitcnt lgkmcnt(12)
  v_mfma_f32_16x16x32_bf16 a[176:179], v[176:179], v[96:99], a[176:179]
  ds_read_b64_tr_b16 v[204:205], v250 offset:30912
  buffer_store_dwordx4 v[52:55], v10, s[20:23], s28 offen offset:1024 sc1
  buffer_store_dwordx2 v[56:57], v248, s[20:23], s28 offen offset:2048 sc1
  v_mfma_f32_16x16x32_bf16 a[180:183], v[176:179], v[100:103], a[180:183]
  ds_read_b64_tr_b16 v[206:207], v250 offset:36032
  v_accvgpr_read_b32 v36, a168
  v_accvgpr_read_b32 v37, a169
  s_waitcnt lgkmcnt(12)
  v_mfma_f32_16x16x32_bf16 a[176:179], v[180:183], v[104:107], a[176:179]
  ds_read_b64_tr_b16 v[208:209], v9 offset:256
  v_accvgpr_read_b32 v38, a170
  v_accvgpr_read_b32 v39, a171
  v_mfma_f32_16x16x32_bf16 a[180:183], v[180:183], v[108:111], a[180:183]
  ds_read_b64_tr_b16 v[210:211], v9 offset:5376
  v_cvt_pk_bf16_f32 v60, v36, v37
  v_cvt_pk_bf16_f32 v61, v38, v39
  s_waitcnt lgkmcnt(12)
  v_mfma_f32_16x16x32_bf16 a[176:179], v[184:187], v[112:115], a[176:179]
  ds_read_b64_tr_b16 v[212:213], v9 offset:10496
  v_accvgpr_read_b32 v40, a172
  v_accvgpr_read_b32 v41, a173
  v_mfma_f32_16x16x32_bf16 a[180:183], v[184:187], v[116:119], a[180:183]
  ds_read_b64_tr_b16 v[214:215], v9 offset:15616
  v_accvgpr_read_b32 v42, a174
  v_accvgpr_read_b32 v43, a175
  s_waitcnt lgkmcnt(12)
  v_mfma_f32_16x16x32_bf16 a[176:179], v[188:191], v[120:123], a[176:179]
  ds_read_b64_tr_b16 v[216:217], v9 offset:20736
  v_cvt_pk_bf16_f32 v62, v40, v41
  v_cvt_pk_bf16_f32 v63, v42, v43
  v_mfma_f32_16x16x32_bf16 a[180:183], v[188:191], v[124:127], a[180:183]
  ds_read_b64_tr_b16 v[218:219], v9 offset:25856
  buffer_store_dwordx4 v[60:63], v10, s[20:23], s29 offen sc1
  s_waitcnt lgkmcnt(12)
  v_mfma_f32_16x16x32_bf16 a[184:187], v[192:195], v[96:99], a[184:187]
  ds_read_b64_tr_b16 v[220:221], v9 offset:30976
  v_mfma_f32_16x16x32_bf16 a[188:191], v[192:195], v[100:103], a[188:191]
  ds_read_b64_tr_b16 v[222:223], v9 offset:36096
  s_waitcnt lgkmcnt(12)
  v_mfma_f32_16x16x32_bf16 a[184:187], v[196:199], v[104:107], a[184:187]
  ds_read_b64_tr_b16 v[224:225], v250 offset:256
  v_accvgpr_read_b32 v36, a176
  v_accvgpr_read_b32 v37, a177
  v_mfma_f32_16x16x32_bf16 a[188:191], v[196:199], v[108:111], a[188:191]
  ds_read_b64_tr_b16 v[226:227], v250 offset:5376
  v_accvgpr_read_b32 v38, a178
  v_accvgpr_read_b32 v39, a179
  s_waitcnt lgkmcnt(12)
  v_mfma_f32_16x16x32_bf16 a[184:187], v[200:203], v[112:115], a[184:187]
  ds_read_b64_tr_b16 v[228:229], v250 offset:10496
  v_cvt_pk_bf16_f32 v64, v36, v37
  v_cvt_pk_bf16_f32 v65, v38, v39
  v_mfma_f32_16x16x32_bf16 a[188:191], v[200:203], v[116:119], a[188:191]
  ds_read_b64_tr_b16 v[230:231], v250 offset:15616
  v_accvgpr_read_b32 v40, a180
  v_accvgpr_read_b32 v41, a181
  s_waitcnt lgkmcnt(12)
  v_mfma_f32_16x16x32_bf16 a[184:187], v[204:207], v[120:123], a[184:187]
  ds_read_b64_tr_b16 v[232:233], v250 offset:20736
  v_accvgpr_read_b32 v42, a182
  v_accvgpr_read_b32 v43, a183
  v_mfma_f32_16x16x32_bf16 a[188:191], v[204:207], v[124:127], a[188:191]
  ds_read_b64_tr_b16 v[234:235], v250 offset:25856
  v_cvt_pk_bf16_f32 v66, v40, v41
  v_cvt_pk_bf16_f32 v67, v42, v43
  s_waitcnt lgkmcnt(12)
  v_mfma_f32_16x16x32_bf16 a[192:195], v[208:211], v[96:99], a[192:195]
  ds_read_b64_tr_b16 v[236:237], v250 offset:30976
  buffer_store_dwordx4 v[64:67], v10, s[20:23], s29 offen offset:1024 sc1
  v_mfma_f32_16x16x32_bf16 a[196:199], v[208:211], v[100:103], a[196:199]
  ds_read_b64_tr_b16 v[238:239], v250 offset:36096
  s_waitcnt lgkmcnt(12)
  v_mfma_f32_16x16x32_bf16 a[192:195], v[212:215], v[104:107], a[192:195]
  ds_read_b64_tr_b16 v[176:177], v9 offset:0
  v_accvgpr_read_b32 v36, a184
  v_accvgpr_read_b32 v37, a185
  v_mfma_f32_16x16x32_bf16 a[196:199], v[212:215], v[108:111], a[196:199]
  ds_read_b64_tr_b16 v[178:179], v9 offset:5120
  v_accvgpr_read_b32 v38, a186
  v_accvgpr_read_b32 v39, a187
  s_waitcnt lgkmcnt(12)
  v_mfma_f32_16x16x32_bf16 a[192:195], v[216:219], v[112:115], a[192:195]
  ds_read_b64_tr_b16 v[180:181], v9 offset:10240
  v_cvt_pk_bf16_f32 v68, v36, v37
  v_cvt_pk_bf16_f32 v69, v38, v39
  v_mfma_f32_16x16x32_bf16 a[196:199], v[216:219], v[116:119], a[196:199]
  ds_read_b64_tr_b16 v[182:183], v9 offset:15360
  v_accvgpr_read_b32 v40, a188
  v_accvgpr_read_b32 v41, a189
  s_waitcnt lgkmcnt(12)
  v_mfma_f32_16x16x32_bf16 a[192:195], v[220:223], v[120:123], a[192:195]
  ds_read_b64_tr_b16 v[184:185], v9 offset:20480
  v_accvgpr_read_b32 v42, a190
  v_accvgpr_read_b32 v43, a191
  v_mfma_f32_16x16x32_bf16 a[196:199], v[220:223], v[124:127], a[196:199]
  ds_read_b64_tr_b16 v[186:187], v9 offset:25600
  v_cvt_pk_bf16_f32 v72, v40, v41
  v_cvt_pk_bf16_f32 v73, v42, v43
  s_waitcnt lgkmcnt(12)
  v_mfma_f32_16x16x32_bf16 a[200:203], v[224:227], v[96:99], a[200:203]
  ds_read_b64_tr_b16 v[188:189], v9 offset:30720
  buffer_store_dwordx2 v[68:69], v248, s[20:23], s29 offen offset:2048 sc1
  v_mfma_f32_16x16x32_bf16 a[204:207], v[224:227], v[100:103], a[204:207]
  ds_read_b64_tr_b16 v[190:191], v9 offset:35840
  s_waitcnt lgkmcnt(12)
  v_mfma_f32_16x16x32_bf16 a[200:203], v[228:231], v[104:107], a[200:203]
  ds_read_b64_tr_b16 v[192:193], v250 offset:0
  v_accvgpr_read_b32 v36, a192
  v_accvgpr_read_b32 v37, a193
  v_mfma_f32_16x16x32_bf16 a[204:207], v[228:231], v[108:111], a[204:207]
  ds_read_b64_tr_b16 v[194:195], v250 offset:5120
  v_accvgpr_read_b32 v38, a194
  v_accvgpr_read_b32 v39, a195
  s_waitcnt lgkmcnt(12)
  v_mfma_f32_16x16x32_bf16 a[200:203], v[232:235], v[112:115], a[200:203]
  ds_read_b64_tr_b16 v[196:197], v250 offset:10240
  v_cvt_pk_bf16_f32 v74, v36, v37
  v_cvt_pk_bf16_f32 v75, v38, v39
  v_mfma_f32_16x16x32_bf16 a[204:207], v[232:235], v[116:119], a[204:207]
  ds_read_b64_tr_b16 v[198:199], v250 offset:15360
  v_accvgpr_read_b32 v40, a196
  v_accvgpr_read_b32 v41, a197
  s_waitcnt lgkmcnt(12)
  v_mfma_f32_16x16x32_bf16 a[200:203], v[236:239], v[120:123], a[200:203]
  ds_read_b64_tr_b16 v[200:201], v250 offset:20480
  v_accvgpr_read_b32 v42, a198
  v_accvgpr_read_b32 v43, a199
  v_mfma_f32_16x16x32_bf16 a[204:207], v[236:239], v[124:127], a[204:207]
  ds_read_b64_tr_b16 v[202:203], v250 offset:25600
  v_cvt_pk_bf16_f32 v76, v40, v41
  v_cvt_pk_bf16_f32 v77, v42, v43
  s_waitcnt lgkmcnt(12)
  v_mfma_f32_16x16x32_bf16 a[128:131], v[176:179], v[96:99], a[128:131]
  ds_read_b64_tr_b16 v[204:205], v250 offset:30720
  buffer_store_dwordx4 v[72:75], v10, s[20:23], s30 offen sc1
  v_mfma_f32_16x16x32_bf16 a[132:135], v[176:179], v[100:103], a[132:135]
  ds_read_b64_tr_b16 v[206:207], v250 offset:35840
  s_waitcnt lgkmcnt(12)
  v_mfma_f32_16x16x32_bf16 a[128:131], v[180:183], v[104:107], a[128:131]
  v_accvgpr_read_b32 v36, a200
  v_accvgpr_read_b32 v37, a201
  v_mfma_f32_16x16x32_bf16 a[132:135], v[180:183], v[108:111], a[132:135]
  v_accvgpr_read_b32 v38, a202
  v_accvgpr_read_b32 v39, a203
  s_waitcnt lgkmcnt(10)
  v_mfma_f32_16x16x32_bf16 a[128:131], v[184:187], v[112:115], a[128:131]
  v_cvt_pk_bf16_f32 v78, v36, v37
  v_cvt_pk_bf16_f32 v79, v38, v39
  v_mfma_f32_16x16x32_bf16 a[132:135], v[184:187], v[116:119], a[132:135]
  v_accvgpr_read_b32 v40, a204
  v_accvgpr_read_b32 v41, a205
  s_waitcnt lgkmcnt(8)
  v_mfma_f32_16x16x32_bf16 a[128:131], v[188:191], v[120:123], a[128:131]
  v_accvgpr_read_b32 v42, a206
  v_accvgpr_read_b32 v43, a207
  v_mfma_f32_16x16x32_bf16 a[132:135], v[188:191], v[124:127], a[132:135]
  v_cvt_pk_bf16_f32 v80, v40, v41
  v_cvt_pk_bf16_f32 v81, v42, v43
  s_waitcnt lgkmcnt(6)
  v_mfma_f32_16x16x32_bf16 a[136:139], v[192:195], v[96:99], a[136:139]
  buffer_store_dwordx4 v[76:79], v10, s[20:23], s30 offen offset:1024 sc1
  buffer_store_dwordx2 v[80:81], v248, s[20:23], s30 offen offset:2048 sc1
  v_mfma_f32_16x16x32_bf16 a[140:143], v[192:195], v[100:103], a[140:143]
  s_waitcnt lgkmcnt(4)
  v_mfma_f32_16x16x32_bf16 a[136:139], v[196:199], v[104:107], a[136:139]
  v_accvgpr_read_b32 v16, a128
  v_accvgpr_read_b32 v17, a129
  v_mfma_f32_16x16x32_bf16 a[140:143], v[196:199], v[108:111], a[140:143]
  v_accvgpr_read_b32 v18, a130
  v_accvgpr_read_b32 v19, a131
  s_waitcnt lgkmcnt(2)
  v_mfma_f32_16x16x32_bf16 a[136:139], v[200:203], v[112:115], a[136:139]
  v_accvgpr_read_b32 v20, a132
  v_accvgpr_read_b32 v21, a133
  v_mfma_f32_16x16x32_bf16 a[140:143], v[200:203], v[116:119], a[140:143]
  v_accvgpr_read_b32 v22, a134
  v_accvgpr_read_b32 v23, a135
  s_waitcnt lgkmcnt(0)
  v_mfma_f32_16x16x32_bf16 a[136:139], v[204:207], v[120:123], a[136:139]
  v_mfma_f32_16x16x32_bf16 a[140:143], v[204:207], v[124:127], a[140:143]
  s_nop 8
  v_accvgpr_read_b32 v24, a136
  v_accvgpr_read_b32 v25, a137
  v_accvgpr_read_b32 v26, a138
  v_accvgpr_read_b32 v27, a139
  v_accvgpr_read_b32 v28, a140
  v_accvgpr_read_b32 v29, a141
  v_accvgpr_read_b32 v30, a142
  v_accvgpr_read_b32 v31, a143
  s_branch L_lastd
L_last1:
  s_cmp_gt_u32 s67, 2
  s_cbranch_scc0 Lna_67
Lnb_68:
  s_mul_i32 s46, s53, 40960
  s_add_u32 s46, s46, s50
  s_cmp_ge_u32 s46, 163840
  s_cselect_b32 s47, 163840, 0
  s_sub_u32 s46, s46, s47
  v_add_u32 v9, s46, v8
  v_add_u32 v250, s46, v251
  ds_read_b64_tr_b16 v[176:177], v250 offset:128
  v_mfma_f32_16x16x32_bf16 a[156:159], v[212:215], a[60:63], a[156:159]
  ds_read_b64_tr_b16 v[178:179], v250 offset:5248
  s_waitcnt lgkmcnt(12)
  v_mfma_f32_16x16x32_bf16 a[160:163], v[216:219], a[56:59], a[160:163]
  ds_read_b64_tr_b16 v[180:181], v250 offset:10368
  v_mfma_f32_16x16x32_bf16 a[164:167], v[216:219], a[60:63], a[164:167]
  ds_read_b64_tr_b16 v[182:183], v250 offset:15488
  s_waitcnt lgkmcnt(12)
  v_mfma_f32_16x16x32_bf16 a[168:171], v[220:223], a[56:59], a[168:171]
  ds_read_b64_tr_b16 v[184:185], v250 offset:20608
  v_mfma_f32_16x16x32_bf16 a[172:175], v[220:223], a[60:63], a[172:175]
  ds_read_b64_tr_b16 v[186:187], v250 offset:25728
  s_waitcnt lgkmcnt(12)
  v_mfma_f32_16x16x32_bf16 a[176:179], v[224:227], a[56:59], a[176:179]
  ds_read_b64_tr_b16 v[188:189], v250 offset:30848
  v_mfma_f32_16x16x32_bf16 a[180:183], v[224:227], a[60:63], a[180:183]
  ds_read_b64_tr_b16 v[190:191], v250 offset:35968
  s_waitcnt lgkmcnt(12)
  v_mfma_f32_16x16x32_bf16 a[184:187], v[228:231], a[56:59], a[184:187]
  ds_read_b64_tr_b16 v[192:193], v9 offset:192
  v_mfma_f32_16x16x32_bf16 a[188:191], v[228:231], a[60:63], a[188:191]
  ds_read_b64_tr_b16 v[194:195], v9 offset:5312
  s_waitcnt lgkmcnt(12)
  v_mfma_f32_16x16x32_bf16 a[192:195], v[232:235], a[56:59], a[192:195]
  ds_read_b64_tr_b16 v[196:197], v9 offset:10432
  v_mfma_f32_16x16x32_bf16 a[196:199], v[232:235], a[60:63], a[196:199]
  ds_read_b64_tr_b16 v[198:199], v9 offset:15552
  s_waitcnt lgkmcnt(12)
  v_mfma_f32_16x16x32_bf16 a[200:203], v[236:239], a[56:59], a[200:203]
  ds_read_b64_tr_b16 v[200:201], v9 offset:20672
  v_mfma_f32_16x16x32_bf16 a[204:207], v[236:239], a[60:63], a[204:207]
  ds_read_b64_tr_b16 v[202:203], v9 offset:25792
  s_waitcnt vmcnt(0)
  s_waitcnt lgkmcnt(12)
  v_mfma_f32_16x16x32_bf16 a[168:171], v[176:179], v[96:99], a[168:171]
  ds_read_b64_tr_b16 v[204:205], v9 offset:30912
  v_mfma_f32_16x16x32_bf16 a[172:175], v[176:179], v[100:103], a[172:175]
  ds_read_b64_tr_b16 v[206:207], v9 offset:36032
  s_waitcnt lgkmcnt(12)
  v_mfma_f32_16x16x32_bf16 a[168:171], v[180:183], v[104:107], a[168:171]
  ds_read_b64_tr_b16 v[208:209], v250 offset:192
  v_mfma_f32_16x16x32_bf16 a[172:175], v[180:183], v[108:111], a[172:175]
  ds_read_b64_tr_b16 v[210:211], v250 offset:5312
  s_waitcnt lgkmcnt(12)
  v_mfma_f32_16x16x32_bf16 a[168:171], v[184:187], v[112:115], a[168:171]
  ds_read_b64_tr_b16 v[212:213], v250 offset:10432
  v_mfma_f32_16x16x32_bf16 a[172:175], v[184:187], v[116:119], a[172:175]
  ds_read_b64_tr_b16 v[214:215], v250 offset:15552
  s_waitcnt lgkmcnt(12)
  v_mfma_f32_16x16x32_bf16 a[168:171], v[188:191], v[120:123], a[168:171]
  ds_read_b64_tr_b16 v[216:217], v250 offset:20672
  v_mfma_f32_16x16x32_bf16 a[172:175], v[188:191], v[124:127], a[172:175]
  ds_read_b64_tr_b16 v[218:219], v250 offset:25792
  s_waitcnt lgkmcnt(12)
  v_mfma_f32_16x16x32_bf16 a[176:179], v[192:195], v[96:99], a[176:179]
  ds_read_b64_tr_b16 v[220:221], v250 offset:30912
  v_mfma_f32_16x16x32_bf16 a[180:183], v[192:195], v[100:103], a[180:183]
  ds_read_b64_tr_b16 v[222:223], v250 offset:36032
  s_waitcnt lgkmcnt(12)
  v_mfma_f32_16x16x32_bf16 a[176:179], v[196:199], v[104:107], a[176:179]
  ds_read_b64_tr_b16 v[224:225], v9 offset:256
  v_mfma_f32_16x16x32_bf16 a[180:183], v[196:199], v[108:111], a[180:183]
  ds_read_b64_tr_b16 v[226:227], v9 offset:5376
  v_accvgpr_read_b32 v36, a168
  v_accvgpr_read_b32 v37, a169
  s_waitcnt lgkmcnt(12)
  v_mfma_f32_16x16x32_bf16 a[176:179], v[200:203], v[112:115], a[176:179]
  ds_read_b64_tr_b16 v[228:229], v9 offset:10496
  v_accvgpr_read_b32 v38, a170
  v_accvgpr_read_b32 v39, a171
  v_mfma_f32_16x16x32_bf16 a[180:183], v[200:203], v[116:119], a[180:183]
  ds_read_b64_tr_b16 v[230:231], v9 offset:15616
  v_cvt_pk_bf16_f32 v48, v36, v37
  v_cvt_pk_bf16_f32 v49, v38, v39
  s_waitcnt lgkmcnt(12)
  v_mfma_f32_16x16x32_bf16 a[176:179], v[204:207], v[120:123], a[176:179]
  ds_read_b64_tr_b16 v[232:233], v9 offset:20736
  v_accvgpr_read_b32 v40, a172
  v_accvgpr_read_b32 v41, a173
  v_mfma_f32_16x16x32_bf16 a[180:183], v[204:207], v[124:127], a[180:183]
  ds_read_b64_tr_b16 v[234:235], v9 offset:25856
  v_accvgpr_read_b32 v42, a174
  v_accvgpr_read_b32 v43, a175
  s_waitcnt lgkmcnt(12)
  v_mfma_f32_16x16x32_bf16 a[184:187], v[208:211], v[96:99], a[184:187]
  ds_read_b64_tr_b16 v[236:237], v9 offset:30976
  v_cvt_pk_bf16_f32 v50, v40, v41
  v_cvt_pk_bf16_f32 v51, v42, v43
  v_mfma_f32_16x16x32_bf16 a[188:191], v[208:211], v[100:103], a[188:191]
  ds_read_b64_tr_b16 v[238:239], v9 offset:36096
  buffer_store_dwordx4 v[48:51], v10, s[20:23], s28 offen sc1
  v_accvgpr_read_b32 v36, a176
  s_waitcnt lgkmcnt(12)
  v_mfma_f32_16x16x32_bf16 a[184:187], v[212:215], v[104:107], a[184:187]
  ds_read_b64_tr_b16 v[176:177], v250 offset:256
  v_accvgpr_read_b32 v37, a177
  v_accvgpr_read_b32 v38, a178
  v_mfma_f32_16x16x32_bf16 a[188:191], v[212:215], v[108:111], a[188:191]
  ds_read_b64_tr_b16 v[178:179], v250 offset:5376
  v_accvgpr_read_b32 v39, a179
  v_cvt_pk_bf16_f32 v52, v36, v37
  s_waitcnt lgkmcnt(12)
  v_mfma_f32_16x16x32_bf16 a[184:187], v[216:219], v[112:115], a[184:187]
  ds_read_b64_tr_b16 v[180:181], v250 offset:10496
  v_cvt_pk_bf16_f32 v53, v38, v39
  v_accvgpr_read_b32 v40, a180
  v_mfma_f32_16x16x32_bf16 a[188:191], v[216:219], v[116:119], a[188:191]
  ds_read_b64_tr_b16 v[182:183], v250 offset:15616
  v_accvgpr_read_b32 v41, a181
  v_accvgpr_read_b32 v42, a182
  s_waitcnt lgkmcnt(12)
  v_mfma_f32_16x16x32_bf16 a[184:187], v[220:223], v[120:123], a[184:187]
  ds_read_b64_tr_b16 v[184:185], v250 offset:20736
  v_accvgpr_read_b32 v43, a183
  v_cvt_pk_bf16_f32 v54, v40, v41
  v_mfma_f32_16x16x32_bf16 a[188:191], v[220:223], v[124:127], a[188:191]
  ds_read_b64_tr_b16 v[186:187], v250 offset:25856
  v_cvt_pk_bf16_f32 v55, v42, v43
  buffer_store_dwordx4 v[52:55], v10, s[20:23], s28 offen offset:1024 sc1
  s_waitcnt lgkmcnt(12)
  v_mfma_f32_16x16x32_bf16 a[192:195], v[224:227], v[96:99], a[192:195]
  ds_read_b64_tr_b16 v[188:189], v250 offset:30976
  v_mfma_f32_16x16x32_bf16 a[196:199], v[224:227], v[100:103], a[196:199]
  ds_read_b64_tr_b16 v[190:191], v250 offset:36096
  s_waitcnt lgkmcnt(12)
  v_mfma_f32_16x16x32_bf16 a[192:195], v[228:231], v[104:107], a[192:195]
  ds_read_b64_tr_b16 v[192:193], v9 offset:0
  v_accvgpr_read_b32 v36, a184
  v_accvgpr_read_b32 v37, a185
  v_mfma_f32_16x16x32_bf16 a[196:199], v[228:231], v[108:111], a[196:199]
  ds_read_b64_tr_b16 v[194:195], v9 offset:5120
  v_accvgpr_read_b32 v38, a186
  v_accvgpr_read_b32 v39, a187
  s_waitcnt lgkmcnt(12)
  v_mfma_f32_16x16x32_bf16 a[192:195], v[232:235], v[112:115], a[192:195]
  ds_read_b64_tr_b16 v[196:197], v9 offset:10240
  v_cvt_pk_bf16_f32 v56, v36, v37
  v_cvt_pk_bf16_f32 v57, v38, v39
  v_mfma_f32_16x16x32_bf16 a[196:199], v[232:235], v[116:119], a[196:199]
  ds_read_b64_tr_b16 v[198:199], v9 offset:15360
  v_accvgpr_read_b32 v40, a188
  v_accvgpr_read_b32 v41, a189
  s_waitcnt lgkmcnt(12)
  v_mfma_f32_16x16x32_bf16 a[192:195], v[236:239], v[120:123], a[192:195]
  ds_read_b64_tr_b16 v[200:201], v9 offset:20480
  v_accvgpr_read_b32 v42, a190
  v_accvgpr_read_b32 v43, a191
  v_mfma_f32_16x16x32_bf16 a[196:199], v[236:239], v[124:127], a[196:199]
  ds_read_b64_tr_b16 v[202:203], v9 offset:25600
  v_cvt_pk_bf16_f32 v60, v40, v41
  v_cvt_pk_bf16_f32 v61, v42, v43
  s_waitcnt lgkmcnt(12)
  v_mfma_f32_16x16x32_bf16 a[200:203], v[176:179], v[96:99], a[200:203]
  ds_read_b64_tr_b16 v[204:205], v9 offset:30720
  buffer_store_dwordx2 v[56:57], v248, s[20:23], s28 offen offset:2048 sc1
  v_mfma_f32_16x16x32_bf16 a[204:207], v[176:179], v[100:103], a[204:207]
  ds_read_b64_tr_b16 v[206:207], v9 offset:35840
  s_waitcnt lgkmcnt(12)
  v_mfma_f32_16x16x32_bf16 a[200:203], v[180:183], v[104:107], a[200:203]
  ds_read_b64_tr_b16 v[208:209], v250 offset:0
  v_accvgpr_read_b32 v36, a192
  v_accvgpr_read_b32 v37, a193
  v_mfma_f32_16x16x32_bf16 a[204:207], v[180:183], v[108:111], a[204:207]
  ds_read_b64_tr_b16 v[210:211], v250 offset:5120
  v_accvgpr_read_b32 v38, a194
  v_accvgpr_read_b32 v39, a195
  s_waitcnt lgkmcnt(12)
  v_mfma_f32_16x16x32_bf16 a[200:203], v[184:187], v[112:115], a[200:203]
  ds_read_b64_tr_b16 v[212:213], v250 offset:10240
  v_cvt_pk_bf16_f32 v62, v36, v37
  v_cvt_pk_bf16_f32 v63, v38, v39
  v_mfma_f32_16x16x32_bf16 a[204:207], v[184:187], v[116:119], a[204:207]
  ds_read_b64_tr_b16 v[214:215], v250 offset:15360
  v_accvgpr_read_b32 v40, a196
  v_accvgpr_read_b32 v41, a197
  s_waitcnt lgkmcnt(12)
  v_mfma_f32_16x16x32_bf16 a[200:203], v[188:191], v[120:123], a[200:203]
  ds_read_b64_tr_b16 v[216:217], v250 offset:20480
  v_accvgpr_read_b32 v42, a198
  v_accvgpr_read_b32 v43, a199
  v_mfma_f32_16x16x32_bf16 a[204:207], v[188:191], v[124:127], a[204:207]
  ds_read_b64_tr_b16 v[218:219], v250 offset:25600
  v_cvt_pk_bf16_f32 v64, v40, v41
  v_cvt_pk_bf16_f32 v65, v42, v43
  s_waitcnt lgkmcnt(12)
  v_mfma_f32_16x16x32_bf16 a[128:131], v[192:195], v[96:99], a[128:131]
  ds_read_b64_tr_b16 v[220:221], v250 offset:30720
  buffer_store_dwordx4 v[60:63], v10, s[20:23], s29 offen sc1
  v_mfma_f32_16x16x32_bf16 a[132:135], v[192:195], v[100:103], a[132:135]
  ds_read_b64_tr_b16 v[222:223], v250 offset:35840
  s_waitcnt lgkmcnt(12)
  v_mfma_f32_16x16x32_bf16 a[128:131], v[196:199], v[104:107], a[128:131]
  ds_read_b64_tr_b16 v[224:225], v9 offset:64
  v_accvgpr_read_b32 v36, a200
  v_accvgpr_read_b32 v37, a201
  v_mfma_f32_16x16x32_bf16 a[132:135], v[196:199], v[108:111], a[132:135]
  ds_read_b64_tr_b16 v[226:227], v9 offset:5184
  v_accvgpr_read_b32 v38, a202
  v_accvgpr_read_b32 v39, a203
  s_waitcnt lgkmcnt(12)
  v_mfma_f32_16x16x32_bf16 a[128:131], v[200:203], v[112:115], a[128:131]
  ds_read_b64_tr_b16 v[228:229], v9 offset:10304
  v_cvt_pk_bf16_f32 v66, v36, v37
  v_cvt_pk_bf16_f32 v67, v38, v39
  v_mfma_f32_16x16x32_bf16 a[132:135], v[200:203], v[116:119], a[132:135]
  ds_read_b64_tr_b16 v[230:231], v9 offset:15424
  v_accvgpr_read_b32 v40, a204
  v_accvgpr_read_b32 v41, a205
  s_waitcnt lgkmcnt(12)
  v_mfma_f32_16x16x32_bf16 a[128:131], v[204:207], v[120:123], a[128:131]
  ds_read_b64_tr_b16 v[232:233], v9 offset:20544
  v_accvgpr_read_b32 v42, a206
  v_accvgpr_read_b32 v43, a207
  v_mfma_f32_16x16x32_bf16 a[132:135], v[204:207], v[124:127], a[132:135]
  ds_read_b64_tr_b16 v[234:235], v9 offset:25664
  v_cvt_pk_bf16_f32 v68, v40, v41
  v_cvt_pk_bf16_f32 v69, v42, v43
  s_waitcnt lgkmcnt(12)
  v_mfma_f32_16x16x32_bf16 a[136:139], v[208:211], v[96:99], a[136:139]
  ds_read_b64_tr_b16 v[236:237], v9 offset:30784
  buffer_store_dwordx4 v[64:67], v10, s[20:23], s29 offen offset:1024 sc1
  buffer_store_dwordx2 v[68:69], v248, s[20:23], s29 offen offset:2048 sc1
  v_mfma_f32_16x16x32_bf16 a[140:143], v[208:211], v[100:103], a[140:143]
  ds_read_b64_tr_b16 v[238:239], v9 offset:35904
  v_accvgpr_read_b32 v36, a128
  v_accvgpr_read_b32 v37, a129
  s_waitcnt lgkmcnt(12)
  v_mfma_f32_16x16x32_bf16 a[136:139], v[212:215], v[104:107], a[136:139]
  ds_read_b64_tr_b16 v[176:177], v250 offset:64
  v_accvgpr_read_b32 v38, a130
  v_accvgpr_read_b32 v39, a131
  v_mfma_f32_16x16x32_bf16 a[140:143], v[212:215], v[108:111], a[140:143]
  ds_read_b64_tr_b16 v[178:179], v250 offset:5184
  v_cvt_pk_bf16_f32 v72, v36, v37
  v_cvt_pk_bf16_f32 v73, v38, v39
  s_waitcnt lgkmcnt(12)
  v_mfma_f32_16x16x32_bf16 a[136:139], v[216:219], v[112:115], a[136:139]
  ds_read_b64_tr_b16 v[180:181], v250 offset:10304
  v_accvgpr_read_b32 v40, a132
  v_accvgpr_read_b32 v41, a133
  v_mfma_f32_16x16x32_bf16 a[140:143], v[216:219], v[116:119], a[140:143]
  ds_read_b64_tr_b16 v[182:183], v250 offset:15424
  v_accvgpr_read_b32 v42, a134
  v_accvgpr_read_b32 v43, a135
  s_waitcnt lgkmcnt(12)
  v_mfma_f32_16x16x32_bf16 a[136:139], v[220:223], v[120:123], a[136:139]
  ds_read_b64_tr_b16 v[184:185], v250 offset:20544
  v_cvt_pk_bf16_f32 v74, v40, v41
  v_cvt_pk_bf16_f32 v75, v42, v43
  v_mfma_f32_16x16x32_bf16 a[140:143], v[220:223], v[124:127], a[140:143]
  ds_read_b64_tr_b16 v[186:187], v250 offset:25664
  buffer_store_dwordx4 v[72:75], v10, s[20:23], s30 offen sc1
  s_waitcnt lgkmcnt(12)
  v_mfma_f32_16x16x32_bf16 a[144:147], v[224:227], v[96:99], a[144:147]
  ds_read_b64_tr_b16 v[188:189], v250 offset:30784
  v_mfma_f32_16x16x32_bf16 a[148:151], v[224:227], v[100:103], a[148:151]
  ds_read_b64_tr_b16 v[190:191], v250 offset:35904
  s_waitcnt lgkmcnt(12)
  v_mfma_f32_16x16x32_bf16 a[144:147], v[228:231], v[104:107], a[144:147]
  ds_read_b64_tr_b16 v[192:193], v9 offset:128
  v_accvgpr_read_b32 v36, a136
  v_accvgpr_read_b32 v37, a137
  v_mfma_f32_16x16x32_bf16 a[148:151], v[228:231], v[108:111], a[148:151]
  ds_read_b64_tr_b16 v[194:195], v9 offset:5248
  v_accvgpr_read_b32 v38, a138
  v_accvgpr_read_b32 v39, a139
  s_waitcnt lgkmcnt(12)
  v_mfma_f32_16x16x32_bf16 a[144:147], v[232:235], v[112:115], a[144:147]
  ds_read_b64_tr_b16 v[196:197], v9 offset:10368
  v_cvt_pk_bf16_f32 v76, v36, v37
  v_cvt_pk_bf16_f32 v77, v38, v39
  v_mfma_f32_16x16x32_bf16 a[148:151], v[232:235], v[116:119], a[148:151]
  ds_read_b64_tr_b16 v[198:199], v9 offset:15488
  v_accvgpr_read_b32 v40, a140
  v_accvgpr_read_b32 v41, a141
  s_waitcnt lgkmcnt(12)
  v_mfma_f32_16x16x32_bf16 a[144:147], v[236:239], v[120:123], a[144:147]
  ds_read_b64_tr_b16 v[200:201], v9 offset:20608
  v_accvgpr_read_b32 v42, a142
  v_accvgpr_read_b32 v43, a143
  v_mfma_f32_16x16x32_bf16 a[148:151], v[236:239], v[124:127], a[148:151]
  ds_read_b64_tr_b16 v[202:203], v9 offset:25728
  v_cvt_pk_bf16_f32 v78, v40, v41
  v_cvt_pk_bf16_f32 v79, v42, v43
  s_waitcnt lgkmcnt(12)
  v_mfma_f32_16x16x32_bf16 a[152:155], v[176:179], v[96:99], a[152:155]
  ds_read_b64_tr_b16 v[204:205], v9 offset:30848
  buffer_store_dwordx4 v[76:79], v10, s[20:23], s30 offen offset:1024 sc1
  v_mfma_f32_16x16x32_bf16 a[156:159], v[176:179], v[100:103], a[156:159]
  ds_read_b64_tr_b16 v[206:207], v9 offset:35968
  s_waitcnt lgkmcnt(12)
  v_mfma_f32_16x16x32_bf16 a[152:155], v[180:183], v[104:107], a[152:155]
  v_accvgpr_read_b32 v36, a144
  v_accvgpr_read_b32 v37, a145
  v_mfma_f32_16x16x32_bf16 a[156:159], v[180:183], v[108:111], a[156:159]
  v_accvgpr_read_b32 v38, a146
  v_accvgpr_read_b32 v39, a147
  s_waitcnt lgkmcnt(10)
  v_mfma_f32_16x16x32_bf16 a[152:155], v[184:187], v[112:115], a[152:155]
  v_cvt_pk_bf16_f32 v80, v36, v37
  v_cvt_pk_bf16_f32 v81, v38, v39
  v_mfma_f32_16x16x32_bf16 a[156:159], v[184:187], v[116:119], a[156:159]
  v_accvgpr_read_b32 v16, a148
  v_accvgpr_read_b32 v17, a149
  s_waitcnt lgkmcnt(8)
  v_mfma_f32_16x16x32_bf16 a[152:155], v[188:191], v[120:123], a[152:155]
  v_accvgpr_read_b32 v18, a150
  v_accvgpr_read_b32 v19, a151
  v_mfma_f32_16x16x32_bf16 a[156:159], v[188:191], v[124:127], a[156:159]
  buffer_store_dwordx2 v[80:81], v248, s[20:23], s30 offen offset:2048 sc1
  s_waitcnt lgkmcnt(6)
  v_mfma_f32_16x16x32_bf16 a[160:163], v[192:195], v[96:99], a[160:163]
  v_mfma_f32_16x16x32_bf16 a[164:167], v[192:195], v[100:103], a[164:167]
  s_waitcnt lgkmcnt(4)
  v_mfma_f32_16x16x32_bf16 a[160:163], v[196:199], v[104:107], a[160:163]
  v_mfma_f32_16x16x32_bf16 a[164:167], v[196:199], v[108:111], a[164:167]
  s_waitcnt lgkmcnt(2)
  v_mfma_f32_16x16x32_bf16 a[160:163], v[200:203], v[112:115], a[160:163]
  v_accvgpr_read_b32 v20, a152
  v_accvgpr_read_b32 v21, a153
  v_mfma_f32_16x16x32_bf16 a[164:167], v[200:203], v[116:119], a[164:167]
  v_accvgpr_read_b32 v22, a154
  v_accvgpr_read_b32 v23, a155
  s_waitcnt lgkmcnt(0)
  v_mfma_f32_16x16x32_bf16 a[160:163], v[204:207], v[120:123], a[160:163]
  v_accvgpr_read_b32 v24, a156
  v_accvgpr_read_b32 v25, a157
  v_mfma_f32_16x16x32_bf16 a[164:167], v[204:207], v[124:127], a[164:167]
  v_accvgpr_read_b32 v26, a158
  v_accvgpr_read_b32 v27, a159
  s_nop 6
  v_accvgpr_read_b32 v28, a160
  v_accvgpr_read_b32 v29, a161
  v_accvgpr_read_b32 v30, a162
  v_accvgpr_read_b32 v31, a163
  v_accvgpr_read_b32 v32, a164
  v_accvgpr_read_b32 v33, a165
  v_accvgpr_read_b32 v34, a166
  v_accvgpr_read_b32 v35, a167
  s_branch L_lastd
L_last2:
  s_cmp_gt_u32 s67, 2
  s_cbranch_scc0 Lna_70
Lnb_71:
  s_mul_i32 s46, s53, 40960
  s_add_u32 s46, s46, s50
  s_cmp_ge_u32 s46, 163840
  s_cselect_b32 s47, 163840, 0
  s_sub_u32 s46, s46, s47
  v_add_u32 v9, s46, v8
  v_add_u32 v250, s46, v251
  ds_read_b64_tr_b16 v[176:177], v250 offset:192
  v_mfma_f32_16x16x32_bf16 a[156:159], v[212:215], a[60:63], a[156:159]
  ds_read_b64_tr_b16 v[178:179], v250 offset:5312
  s_waitcnt lgkmcnt(12)
  v_mfma_f32_16x16x32_bf16 a[160:163], v[216:219], a[56:59], a[160:163]
  ds_read_b64_tr_b16 v[180:181], v250 offset:10432
  v_mfma_f32_16x16x32_bf16 a[164:167], v[216:219], a[60:63], a[164:167]
  ds_read_b64_tr_b16 v[182:183], v250 offset:15552
  s_waitcnt lgkmcnt(12)
  v_mfma_f32_16x16x32_bf16 a[168:171], v[220:223], a[56:59], a[168:171]
  ds_read_b64_tr_b16 v[184:185], v250 offset:20672
  v_mfma_f32_16x16x32_bf16 a[172:175], v[220:223], a[60:63], a[172:175]
  ds_read_b64_tr_b16 v[186:187], v250 offset:25792
  s_waitcnt lgkmcnt(12)
  v_mfma_f32_16x16x32_bf16 a[176:179], v[224:227], a[56:59], a[176:179]
  ds_read_b64_tr_b16 v[188:189], v250 offset:30912
  v_mfma_f32_16x16x32_bf16 a[180:183], v[224:227], a[60:63], a[180:183]
  ds_read_b64_tr_b16 v[190:191], v250 offset:36032
  s_waitcnt lgkmcnt(12)
  v_mfma_f32_16x16x32_bf16 a[184:187], v[228:231], a[56:59], a[184:187]
  ds_read_b64_tr_b16 v[192:193], v9 offset:256
  v_mfma_f32_16x16x32_bf16 a[188:191], v[228:231], a[60:63], a[188:191]
  ds_read_b64_tr_b16 v[194:195], v9 offset:5376
  s_waitcnt lgkmcnt(12)
  v_mfma_f32_16x16x32_bf16 a[192:195], v[232:235], a[56:59], a[192:195]
  ds_read_b64_tr_b16 v[196:197], v9 offset:10496
  v_mfma_f32_16x16x32_bf16 a[196:199], v[232:235], a[60:63], a[196:199]
  ds_read_b64_tr_b16 v[198:199], v9 offset:15616
  s_waitcnt lgkmcnt(12)
  v_mfma_f32_16x16x32_bf16 a[200:203], v[236:239], a[56:59], a[200:203]
  ds_read_b64_tr_b16 v[200:201], v9 offset:20736
  v_mfma_f32_16x16x32_bf16 a[204:207], v[236:239], a[60:63], a[204:207]
  ds_read_b64_tr_b16 v[202:203], v9 offset:25856
  s_waitcnt vmcnt(0)
  s_waitcnt lgkmcnt(12)
  v_mfma_f32_16x16x32_bf16 a[184:187], v[176:179], v[96:99], a[184:187]
  ds_read_b64_tr_b16 v[204:205], v9 offset:30976
  v_mfma_f32_16x16x32_bf16 a[188:191], v[176:179], v[100:103], a[188:191]
  ds_read_b64_tr_b16 v[206:207], v9 offset:36096
  s_waitcnt lgkmcnt(12)
  v_mfma_f32_16x16x32_bf16 a[184:187], v[180:183], v[104:107], a[184:187]
  ds_read_b64_tr_b16 v[208:209], v250 offset:256
  v_mfma_f32_16x16x32_bf16 a[188:191], v[180:183], v[108:111], a[188:191]
  ds_read_b64_tr_b16 v[210:211], v250 offset:5376
  s_waitcnt lgkmcnt(12)
  v_mfma_f32_16x16x32_bf16 a[184:187], v[184:187], v[112:115], a[184:187]
  ds_read_b64_tr_b16 v[212:213], v250 offset:10496
  v_mfma_f32_16x16x32_bf16 a[188:191], v[184:187], v[116:119], a[188:191]
  ds_read_b64_tr_b16 v[214:215], v250 offset:15616
  s_waitcnt lgkmcnt(12)
  v_mfma_f32_16x16x32_bf16 a[184:187], v[188:191], v[120:123], a[184:187]
  ds_read_b64_tr_b16 v[216:217], v250 offset:20736
  v_mfma_f32_16x16x32_bf16 a[188:191], v[188:191], v[124:127], a[188:191]
  ds_read_b64_tr_b16 v[218:219], v250 offset:25856
  s_waitcnt lgkmcnt(12)
  v_mfma_f32_16x16x32_bf16 a[192:195], v[192:195], v[96:99], a[192:195]
  ds_read_b64_tr_b16 v[220:221], v250 offset:30976
  v_mfma_f32_16x16x32_bf16 a[196:199], v[192:195], v[100:103], a[196:199]
  ds_read_b64_tr_b16 v[222:223], v250 offset:36096
  s_waitcnt lgkmcnt(12)
  v_mfma_f32_16x16x32_bf16 a[192:195], v[196:199], v[104:107], a[192:195]
  ds_read_b64_tr_b16 v[224:225], v9 offset:0
  v_mfma_f32_16x16x32_bf16 a[196:199], v[196:199], v[108:111], a[196:199]
  ds_read_b64_tr_b16 v[226:227], v9 offset:5120
  v_accvgpr_read_b32 v32, a184
  v_accvgpr_read_b32 v33, a185
  s_waitcnt lgkmcnt(12)
  v_mfma_f32_16x16x32_bf16 a[192:195], v[200:203], v[112:115], a[192:195]
  ds_read_b64_tr_b16 v[228:229], v9 offset:10240
  v_accvgpr_read_b32 v34, a186
  v_accvgpr_read_b32 v35, a187
  v_mfma_f32_16x16x32_bf16 a[196:199], v[200:203], v[116:119], a[196:199]
  ds_read_b64_tr_b16 v[230:231], v9 offset:15360
  v_accvgpr_read_b32 v40, a188
  v_accvgpr_read_b32 v41, a189
  s_waitcnt lgkmcnt(12)
  v_mfma_f32_16x16x32_bf16 a[192:195], v[204:207], v[120:123], a[192:195]
  ds_read_b64_tr_b16 v[232:233], v9 offset:20480
  v_accvgpr_read_b32 v42, a190
  v_accvgpr_read_b32 v43, a191
  v_mfma_f32_16x16x32_bf16 a[196:199], v[204:207], v[124:127], a[196:199]
  ds_read_b64_tr_b16 v[234:235], v9 offset:25600
  v_cvt_pk_bf16_f32 v48, v40, v41
  v_cvt_pk_bf16_f32 v49, v42, v43
  s_waitcnt lgkmcnt(12)
  v_mfma_f32_16x16x32_bf16 a[200:203], v[208:211], v[96:99], a[200:203]
  ds_read_b64_tr_b16 v[236:237], v9 offset:30720
  v_mfma_f32_16x16x32_bf16 a[204:207], v[208:211], v[100:103], a[204:207]
  ds_read_b64_tr_b16 v[238:239], v9 offset:35840
  s_waitcnt lgkmcnt(12)
  v_mfma_f32_16x16x32_bf16 a[200:203], v[212:215], v[104:107], a[200:203]
  ds_read_b64_tr_b16 v[176:177], v250 offset:0
  v_accvgpr_read_b32 v36, a192
  v_accvgpr_read_b32 v37, a193
  v_mfma_f32_16x16x32_bf16 a[204:207], v[212:215], v[108:111], a[204:207]
  ds_read_b64_tr_b16 v[178:179], v250 offset:5120
  v_accvgpr_read_b32 v38, a194
  v_accvgpr_read_b32 v39, a195
  s_waitcnt lgkmcnt(12)
  v_mfma_f32_16x16x32_bf16 a[200:203], v[216:219], v[112:115], a[200:203]
  ds_read_b64_tr_b16 v[180:181], v250 offset:10240
  v_cvt_pk_bf16_f32 v50, v36, v37
  v_cvt_pk_bf16_f32 v51, v38, v39
  v_mfma_f32_16x16x32_bf16 a[204:207], v[216:219], v[116:119], a[204:207]
  ds_read_b64_tr_b16 v[182:183], v250 offset:15360
  v_accvgpr_read_b32 v40, a196
  v_accvgpr_read_b32 v41, a197
  s_waitcnt lgkmcnt(12)
  v_mfma_f32_16x16x32_bf16 a[200:203], v[220:223], v[120:123], a[200:203]
  ds_read_b64_tr_b16 v[184:185], v250 offset:20480
  v_accvgpr_read_b32 v42, a198
  v_accvgpr_read_b32 v43, a199
  v_mfma_f32_16x16x32_bf16 a[204:207], v[220:223], v[124:127], a[204:207]
  ds_read_b64_tr_b16 v[186:187], v250 offset:25600
  v_cvt_pk_bf16_f32 v52, v40, v41
  v_cvt_pk_bf16_f32 v53, v42, v43
  s_waitcnt lgkmcnt(12)
  v_mfma_f32_16x16x32_bf16 a[128:131], v[224:227], v[96:99], a[128:131]
  ds_read_b64_tr_b16 v[188:189], v250 offset:30720
  buffer_store_dwordx4 v[48:51], v10, s[20:23], s28 offen sc1
  v_mfma_f32_16x16x32_bf16 a[132:135], v[224:227], v[100:103], a[132:135]
  ds_read_b64_tr_b16 v[190:191], v250 offset:35840
  s_waitcnt lgkmcnt(12)
  v_mfma_f32_16x16x32_bf16 a[128:131], v[228:231], v[104:107], a[128:131]
  ds_read_b64_tr_b16 v[192:193], v9 offset:64
  v_accvgpr_read_b32 v36, a200
  v_accvgpr_read_b32 v37, a201
  v_mfma_f32_16x16x32_bf16 a[132:135], v[228:231], v[108:111], a[132:135]
  ds_read_b64_tr_b16 v[194:195], v9 offset:5184
  v_accvgpr_read_b32 v38, a202
  v_accvgpr_read_b32 v39, a203
  s_waitcnt lgkmcnt(12)
  v_mfma_f32_16x16x32_bf16 a[128:131], v[232:235], v[112:115], a[128:131]
  ds_read_b64_tr_b16 v[196:197], v9 offset:10304
  v_cvt_pk_bf16_f32 v54, v36, v37
  v_cvt_pk_bf16_f32 v55, v38, v39
  v_mfma_f32_16x16x32_bf16 a[132:135], v[232:235], v[116:119], a[132:135]
  ds_read_b64_tr_b16 v[198:199], v9 offset:15424
  v_accvgpr_read_b32 v40, a204
  v_accvgpr_read_b32 v41, a205
  s_waitcnt lgkmcnt(12)
  v_mfma_f32_16x16x32_bf16 a[128:131], v[236:239], v[120:123], a[128:131]
  ds_read_b64_tr_b16 v[200:201], v9 offset:20544
  v_accvgpr_read_b32 v42, a206
  v_accvgpr_read_b32 v43, a207
  v_mfma_f32_16x16x32_bf16 a[132:135], v[236:239], v[124:127], a[132:135]
  ds_read_b64_tr_b16 v[202:203], v9 offset:25664
  v_cvt_pk_bf16_f32 v56, v40, v41
  v_cvt_pk_bf16_f32 v57, v42, v43
  s_waitcnt lgkmcnt(12)
  v_mfma_f32_16x16x32_bf16 a[136:139], v[176:179], v[96:99], a[136:139]
  ds_read_b64_tr_b16 v[204:205], v9 offset:30784
  buffer_store_dwordx4 v[52:55], v10, s[20:23], s28 offen offset:1024 sc1
  buffer_store_dwordx2 v[56:57], v248, s[20:23], s28 offen offset:2048 sc1
  v_mfma_f32_16x16x32_bf16 a[140:143], v[176:179], v[100:103], a[140:143]
  ds_read_b64_tr_b16 v[206:207], v9 offset:35904
  v_accvgpr_read_b32 v36, a128
  v_accvgpr_read_b32 v37, a129
  s_waitcnt lgkmcnt(12)
  v_mfma_f32_16x16x32_bf16 a[136:139], v[180:183], v[104:107], a[136:139]
  ds_read_b64_tr_b16 v[208:209], v250 offset:64
  v_accvgpr_read_b32 v38, a130
  v_accvgpr_read_b32 v39, a131
  v_mfma_f32_16x16x32_bf16 a[140:143], v[180:183], v[108:111], a[140:143]
  ds_read_b64_tr_b16 v[210:211], v250 offset:5184
  v_cvt_pk_bf16_f32 v60, v36, v37
  v_cvt_pk_bf16_f32 v61, v38, v39
  s_waitcnt lgkmcnt(12)
  v_mfma_f32_16x16x32_bf16 a[136:139], v[184:187], v[112:115], a[136:139]
  ds_read_b64_tr_b16 v[212:213], v250 offset:10304
  v_accvgpr_read_b32 v40, a132
  v_accvgpr_read_b32 v41, a133
  v_mfma_f32_16x16x32_bf16 a[140:143], v[184:187], v[116:119], a[140:143]
  ds_read_b64_tr_b16 v[214:215], v250 offset:15424
  v_accvgpr_read_b32 v42, a134
  v_accvgpr_read_b32 v43, a135
  s_waitcnt lgkmcnt(12)
  v_mfma_f32_16x16x32_bf16 a[136:139], v[188:191], v[120:123], a[136:139]
  ds_read_b64_tr_b16 v[216:217], v250 offset:20544
  v_cvt_pk_bf16_f32 v62, v40, v41
  v_cvt_pk_bf16_f32 v63, v42, v43
  v_mfma_f32_16x16x32_bf16 a[140:143], v[188:191], v[124:127], a[140:143]
  ds_read_b64_tr_b16 v[218:219], v250 offset:25664
  buffer_store_dwordx4 v[60:63], v10, s[20:23], s29 offen sc1
  s_waitcnt lgkmcnt(12)
  v_mfma_f32_16x16x32_bf16 a[144:147], v[192:195], v[96:99], a[144:147]
  ds_read_b64_tr_b16 v[220:221], v250 offset:30784
  v_mfma_f32_16x16x32_bf16 a[148:151], v[192:195], v[100:103], a[148:151]
  ds_read_b64_tr_b16 v[222:223], v250 offset:35904
  s_waitcnt lgkmcnt(12)
  v_mfma_f32_16x16x32_bf16 a[144:147], v[196:199], v[104:107], a[144:147]
  ds_read_b64_tr_b16 v[224:225], v9 offset:128
  v_accvgpr_read_b32 v36, a136
  v_accvgpr_read_b32 v37, a137
  v_mfma_f32_16x16x32_bf16 a[148:151], v[196:199], v[108:111], a[148:151]
  ds_read_b64_tr_b16 v[226:227], v9 offset:5248
  v_accvgpr_read_b32 v38, a138
  v_accvgpr_read_b32 v39, a139
  s_waitcnt lgkmcnt(12)
  v_mfma_f32_16x16x32_bf16 a[144:147], v[200:203], v[112:115], a[144:147]
  ds_read_b64_tr_b16 v[228:229], v9 offset:10368
  v_cvt_pk_bf16_f32 v64, v36, v37
  v_cvt_pk_bf16_f32 v65, v38, v39
  v_mfma_f32_16x16x32_bf16 a[148:151], v[200:203], v[116:119], a[148:151]
  ds_read_b64_tr_b16 v[230:231], v9 offset:15488
  v_accvgpr_read_b32 v40, a140
  v_accvgpr_read_b32 v41, a141
  s_waitcnt lgkmcnt(12)
  v_mfma_f32_16x16x32_bf16 a[144:147], v[204:207], v[120:123], a[144:147]
  ds_read_b64_tr_b16 v[232:233], v9 offset:20608
  v_accvgpr_read_b32 v42, a142
  v_accvgpr_read_b32 v43, a143
  v_mfma_f32_16x16x32_bf16 a[148:151], v[204:207], v[124:127], a[148:151]
  ds_read_b64_tr_b16 v[234:235], v9 offset:25728
  v_cvt_pk_bf16_f32 v66, v40, v41
  v_cvt_pk_bf16_f32 v67, v42, v43
  s_waitcnt lgkmcnt(12)
  v_mfma_f32_16x16x32_bf16 a[152:155], v[208:211], v[96:99], a[152:155]
  ds_read_b64_tr_b16 v[236:237], v9 offset:30848
  buffer_store_dwordx4 v[64:67], v10, s[20:23], s29 offen offset:1024 sc1
  v_mfma_f32_16x16x32_bf16 a[156:159], v[208:211], v[100:103], a[156:159]
  ds_read_b64_tr_b16 v[238:239], v9 offset:35968
  s_waitcnt lgkmcnt(12)
  v_mfma_f32_16x16x32_bf16 a[152:155], v[212:215], v[104:107], a[152:155]
  ds_read_b64_tr_b16 v[176:177], v250 offset:128
  v_accvgpr_read_b32 v36, a144
  v_accvgpr_read_b32 v37, a145
  v_mfma_f32_16x16x32_bf16 a[156:159], v[212:215], v[108:111], a[156:159]
  ds_read_b64_tr_b16 v[178:179], v250 offset:5248
  v_accvgpr_read_b32 v38, a146
  v_accvgpr_read_b32 v39, a147
  s_waitcnt lgkmcnt(12)
  v_mfma_f32_16x16x32_bf16 a[152:155], v[216:219], v[112:115], a[152:155]
  ds_read_b64_tr_b16 v[180:181], v250 offset:10368
  v_cvt_pk_bf16_f32 v68, v36, v37
  v_cvt_pk_bf16_f32 v69, v38, v39
  v_mfma_f32_16x16x32_bf16 a[156:159], v[216:219], v[116:119], a[156:159]
  ds_read_b64_tr_b16 v[182:183], v250 offset:15488
  v_accvgpr_read_b32 v40, a148
  v_accvgpr_read_b32 v41, a149
  s_waitcnt lgkmcnt(12)
  v_mfma_f32_16x16x32_bf16 a[152:155], v[220:223], v[120:123], a[152:155]
  ds_read_b64_tr_b16 v[184:185], v250 offset:20608
  v_accvgpr_read_b32 v42, a150
  v_accvgpr_read_b32 v43, a151
  v_mfma_f32_16x16x32_bf16 a[156:159], v[220:223], v[124:127], a[156:159]
  ds_read_b64_tr_b16 v[186:187], v250 offset:25728
  v_cvt_pk_bf16_f32 v72, v40, v41
  v_cvt_pk_bf16_f32 v73, v42, v43
  s_waitcnt lgkmcnt(12)
  v_mfma_f32_16x16x32_bf16 a[160:163], v[224:227], v[96:99], a[160:163]
  ds_read_b64_tr_b16 v[188:189], v250 offset:30848
  buffer_store_dwordx2 v[68:69], v248, s[20:23], s29 offen offset:2048 sc1
  v_mfma_f32_16x16x32_bf16 a[164:167], v[224:227], v[100:103], a[164:167]
  ds_read_b64_tr_b16 v[190:191], v250 offset:35968
  s_waitcnt lgkmcnt(12)
  v_mfma_f32_16x16x32_bf16 a[160:163], v[228:231], v[104:107], a[160:163]
  ds_read_b64_tr_b16 v[192:193], v9 offset:192
  v_accvgpr_read_b32 v36, a152
  v_accvgpr_read_b32 v37, a153
  v_mfma_f32_16x16x32_bf16 a[164:167], v[228:231], v[108:111], a[164:167]
  ds_read_b64_tr_b16 v[194:195], v9 offset:5312
  v_accvgpr_read_b32 v38, a154
  v_accvgpr_read_b32 v39, a155
  s_waitcnt lgkmcnt(12)
  v_mfma_f32_16x16x32_bf16 a[160:163], v[232:235], v[112:115], a[160:163]
  ds_read_b64_tr_b16 v[196:197], v9 offset:10432
  v_cvt_pk_bf16_f32 v74, v36, v37
  v_cvt_pk_bf16_f32 v75, v38, v39
  v_mfma_f32_16x16x32_bf16 a[164:167], v[232:235], v[116:119], a[164:167]
  ds_read_b64_tr_b16 v[198:199], v9 offset:15552
  v_accvgpr_read_b32 v40, a156
  v_accvgpr_read_b32 v41, a157
  s_waitcnt lgkmcnt(12)
  v_mfma_f32_16x16x32_bf16 a[160:163], v[236:239], v[120:123], a[160:163]
  ds_read_b64_tr_b16 v[200:201], v9 offset:20672
  v_accvgpr_read_b32 v42, a158
  v_accvgpr_read_b32 v43, a159
  v_mfma_f32_16x16x32_bf16 a[164:167], v[236:239], v[124:127], a[164:167]
  ds_read_b64_tr_b16 v[202:203], v9 offset:25792
  v_cvt_pk_bf16_f32 v76, v40, v41
  v_cvt_pk_bf16_f32 v77, v42, v43
  s_waitcnt lgkmcnt(12)
  v_mfma_f32_16x16x32_bf16 a[168:171], v[176:179], v[96:99], a[168:171]
  ds_read_b64_tr_b16 v[204:205], v9 offset:30912
  buffer_store_dwordx4 v[72:75], v10, s[20:23], s30 offen sc1
  v_mfma_f32_16x16x32_bf16 a[172:175], v[176:179], v[100:103], a[172:175]
  ds_read_b64_tr_b16 v[206:207], v9 offset:36032
  s_waitcnt lgkmcnt(12)
  v_mfma_f32_16x16x32_bf16 a[168:171], v[180:183], v[104:107], a[168:171]
  v_accvgpr_read_b32 v36, a160
  v_accvgpr_read_b32 v37, a161
  v_mfma_f32_16x16x32_bf16 a[172:175], v[180:183], v[108:111], a[172:175]
  v_accvgpr_read_b32 v38, a162
  v_accvgpr_read_b32 v39, a163
  s_waitcnt lgkmcnt(10)
  v_mfma_f32_16x16x32_bf16 a[168:171], v[184:187], v[112:115], a[168:171]
  v_cvt_pk_bf16_f32 v78, v36, v37
  v_cvt_pk_bf16_f32 v79, v38, v39
  v_mfma_f32_16x16x32_bf16 a[172:175], v[184:187], v[116:119], a[172:175]
  v_accvgpr_read_b32 v40, a164
  v_accvgpr_read_b32 v41, a165
  s_waitcnt lgkmcnt(8)
  v_mfma_f32_16x16x32_bf16 a[168:171], v[188:191], v[120:123], a[168:171]
  v_accvgpr_read_b32 v42, a166
  v_accvgpr_read_b32 v43, a167
  v_mfma_f32_16x16x32_bf16 a[172:175], v[188:191], v[124:127], a[172:175]
  v_cvt_pk_bf16_f32 v80, v40, v41
  v_cvt_pk_bf16_f32 v81, v42, v43
  s_waitcnt lgkmcnt(6)
  v_mfma_f32_16x16x32_bf16 a[176:179], v[192:195], v[96:99], a[176:179]
  buffer_store_dwordx4 v[76:79], v10, s[20:23], s30 offen offset:1024 sc1
  buffer_store_dwordx2 v[80:81], v248, s[20:23], s30 offen offset:2048 sc1
  v_mfma_f32_16x16x32_bf16 a[180:183], v[192:195], v[100:103], a[180:183]
  s_waitcnt lgkmcnt(4)
  v_mfma_f32_16x16x32_bf16 a[176:179], v[196:199], v[104:107], a[176:179]
  v_accvgpr_read_b32 v16, a168
  v_accvgpr_read_b32 v17, a169
  v_mfma_f32_16x16x32_bf16 a[180:183], v[196:199], v[108:111], a[180:183]
  v_accvgpr_read_b32 v18, a170
  v_accvgpr_read_b32 v19, a171
  s_waitcnt lgkmcnt(2)
  v_mfma_f32_16x16x32_bf16 a[176:179], v[200:203], v[112:115], a[176:179]
  v_accvgpr_read_b32 v20, a172
  v_accvgpr_read_b32 v21, a173
  v_mfma_f32_16x16x32_bf16 a[180:183], v[200:203], v[116:119], a[180:183]
  v_accvgpr_read_b32 v22, a174
  v_accvgpr_read_b32 v23, a175
  s_waitcnt lgkmcnt(0)
  v_mfma_f32_16x16x32_bf16 a[176:179], v[204:207], v[120:123], a[176:179]
  v_mfma_f32_16x16x32_bf16 a[180:183], v[204:207], v[124:127], a[180:183]
  s_nop 8
  v_accvgpr_read_b32 v24, a176
  v_accvgpr_read_b32 v25, a177
  v_accvgpr_read_b32 v26, a178
  v_accvgpr_read_b32 v27, a179
  v_accvgpr_read_b32 v28, a180
  v_accvgpr_read_b32 v29, a181
  v_accvgpr_read_b32 v30, a182
  v_accvgpr_read_b32 v31, a183
  s_branch L_lastd
L_last3:
  s_cmp_gt_u32 s67, 2
  s_cbranch_scc0 Lna_73
Lnb_74:
  s_mul_i32 s46, s53, 40960
  s_add_u32 s46, s46, s50
  s_cmp_ge_u32 s46, 163840
  s_cselect_b32 s47, 163840, 0
  s_sub_u32 s46, s46, s47
  v_add_u32 v9, s46, v8
  v_add_u32 v250, s46, v251
  ds_read_b64_tr_b16 v[176:177], v9 offset:0
  v_mfma_f32_16x16x32_bf16 a[156:159], v[212:215], a[60:63], a[156:159]
  ds_read_b64_tr_b16 v[178:179], v9 offset:5120
  s_waitcnt lgkmcnt(12)
  v_mfma_f32_16x16x32_bf16 a[160:163], v[216:219], a[56:59], a[160:163]
  ds_read_b64_tr_b16 v[180:181], v9 offset:10240
  v_mfma_f32_16x16x32_bf16 a[164:167], v[216:219], a[60:63], a[164:167]
  ds_read_b64_tr_b16 v[182:183], v9 offset:15360
  s_waitcnt lgkmcnt(12)
  v_mfma_f32_16x16x32_bf16 a[168:171], v[220:223], a[56:59], a[168:171]
  ds_read_b64_tr_b16 v[184:185], v9 offset:20480
  v_mfma_f32_16x16x32_bf16 a[172:175], v[220:223], a[60:63], a[172:175]
  ds_read_b64_tr_b16 v[186:187], v9 offset:25600
  s_waitcnt lgkmcnt(12)
  v_mfma_f32_16x16x32_bf16 a[176:179], v[224:227], a[56:59], a[176:179]
  ds_read_b64_tr_b16 v[188:189], v9 offset:30720
  v_mfma_f32_16x16x32_bf16 a[180:183], v[224:227], a[60:63], a[180:183]
  ds_read_b64_tr_b16 v[190:191], v9 offset:35840
  s_waitcnt lgkmcnt(12)
  v_mfma_f32_16x16x32_bf16 a[184:187], v[228:231], a[56:59], a[184:187]
  ds_read_b64_tr_b16 v[192:193], v250 offset:0
  v_mfma_f32_16x16x32_bf16 a[188:191], v[228:231], a[60:63], a[188:191]
  ds_read_b64_tr_b16 v[194:195], v250 offset:5120
  s_waitcnt lgkmcnt(12)
  v_mfma_f32_16x16x32_bf16 a[192:195], v[232:235], a[56:59], a[192:195]
  ds_read_b64_tr_b16 v[196:197], v250 offset:10240
  v_mfma_f32_16x16x32_bf16 a[196:199], v[232:235], a[60:63], a[196:199]
  ds_read_b64_tr_b16 v[198:199], v250 offset:15360
  s_waitcnt lgkmcnt(12)
  v_mfma_f32_16x16x32_bf16 a[200:203], v[236:239], a[56:59], a[200:203]
  ds_read_b64_tr_b16 v[200:201], v250 offset:20480
  v_mfma_f32_16x16x32_bf16 a[204:207], v[236:239], a[60:63], a[204:207]
  ds_read_b64_tr_b16 v[202:203], v250 offset:25600
  s_waitcnt vmcnt(0)
  s_waitcnt lgkmcnt(12)
  v_mfma_f32_16x16x32_bf16 a[128:131], v[176:179], v[96:99], a[128:131]
  ds_read_b64_tr_b16 v[204:205], v250 offset:30720
  v_mfma_f32_16x16x32_bf16 a[132:135], v[176:179], v[100:103], a[132:135]
  ds_read_b64_tr_b16 v[206:207], v250 offset:35840
  s_waitcnt lgkmcnt(12)
  v_mfma_f32_16x16x32_bf16 a[128:131], v[180:183], v[104:107], a[128:131]
  ds_read_b64_tr_b16 v[208:209], v9 offset:64
  v_mfma_f32_16x16x32_bf16 a[132:135], v[180:183], v[108:111], a[132:135]
  ds_read_b64_tr_b16 v[210:211], v9 offset:5184
  s_waitcnt lgkmcnt(12)
  v_mfma_f32_16x16x32_bf16 a[128:131], v[184:187], v[112:115], a[128:131]
  ds_read_b64_tr_b16 v[212:213], v9 offset:10304
  v_mfma_f32_16x16x32_bf16 a[132:135], v[184:187], v[116:119], a[132:135]
  ds_read_b64_tr_b16 v[214:215], v9 offset:15424
  s_waitcnt lgkmcnt(12)
  v_mfma_f32_16x16x32_bf16 a[128:131], v[188:191], v[120:123], a[128:131]
  ds_read_b64_tr_b16 v[216:217], v9 offset:20544
  v_mfma_f32_16x16x32_bf16 a[132:135], v[188:191], v[124:127], a[132:135]
  ds_read_b64_tr_b16 v[218:219], v9 offset:25664
  s_waitcnt lgkmcnt(12)
  v_mfma_f32_16x16x32_bf16 a[136:139], v[192:195], v[96:99], a[136:139]
  ds_read_b64_tr_b16 v[220:221], v9 offset:30784
  v_mfma_f32_16x16x32_bf16 a[140:143], v[192:195], v[100:103], a[140:143]
  ds_read_b64_tr_b16 v[222:223], v9 offset:35904
  s_waitcnt lgkmcnt(12)
  v_mfma_f32_16x16x32_bf16 a[136:139], v[196:199], v[104:107], a[136:139]
  ds_read_b64_tr_b16 v[224:225], v250 offset:64
  v_mfma_f32_16x16x32_bf16 a[140:143], v[196:199], v[108:111], a[140:143]
  ds_read_b64_tr_b16 v[226:227], v250 offset:5184
  v_accvgpr_read_b32 v36, a128
  v_accvgpr_read_b32 v37, a129
  s_waitcnt lgkmcnt(12)
  v_mfma_f32_16x16x32_bf16 a[136:139], v[200:203], v[112:115], a[136:139]
  ds_read_b64_tr_b16 v[228:229], v250 offset:10304
  v_accvgpr_read_b32 v38, a130
  v_accvgpr_read_b32 v39, a131
  v_mfma_f32_16x16x32_bf16 a[140:143], v[200:203], v[116:119], a[140:143]
  ds_read_b64_tr_b16 v[230:231], v250 offset:15424
  v_cvt_pk_bf16_f32 v48, v36, v37
  v_cvt_pk_bf16_f32 v49, v38, v39
  s_waitcnt lgkmcnt(12)
  v_mfma_f32_16x16x32_bf16 a[136:139], v[204:207], v[120:123], a[136:139]
  ds_read_b64_tr_b16 v[232:233], v250 offset:20544
  v_accvgpr_read_b32 v40, a132
  v_accvgpr_read_b32 v41, a133
  v_mfma_f32_16x16x32_bf16 a[140:143], v[204:207], v[124:127], a[140:143]
  ds_read_b64_tr_b16 v[234:235], v250 offset:25664
  v_accvgpr_read_b32 v42, a134
  v_accvgpr_read_b32 v43, a135
  s_waitcnt lgkmcnt(12)
  v_mfma_f32_16x16x32_bf16 a[144:147], v[208:211], v[96:99], a[144:147]
  ds_read_b64_tr_b16 v[236:237], v250 offset:30784
  v_cvt_pk_bf16_f32 v50, v40, v41
  v_cvt_pk_bf16_f32 v51, v42, v43
  v_mfma_f32_16x16x32_bf16 a[148:151], v[208:211], v[100:103], a[148:151]
  ds_read_b64_tr_b16 v[238:239], v250 offset:35904
  buffer_store_dwordx4 v[48:51], v10, s[20:23], s28 offen sc1
  v_accvgpr_read_b32 v36, a136
  s_waitcnt lgkmcnt(12)
  v_mfma_f32_16x16x32_bf16 a[144:147], v[212:215], v[104:107], a[144:147]
  ds_read_b64_tr_b16 v[176:177], v9 offset:128
  v_accvgpr_read_b32 v37, a137
  v_accvgpr_read_b32 v38, a138
  v_mfma_f32_16x16x32_bf16 a[148:151], v[212:215], v[108:111], a[148:151]
  ds_read_b64_tr_b16 v[178:179], v9 offset:5248
  v_accvgpr_read_b32 v39, a139
  v_cvt_pk_bf16_f32 v52, v36, v37
  s_waitcnt lgkmcnt(12)
  v_mfma_f32_16x16x32_bf16 a[144:147], v[216:219], v[112:115], a[144:147]
  ds_read_b64_tr_b16 v[180:181], v9 offset:10368
  v_cvt_pk_bf16_f32 v53, v38, v39
  v_accvgpr_read_b32 v40, a140
  v_mfma_f32_16x16x32_bf16 a[148:151], v[216:219], v[116:119], a[148:151]
  ds_read_b64_tr_b16 v[182:183], v9 offset:15488
  v_accvgpr_read_b32 v41, a141
  v_accvgpr_read_b32 v42, a142
  s_waitcnt lgkmcnt(12)
  v_mfma_f32_16x16x32_bf16 a[144:147], v[220:223], v[120:123], a[144:147]
  ds_read_b64_tr_b16 v[184:185], v9 offset:20608
  v_accvgpr_read_b32 v43, a143
  v_cvt_pk_bf16_f32 v54, v40, v41
  v_mfma_f32_16x16x32_bf16 a[148:151], v[220:223], v[124:127], a[148:151]
  ds_read_b64_tr_b16 v[186:187], v9 offset:25728
  v_cvt_pk_bf16_f32 v55, v42, v43
  buffer_store_dwordx4 v[52:55], v10, s[20:23], s28 offen offset:1024 sc1
  s_waitcnt lgkmcnt(12)
  v_mfma_f32_16x16x32_bf16 a[152:155], v[224:227], v[96:99], a[152:155]
  ds_read_b64_tr_b16 v[188:189], v9 offset:30848
  v_mfma_f32_16x16x32_bf16 a[156:159], v[224:227], v[100:103], a[156:159]
  ds_read_b64_tr_b16 v[190:191], v9 offset:35968
  s_waitcnt lgkmcnt(12)
  v_mfma_f32_16x16x32_bf16 a[152:155], v[228:231], v[104:107], a[152:155]
  ds_read_b64_tr_b16 v[192:193], v250 offset:128
  v_accvgpr_read_b32 v36, a144
  v_accvgpr_read_b32 v37, a145
  v_mfma_f32_16x16x32_bf16 a[156:159], v[228:231], v[108:111], a[156:159]
  ds_read_b64_tr_b16 v[194:195], v250 offset:5248
  v_accvgpr_read_b32 v38, a146
  v_accvgpr_read_b32 v39, a147
  s_waitcnt lgkmcnt(12)
  v_mfma_f32_16x16x32_bf16 a[152:155], v[232:235], v[112:115], a[152:155]
  ds_read_b64_tr_b16 v[196:197], v250 offset:10368
  v_cvt_pk_bf16_f32 v56, v36, v37
  v_cvt_pk_bf16_f32 v57, v38, v39
  v_mfma_f32_16x16x32_bf16 a[156:159], v[232:235], v[116:119], a[156:159]
  ds_read_b64_tr_b16 v[198:199], v250 offset:15488
  v_accvgpr_read_b32 v40, a148
  v_accvgpr_read_b32 v41, a149
  s_waitcnt lgkmcnt(12)
  v_mfma_f32_16x16x32_bf16 a[152:155], v[236:239], v[120:123], a[152:155]
  ds_read_b64_tr_b16 v[200:201], v250 offset:20608
  v_accvgpr_read_b32 v42, a150
  v_accvgpr_read_b32 v43, a151
  v_mfma_f32_16x16x32_bf16 a[156:159], v[236:239], v[124:127], a[156:159]
  ds_read_b64_tr_b16 v[202:203], v250 offset:25728
  v_cvt_pk_bf16_f32 v60, v40, v41
  v_cvt_pk_bf16_f32 v61, v42, v43
  s_waitcnt lgkmcnt(12)
  v_mfma_f32_16x16x32_bf16 a[160:163], v[176:179], v[96:99], a[160:163]
  ds_read_b64_tr_b16 v[204:205], v250 offset:30848
  buffer_store_dwordx2 v[56:57], v248, s[20:23], s28 offen offset:2048 sc1
  v_mfma_f32_16x16x32_bf16 a[164:167], v[176:179], v[100:103], a[164:167]
  ds_read_b64_tr_b16 v[206:207], v250 offset:35968
  s_waitcnt lgkmcnt(12)
  v_mfma_f32_16x16x32_bf16 a[160:163], v[180:183], v[104:107], a[160:163]
  ds_read_b64_tr_b16 v[208:209], v9 offset:192
  v_accvgpr_read_b32 v36, a152
  v_accvgpr_read_b32 v37, a153
  v_mfma_f32_16x16x32_bf16 a[164:167], v[180:183], v[108:111], a[164:167]
  ds_read_b64_tr_b16 v[210:211], v9 offset:5312
  v_accvgpr_read_b32 v38, a154
  v_accvgpr_read_b32 v39, a155
  s_waitcnt lgkmcnt(12)
  v_mfma_f32_16x16x32_bf16 a[160:163], v[184:187], v[112:115], a[160:163]
  ds_read_b64_tr_b16 v[212:213], v9 offset:10432
  v_cvt_pk_bf16_f32 v62, v36, v37
  v_cvt_pk_bf16_f32 v63, v38, v39
  v_mfma_f32_16x16x32_bf16 a[164:167], v[184:187], v[116:119], a[164:167]
  ds_read_b64_tr_b16 v[214:215], v9 offset:15552
  v_accvgpr_read_b32 v40, a156
  v_accvgpr_read_b32 v41, a157
  s_waitcnt lgkmcnt(12)
  v_mfma_f32_16x16x32_bf16 a[160:163], v[188:191], v[120:123], a[160:163]
  ds_read_b64_tr_b16 v[216:217], v9 offset:20672
  v_accvgpr_read_b32 v42, a158
  v_accvgpr_read_b32 v43, a159
  v_mfma_f32_16x16x32_bf16 a[164:167], v[188:191], v[124:127], a[164:167]
  ds_read_b64_tr_b16 v[218:219], v9 offset:25792
  v_cvt_pk_bf16_f32 v64, v40, v41
  v_cvt_pk_bf16_f32 v65, v42, v43
  s_waitcnt lgkmcnt(12)
  v_mfma_f32_16x16x32_bf16 a[168:171], v[192:195], v[96:99], a[168:171]
  ds_read_b64_tr_b16 v[220:221], v9 offset:30912
  buffer_store_dwordx4 v[60:63], v10, s[20:23], s29 offen sc1
  v_mfma_f32_16x16x32_bf16 a[172:175], v[192:195], v[100:103], a[172:175]
  ds_read_b64_tr_b16 v[222:223], v9 offset:36032
  s_waitcnt lgkmcnt(12)
  v_mfma_f32_16x16x32_bf16 a[168:171], v[196:199], v[104:107], a[168:171]
  ds_read_b64_tr_b16 v[224:225], v250 offset:192
  v_accvgpr_read_b32 v36, a160
  v_accvgpr_read_b32 v37, a161
  v_mfma_f32_16x16x32_bf16 a[172:175], v[196:199], v[108:111], a[172:175]
  ds_read_b64_tr_b16 v[226:227], v250 offset:5312
  v_accvgpr_read_b32 v38, a162
  v_accvgpr_read_b32 v39, a163
  s_waitcnt lgkmcnt(12)
  v_mfma_f32_16x16x32_bf16 a[168:171], v[200:203], v[112:115], a[168:171]
  ds_read_b64_tr_b16 v[228:229], v250 offset:10432
  v_cvt_pk_bf16_f32 v66, v36, v37
  v_cvt_pk_bf16_f32 v67, v38, v39
  v_mfma_f32_16x16x32_bf16 a[172:175], v[200:203], v[116:119], a[172:175]
  ds_read_b64_tr_b16 v[230:231], v250 offset:15552
  v_accvgpr_read_b32 v40, a164
  v_accvgpr_read_b32 v41, a165
  s_waitcnt lgkmcnt(12)
  v_mfma_f32_16x16x32_bf16 a[168:171], v[204:207], v[120:123], a[168:171]
  ds_read_b64_tr_b16 v[232:233], v250 offset:20672
  v_accvgpr_read_b32 v42, a166
  v_accvgpr_read_b32 v43, a167
  v_mfma_f32_16x16x32_bf16 a[172:175], v[204:207], v[124:127], a[172:175]
  ds_read_b64_tr_b16 v[234:235], v250 offset:25792
  v_cvt_pk_bf16_f32 v68, v40, v41
  v_cvt_pk_bf16_f32 v69, v42, v43
  s_waitcnt lgkmcnt(12)
  v_mfma_f32_16x16x32_bf16 a[176:179], v[208:211], v[96:99], a[176:179]
  ds_read_b64_tr_b16 v[236:237], v250 offset:30912
  buffer_store_dwordx4 v[64:67], v10, s[20:23], s29 offen offset:1024 sc1
  buffer_store_dwordx2 v[68:69], v248, s[20:23], s29 offen offset:2048 sc1
  v_mfma_f32_16x16x32_bf16 a[180:183], v[208:211], v[100:103], a[180:183]
  ds_read_b64_tr_b16 v[238:239], v250 offset:36032
  v_accvgpr_read_b32 v36, a168
  v_accvgpr_read_b32 v37, a169
  s_waitcnt lgkmcnt(12)
  v_mfma_f32_16x16x32_bf16 a[176:179], v[212:215], v[104:107], a[176:179]
  ds_read_b64_tr_b16 v[176:177], v9 offset:256
  v_accvgpr_read_b32 v38, a170
  v_accvgpr_read_b32 v39, a171
  v_mfma_f32_16x16x32_bf16 a[180:183], v[212:215], v[108:111], a[180:183]
  ds_read_b64_tr_b16 v[178:179], v9 offset:5376
  v_cvt_pk_bf16_f32 v72, v36, v37
  v_cvt_pk_bf16_f32 v73, v38, v39
  s_waitcnt lgkmcnt(12)
  v_mfma_f32_16x16x32_bf16 a[176:179], v[216:219], v[112:115], a[176:179]
  ds_read_b64_tr_b16 v[180:181], v9 offset:10496
  v_accvgpr_read_b32 v40, a172
  v_accvgpr_read_b32 v41, a173
  v_mfma_f32_16x16x32_bf16 a[180:183], v[216:219], v[116:119], a[180:183]
  ds_read_b64_tr_b16 v[182:183], v9 offset:15616
  v_accvgpr_read_b32 v42, a174
  v_accvgpr_read_b32 v43, a175
  s_waitcnt lgkmcnt(12)
  v_mfma_f32_16x16x32_bf16 a[176:179], v[220:223], v[120:123], a[176:179]
  ds_read_b64_tr_b16 v[184:185], v9 offset:20736
  v_cvt_pk_bf16_f32 v74, v40, v41
  v_cvt_pk_bf16_f32 v75, v42, v43
  v_mfma_f32_16x16x32_bf16 a[180:183], v[220:223], v[124:127], a[180:183]
  ds_read_b64_tr_b16 v[186:187], v9 offset:25856
  buffer_store_dwordx4 v[72:75], v10, s[20:23], s30 offen sc1
  s_waitcnt lgkmcnt(12)
  v_mfma_f32_16x16x32_bf16 a[184:187], v[224:227], v[96:99], a[184:187]
  ds_read_b64_tr_b16 v[188:189], v9 offset:30976
  v_mfma_f32_16x16x32_bf16 a[188:191], v[224:227], v[100:103], a[188:191]
  ds_read_b64_tr_b16 v[190:191], v9 offset:36096
  s_waitcnt lgkmcnt(12)
  v_mfma_f32_16x16x32_bf16 a[184:187], v[228:231], v[104:107], a[184:187]
  ds_read_b64_tr_b16 v[192:193], v250 offset:256
  v_accvgpr_read_b32 v36, a176
  v_accvgpr_read_b32 v37, a177
  v_mfma_f32_16x16x32_bf16 a[188:191], v[228:231], v[108:111], a[188:191]
  ds_read_b64_tr_b16 v[194:195], v250 offset:5376
  v_accvgpr_read_b32 v38, a178
  v_accvgpr_read_b32 v39, a179
  s_waitcnt lgkmcnt(12)
  v_mfma_f32_16x16x32_bf16 a[184:187], v[232:235], v[112:115], a[184:187]
  ds_read_b64_tr_b16 v[196:197], v250 offset:10496
  v_cvt_pk_bf16_f32 v76, v36, v37
  v_cvt_pk_bf16_f32 v77, v38, v39
  v_mfma_f32_16x16x32_bf16 a[188:191], v[232:235], v[116:119], a[188:191]
  ds_read_b64_tr_b16 v[198:199], v250 offset:15616
  v_accvgpr_read_b32 v40, a180
  v_accvgpr_read_b32 v41, a181
  s_waitcnt lgkmcnt(12)
  v_mfma_f32_16x16x32_bf16 a[184:187], v[236:239], v[120:123], a[184:187]
  ds_read_b64_tr_b16 v[200:201], v250 offset:20736
  v_accvgpr_read_b32 v42, a182
  v_accvgpr_read_b32 v43, a183
  v_mfma_f32_16x16x32_bf16 a[188:191], v[236:239], v[124:127], a[188:191]
  ds_read_b64_tr_b16 v[202:203], v250 offset:25856
  v_cvt_pk_bf16_f32 v78, v40, v41
  v_cvt_pk_bf16_f32 v79, v42, v43
  s_waitcnt lgkmcnt(12)
  v_mfma_f32_16x16x32_bf16 a[192:195], v[176:179], v[96:99], a[192:195]
  ds_read_b64_tr_b16 v[204:205], v250 offset:30976
  buffer_store_dwordx4 v[76:79], v10, s[20:23], s30 offen offset:1024 sc1
  v_mfma_f32_16x16x32_bf16 a[196:199], v[176:179], v[100:103], a[196:199]
  ds_read_b64_tr_b16 v[206:207], v250 offset:36096
  s_waitcnt lgkmcnt(12)
  v_mfma_f32_16x16x32_bf16 a[192:195], v[180:183], v[104:107], a[192:195]
  v_accvgpr_read_b32 v36, a184
  v_accvgpr_read_b32 v37, a185
  v_mfma_f32_16x16x32_bf16 a[196:199], v[180:183], v[108:111], a[196:199]
  v_accvgpr_read_b32 v38, a186
  v_accvgpr_read_b32 v39, a187
  s_waitcnt lgkmcnt(10)
  v_mfma_f32_16x16x32_bf16 a[192:195], v[184:187], v[112:115], a[192:195]
  v_cvt_pk_bf16_f32 v80, v36, v37
  v_cvt_pk_bf16_f32 v81, v38, v39
  v_mfma_f32_16x16x32_bf16 a[196:199], v[184:187], v[116:119], a[196:199]
  v_accvgpr_read_b32 v16, a188
  v_accvgpr_read_b32 v17, a189
  s_waitcnt lgkmcnt(8)
  v_mfma_f32_16x16x32_bf16 a[192:195], v[188:191], v[120:123], a[192:195]
  v_accvgpr_read_b32 v18, a190
  v_accvgpr_read_b32 v19, a191
  v_mfma_f32_16x16x32_bf16 a[196:199], v[188:191], v[124:127], a[196:199]
  buffer_store_dwordx2 v[80:81], v248, s[20:23], s30 offen offset:2048 sc1
  s_waitcnt lgkmcnt(6)
  v_mfma_f32_16x16x32_bf16 a[200:203], v[192:195], v[96:99], a[200:203]
  v_mfma_f32_16x16x32_bf16 a[204:207], v[192:195], v[100:103], a[204:207]
  s_waitcnt lgkmcnt(4)
  v_mfma_f32_16x16x32_bf16 a[200:203], v[196:199], v[104:107], a[200:203]
  v_mfma_f32_16x16x32_bf16 a[204:207], v[196:199], v[108:111], a[204:207]
  s_waitcnt lgkmcnt(2)
  v_mfma_f32_16x16x32_bf16 a[200:203], v[200:203], v[112:115], a[200:203]
  v_accvgpr_read_b32 v20, a192
  v_accvgpr_read_b32 v21, a193
  v_mfma_f32_16x16x32_bf16 a[204:207], v[200:203], v[116:119], a[204:207]
  v_accvgpr_read_b32 v22, a194
  v_accvgpr_read_b32 v23, a195
  s_waitcnt lgkmcnt(0)
  v_mfma_f32_16x16x32_bf16 a[200:203], v[204:207], v[120:123], a[200:203]
  v_accvgpr_read_b32 v24, a196
  v_accvgpr_read_b32 v25, a197
  v_mfma_f32_16x16x32_bf16 a[204:207], v[204:207], v[124:127], a[204:207]
  v_accvgpr_read_b32 v26, a198
  v_accvgpr_read_b32 v27, a199
  s_nop 6
  v_accvgpr_read_b32 v28, a200
  v_accvgpr_read_b32 v29, a201
  v_accvgpr_read_b32 v30, a202
  v_accvgpr_read_b32 v31, a203
  v_accvgpr_read_b32 v32, a204
  v_accvgpr_read_b32 v33, a205
  v_accvgpr_read_b32 v34, a206
  v_accvgpr_read_b32 v35, a207
L_lastd:
  s_waitcnt vmcnt(0)
  s_mov_b64 exec, 1
  v_mov_b32 v158, 0
  buffer_store_dwordx2 v[12:13], v158, s[20:23], s57 offen offset:256 sc1
  s_mov_b64 exec, -1
  s_mov_b32 s59, 0
L_px:
  s_mov_b32 s46, 25166080
  buffer_load_dwordx2 v[14:15], v11, s[20:23], s46 offen sc1
  s_waitcnt vmcnt(0)
  v_cmp_ne_u64 vcc, v[14:15], v[12:13]
  s_cbranch_vccz L_pd
  s_add_u32 s59, s59, 1
  s_cmp_lt_u32 s59, 0x200000
  s_cbranch_scc1 L_px
L_pd:
  buffer_load_dwordx4 v[100:103], v10, s[20:23], s31 offen sc1
  buffer_load_dwordx4 v[104:107], v10, s[20:23], s31 offen offset:1024 sc1
  buffer_load_dwordx2 v[108:109], v248, s[20:23], s31 offen offset:2048 sc1
  buffer_load_dwordx4 v[112:115], v10, s[20:23], s32 offen sc1
  buffer_load_dwordx4 v[116:119], v10, s[20:23], s32 offen offset:1024 sc1
  buffer_load_dwordx2 v[120:121], v248, s[20:23], s32 offen offset:2048 sc1
  buffer_load_dwordx4 v[124:127], v10, s[20:23], s33 offen sc1
  buffer_load_dwordx4 v[128:131], v10, s[20:23], s33 offen offset:1024 sc1
  buffer_load_dwordx2 v[132:133], v248, s[20:23], s33 offen offset:2048 sc1
  v_mov_b32 v158, 0xffff0000
  s_mul_i32 s48, s41, 5
  s_add_u32 s46, s48, 0
  s_and_b32 s47, s46, 1
  s_mul_i32 s47, s47, 40960
  s_lshr_b32 s46, s46, 1
  s_lshl_b32 s46, s46, 5
  s_add_u32 s46, s46, s47
  s_add_u32 s35, s46, s34
  s_add_u32 s46, s48, 1
  s_and_b32 s47, s46, 1
  s_mul_i32 s47, s47, 40960
  s_lshr_b32 s46, s46, 1
  s_lshl_b32 s46, s46, 5
  s_add_u32 s46, s46, s47
  s_add_u32 s36, s46, s34
  s_add_u32 s46, s48, 2
  s_and_b32 s47, s46, 1
  s_mul_i32 s47, s47, 40960
  s_lshr_b32 s46, s46, 1
  s_lshl_b32 s46, s46, 5
  s_add_u32 s46, s46, s47
  s_add_u32 s37, s46, s34
  s_add_u32 s46, s48, 3
  s_and_b32 s47, s46, 1
  s_mul_i32 s47, s47, 40960
  s_lshr_b32 s46, s46, 1
  s_lshl_b32 s46, s46, 5
  s_add_u32 s46, s46, s47
  s_add_u32 s38, s46, s34
  s_add_u32 s46, s48, 4
  s_and_b32 s47, s46, 1
  s_mul_i32 s47, s47, 40960
  s_lshr_b32 s46, s46, 1
  s_lshl_b32 s46, s46, 5
  s_add_u32 s46, s46, s47
  s_add_u32 s39, s46, s34
  s_waitcnt vmcnt(6)
  v_lshlrev_b32 v176, 16, v100
  v_and_b32 v177, v158, v100
  v_lshlrev_b32 v178, 16, v101
  v_and_b32 v179, v158, v101
  v_lshlrev_b32 v180, 16, v102
  v_and_b32 v181, v158, v102
  v_lshlrev_b32 v182, 16, v103
  v_and_b32 v183, v158, v103
  v_lshlrev_b32 v184, 16, v104
  v_and_b32 v185, v158, v104
  v_lshlrev_b32 v186, 16, v105
  v_and_b32 v187, v158, v105
  v_lshlrev_b32 v188, 16, v106
  v_and_b32 v189, v158, v106
  v_lshlrev_b32 v190, 16, v107
  v_and_b32 v191, v158, v107
  v_lshlrev_b32 v192, 16, v108
  v_and_b32 v193, v158, v108
  v_lshlrev_b32 v194, 16, v109
  v_and_b32 v195, v158, v109
  v_pk_add_f32 v[16:17], v[16:17], v[176:177]
  v_pk_add_f32 v[18:19], v[18:19], v[178:179]
  v_pk_add_f32 v[20:21], v[20:21], v[180:181]
  v_pk_add_f32 v[22:23], v[22:23], v[182:183]
  v_pk_add_f32 v[24:25], v[24:25], v[184:185]
  v_pk_add_f32 v[26:27], v[26:27], v[186:187]
  v_pk_add_f32 v[28:29], v[28:29], v[188:189]
  v_pk_add_f32 v[30:31], v[30:31], v[190:191]
  v_pk_add_f32 v[32:33], v[32:33], v[192:193]
  v_pk_add_f32 v[34:35], v[34:35], v[194:195]
  s_waitcnt vmcnt(3)
  v_lshlrev_b32 v176, 16, v112
  v_and_b32 v177, v158, v112
  v_lshlrev_b32 v178, 16, v113
  v_and_b32 v179, v158, v113
  v_lshlrev_b32 v180, 16, v114
  v_and_b32 v181, v158, v114
  v_lshlrev_b32 v182, 16, v115
  v_and_b32 v183, v158, v115
  v_lshlrev_b32 v184, 16, v116
  v_and_b32 v185, v158, v116
  v_lshlrev_b32 v186, 16, v117
  v_and_b32 v187, v158, v117
  v_lshlrev_b32 v188, 16, v118
  v_and_b32 v189, v158, v118
  v_lshlrev_b32 v190, 16, v119
  v_and_b32 v191, v158, v119
  v_lshlrev_b32 v192, 16, v120
  v_and_b32 v193, v158, v120
  v_lshlrev_b32 v194, 16, v121
  v_and_b32 v195, v158, v121
  v_pk_add_f32 v[16:17], v[16:17], v[176:177]
  v_pk_add_f32 v[18:19], v[18:19], v[178:179]
  v_pk_add_f32 v[20:21], v[20:21], v[180:181]
  v_pk_add_f32 v[22:23], v[22:23], v[182:183]
  v_pk_add_f32 v[24:25], v[24:25], v[184:185]
  v_pk_add_f32 v[26:27], v[26:27], v[186:187]
  v_pk_add_f32 v[28:29], v[28:29], v[188:189]
  v_pk_add_f32 v[30:31], v[30:31], v[190:191]
  v_pk_add_f32 v[32:33], v[32:33], v[192:193]
  v_pk_add_f32 v[34:35], v[34:35], v[194:195]
  s_waitcnt vmcnt(0)
  v_lshlrev_b32 v176, 16, v124
  v_and_b32 v177, v158, v124
  v_lshlrev_b32 v178, 16, v125
  v_and_b32 v179, v158, v125
  v_lshlrev_b32 v180, 16, v126
  v_and_b32 v181, v158, v126
  v_lshlrev_b32 v182, 16, v127
  v_and_b32 v183, v158, v127
  v_lshlrev_b32 v184, 16, v128
  v_and_b32 v185, v158, v128
  v_lshlrev_b32 v186, 16, v129
  v_and_b32 v187, v158, v129
  v_lshlrev_b32 v188, 16, v130
  v_and_b32 v189, v158, v130
  v_lshlrev_b32 v190, 16, v131
  v_and_b32 v191, v158, v131
  v_lshlrev_b32 v192, 16, v132
  v_and_b32 v193, v158, v132
  v_lshlrev_b32 v194, 16, v133
  v_and_b32 v195, v158, v133
  v_pk_add_f32 v[16:17], v[16:17], v[176:177]
  v_pk_add_f32 v[18:19], v[18:19], v[178:179]
  v_pk_add_f32 v[20:21], v[20:21], v[180:181]
  v_pk_add_f32 v[22:23], v[22:23], v[182:183]
  v_pk_add_f32 v[24:25], v[24:25], v[184:185]
  v_pk_add_f32 v[26:27], v[26:27], v[186:187]
  v_pk_add_f32 v[28:29], v[28:29], v[188:189]
  v_pk_add_f32 v[30:31], v[30:31], v[190:191]
  v_pk_add_f32 v[32:33], v[32:33], v[192:193]
  v_pk_add_f32 v[34:35], v[34:35], v[194:195]
  v_cvt_pk_bf16_f32 v64, v16, v17
  v_cvt_pk_bf16_f32 v65, v18, v19
  buffer_store_dwordx2 v[64:65], v249, s[24:27], s35 offen
  v_cvt_pk_bf16_f32 v66, v20, v21
  v_cvt_pk_bf16_f32 v67, v22, v23
  buffer_store_dwordx2 v[66:67], v249, s[24:27], s36 offen
  v_cvt_pk_bf16_f32 v68, v24, v25
  v_cvt_pk_bf16_f32 v69, v26, v27
  buffer_store_dwordx2 v[68:69], v249, s[24:27], s37 offen
  v_cvt_pk_bf16_f32 v70, v28, v29
  v_cvt_pk_bf16_f32 v71, v30, v31
  buffer_store_dwordx2 v[70:71], v249, s[24:27], s38 offen
  v_cvt_pk_bf16_f32 v72, v32, v33
  v_cvt_pk_bf16_f32 v73, v34, v35
  buffer_store_dwordx2 v[72:73], v249, s[24:27], s39 offen
  s_endpgm
L_wq_block:
  s_mov_b32 s56, 1
  v_add_u32 v152, s50, v166
  v_add_u32 v56, s50, v165
  v_xor_b32 v57, 32, v56
  v_xor_b32 v58, 64, v56
  v_xor_b32 v59, 96, v56
  v_xor_b32 v60, 128, v56
  v_xor_b32 v61, 160, v56
  v_xor_b32 v62, 192, v56
  v_xor_b32 v63, 224, v56
  v_add_u32 v153, s50, v167
  ds_read_b128 a[160:163], v152 offset:0
  ds_read_b128 a[164:167], v152 offset:2048
  ds_read_b64_tr_b16 a[128:129], v56 offset:0
  ds_read_b64_tr_b16 a[130:131], v56 offset:1024
  ds_read_b64_tr_b16 a[132:133], v57 offset:0
  ds_read_b64_tr_b16 a[134:135], v57 offset:1024
  ds_read_b64_tr_b16 a[136:137], v58 offset:0
  ds_read_b64_tr_b16 a[138:139], v58 offset:1024
  ds_read_b64_tr_b16 a[140:141], v59 offset:0
  ds_read_b64_tr_b16 a[142:143], v59 offset:1024
  ds_read_b64_tr_b16 a[144:145], v60 offset:0
  ds_read_b64_tr_b16 a[146:147], v60 offset:1024
  ds_read_b64_tr_b16 a[148:149], v61 offset:0
  ds_read_b64_tr_b16 a[150:151], v61 offset:1024
  ds_read_b64_tr_b16 a[152:153], v62 offset:0
  ds_read_b64_tr_b16 a[154:155], v62 offset:1024
  ds_read_b64_tr_b16 a[156:157], v63 offset:0
  ds_read_b64_tr_b16 a[158:159], v63 offset:1024
  s_add_u32 s50, s50, 40960
  s_cmp_eq_u32 s50, 163840
  s_cselect_b32 s50, 0, s50
  s_waitcnt lgkmcnt(0)
  v_mfma_f32_16x16x32_bf16 v[176:179], a[128:131], a[160:163], 0
  ds_read_b128 a[200:203], v153 offset:0
  ds_read_b128 a[204:207], v153 offset:2048
  v_mfma_f32_16x16x32_bf16 v[180:183], a[128:131], a[164:167], 0
  ds_read_b64_tr_b16 a[168:169], v56 offset:8192
  v_mfma_f32_16x16x32_bf16 v[184:187], a[132:135], a[160:163], 0
  ds_read_b64_tr_b16 a[170:171], v56 offset:9216
  ds_read_b64_tr_b16 a[172:173], v57 offset:8192
  v_mfma_f32_16x16x32_bf16 v[188:191], a[132:135], a[164:167], 0
  ds_read_b64_tr_b16 a[174:175], v57 offset:9216
  v_mfma_f32_16x16x32_bf16 v[192:195], a[136:139], a[160:163], 0
  ds_read_b64_tr_b16 a[176:177], v58 offset:8192
  ds_read_b64_tr_b16 a[178:179], v58 offset:9216
  v_mfma_f32_16x16x32_bf16 v[196:199], a[136:139], a[164:167], 0
  ds_read_b64_tr_b16 a[180:181], v59 offset:8192
  v_mfma_f32_16x16x32_bf16 v[200:203], a[140:143], a[160:163], 0
  ds_read_b64_tr_b16 a[182:183], v59 offset:9216
  ds_read_b64_tr_b16 a[184:185], v60 offset:8192
  v_mfma_f32_16x16x32_bf16 v[204:207], a[140:143], a[164:167], 0
  ds_read_b64_tr_b16 a[186:187], v60 offset:9216
  v_mfma_f32_16x16x32_bf16 v[208:211], a[144:147], a[160:163], 0
  ds_read_b64_tr_b16 a[188:189], v61 offset:8192
  ds_read_b64_tr_b16 a[190:191], v61 offset:9216
  v_mfma_f32_16x16x32_bf16 v[212:215], a[144:147], a[164:167], 0
  ds_read_b64_tr_b16 a[192:193], v62 offset:8192
  v_mfma_f32_16x16x32_bf16 v[216:219], a[148:151], a[160:163], 0
  ds_read_b64_tr_b16 a[194:195], v62 offset:9216
  ds_read_b64_tr_b16 a[196:197], v63 offset:8192
  v_mfma_f32_16x16x32_bf16 v[220:223], a[148:151], a[164:167], 0
  ds_read_b64_tr_b16 a[198:199], v63 offset:9216
  v_mfma_f32_16x16x32_bf16 v[224:227], a[152:155], a[160:163], 0
  v_mfma_f32_16x16x32_bf16 v[228:231], a[152:155], a[164:167], 0
  v_mfma_f32_16x16x32_bf16 v[232:235], a[156:159], a[160:163], 0
  s_waitcnt lgkmcnt(0)
  v_mfma_f32_16x16x32_bf16 v[236:239], a[156:159], a[164:167], 0
  s_barrier
L_wq_loop:
  v_mfma_f32_16x16x32_bf16 v[176:179], a[168:171], a[200:203], v[176:179]
  v_add_u32 v152, s50, v166
  ds_read_b128 a[160:163], v152 offset:0
  v_mfma_f32_16x16x32_bf16 v[180:183], a[168:171], a[204:207], v[180:183]
  v_add_u32 v56, s50, v165
  ds_read_b128 a[164:167], v152 offset:2048
  v_mfma_f32_16x16x32_bf16 v[184:187], a[172:175], a[200:203], v[184:187]
  v_xor_b32 v57, 32, v56
  ds_read_b64_tr_b16 a[128:129], v56 offset:0
  v_mfma_f32_16x16x32_bf16 v[188:191], a[172:175], a[204:207], v[188:191]
  ds_read_b64_tr_b16 a[130:131], v56 offset:1024
  v_xor_b32 v58, 64, v56
  ds_read_b64_tr_b16 a[132:133], v57 offset:0
  v_mfma_f32_16x16x32_bf16 v[192:195], a[176:179], a[200:203], v[192:195]
  ds_read_b64_tr_b16 a[134:135], v57 offset:1024
  v_xor_b32 v59, 96, v56
  v_mfma_f32_16x16x32_bf16 v[196:199], a[176:179], a[204:207], v[196:199]
  ds_read_b64_tr_b16 a[136:137], v58 offset:0
  ds_read_b64_tr_b16 a[138:139], v58 offset:1024
  v_mfma_f32_16x16x32_bf16 v[200:203], a[180:183], a[200:203], v[200:203]
  v_xor_b32 v60, 128, v56
  ds_read_b64_tr_b16 a[140:141], v59 offset:0
  v_mfma_f32_16x16x32_bf16 v[204:207], a[180:183], a[204:207], v[204:207]
  ds_read_b64_tr_b16 a[142:143], v59 offset:1024
  v_xor_b32 v61, 160, v56
  v_mfma_f32_16x16x32_bf16 v[208:211], a[184:187], a[200:203], v[208:211]
  ds_read_b64_tr_b16 a[144:145], v60 offset:0
  ds_read_b64_tr_b16 a[146:147], v60 offset:1024
  v_mfma_f32_16x16x32_bf16 v[212:215], a[184:187], a[204:207], v[212:215]
  v_xor_b32 v62, 192, v56
  ds_read_b64_tr_b16 a[148:149], v61 offset:0
  ds_read_b64_tr_b16 a[150:151], v61 offset:1024
  v_mfma_f32_16x16x32_bf16 v[216:219], a[188:191], a[200:203], v[216:219]
  v_xor_b32 v63, 224, v56
  ds_read_b64_tr_b16 a[152:153], v62 offset:0
  v_mfma_f32_16x16x32_bf16 v[220:223], a[188:191], a[204:207], v[220:223]
  ds_read_b64_tr_b16 a[154:155], v62 offset:1024
  v_add_u32 v153, s50, v167
  v_mfma_f32_16x16x32_bf16 v[224:227], a[192:195], a[200:203], v[224:227]
  ds_read_b64_tr_b16 a[156:157], v63 offset:0
  ds_read_b64_tr_b16 a[158:159], v63 offset:1024
  v_mfma_f32_16x16x32_bf16 v[228:231], a[192:195], a[204:207], v[228:231]
  v_mfma_f32_16x16x32_bf16 v[232:235], a[196:199], a[200:203], v[232:235]
  v_mfma_f32_16x16x32_bf16 v[236:239], a[196:199], a[204:207], v[236:239]
  s_waitcnt lgkmcnt(0)
  v_mfma_f32_16x16x32_bf16 v[176:179], a[128:131], a[160:163], v[176:179]
  ds_read_b128 a[200:203], v153 offset:0
  ds_read_b128 a[204:207], v153 offset:2048
  v_mfma_f32_16x16x32_bf16 v[180:183], a[128:131], a[164:167], v[180:183]
  ds_read_b64_tr_b16 a[168:169], v56 offset:8192
  ds_read_b64_tr_b16 a[170:171], v56 offset:9216
  v_mfma_f32_16x16x32_bf16 v[184:187], a[132:135], a[160:163], v[184:187]
  ds_read_b64_tr_b16 a[172:173], v57 offset:8192
  v_mfma_f32_16x16x32_bf16 v[188:191], a[132:135], a[164:167], v[188:191]
  ds_read_b64_tr_b16 a[174:175], v57 offset:9216
  ds_read_b64_tr_b16 a[176:177], v58 offset:8192
  v_mfma_f32_16x16x32_bf16 v[192:195], a[136:139], a[160:163], v[192:195]
  ds_read_b64_tr_b16 a[178:179], v58 offset:9216
  ds_read_b64_tr_b16 a[180:181], v59 offset:8192
  v_mfma_f32_16x16x32_bf16 v[196:199], a[136:139], a[164:167], v[196:199]
  ds_read_b64_tr_b16 a[182:183], v59 offset:9216
  ds_read_b64_tr_b16 a[184:185], v60 offset:8192
  v_mfma_f32_16x16x32_bf16 v[200:203], a[140:143], a[160:163], v[200:203]
  ds_read_b64_tr_b16 a[186:187], v60 offset:9216
  v_mfma_f32_16x16x32_bf16 v[204:207], a[140:143], a[164:167], v[204:207]
  ds_read_b64_tr_b16 a[188:189], v61 offset:8192
  ds_read_b64_tr_b16 a[190:191], v61 offset:9216
  v_mfma_f32_16x16x32_bf16 v[208:211], a[144:147], a[160:163], v[208:211]
  ds_read_b64_tr_b16 a[192:193], v62 offset:8192
  ds_read_b64_tr_b16 a[194:195], v62 offset:9216
  v_mfma_f32_16x16x32_bf16 v[212:215], a[144:147], a[164:167], v[212:215]
  ds_read_b64_tr_b16 a[196:197], v63 offset:8192
  ds_read_b64_tr_b16 a[198:199], v63 offset:9216
  v_mfma_f32_16x16x32_bf16 v[216:219], a[148:151], a[160:163], v[216:219]
  s_add_u32 s50, s50, 40960
  v_mfma_f32_16x16x32_bf16 v[220:223], a[148:151], a[164:167], v[220:223]
  s_cmp_eq_u32 s50, 163840
  s_cselect_b32 s50, 0, s50
  v_mfma_f32_16x16x32_bf16 v[224:227], a[152:155], a[160:163], v[224:227]
  v_mfma_f32_16x16x32_bf16 v[228:231], a[152:155], a[164:167], v[228:231]
  v_mfma_f32_16x16x32_bf16 v[232:235], a[156:159], a[160:163], v[232:235]
  s_waitcnt lgkmcnt(0)
  v_mfma_f32_16x16x32_bf16 v[236:239], a[156:159], a[164:167], v[236:239]
  s_barrier
  s_add_u32 s56, s56, 1
  s_cmp_lt_u32 s56, 10
  s_cbranch_scc1 L_wq_loop
L_wq_done:
  v_mfma_f32_16x16x32_bf16 v[176:179], a[168:171], a[200:203], v[176:179]
  v_mfma_f32_16x16x32_bf16 v[180:183], a[168:171], a[204:207], v[180:183]
  v_mfma_f32_16x16x32_bf16 v[184:187], a[172:175], a[200:203], v[184:187]
  v_mfma_f32_16x16x32_bf16 v[188:191], a[172:175], a[204:207], v[188:191]
  v_mfma_f32_16x16x32_bf16 v[192:195], a[176:179], a[200:203], v[192:195]
  v_mfma_f32_16x16x32_bf16 v[196:199], a[176:179], a[204:207], v[196:199]
  v_mfma_f32_16x16x32_bf16 v[200:203], a[180:183], a[200:203], v[200:203]
  v_mfma_f32_16x16x32_bf16 v[204:207], a[180:183], a[204:207], v[204:207]
  v_mfma_f32_16x16x32_bf16 v[208:211], a[184:187], a[200:203], v[208:211]
  v_mfma_f32_16x16x32_bf16 v[212:215], a[184:187], a[204:207], v[212:215]
  v_mfma_f32_16x16x32_bf16 v[216:219], a[188:191], a[200:203], v[216:219]
  v_mfma_f32_16x16x32_bf16 v[220:223], a[188:191], a[204:207], v[220:223]
  v_mfma_f32_16x16x32_bf16 v[224:227], a[192:195], a[200:203], v[224:227]
  v_mfma_f32_16x16x32_bf16 v[228:231], a[192:195], a[204:207], v[228:231]
  v_mfma_f32_16x16x32_bf16 v[232:235], a[196:199], a[200:203], v[232:235]
  v_mfma_f32_16x16x32_bf16 v[236:239], a[196:199], a[204:207], v[236:239]
  v_pk_mul_f32 v[176:177], v[176:177], s[60:61]
  v_pk_mul_f32 v[178:179], v[178:179], s[60:61]
  v_pk_mul_f32 v[180:181], v[180:181], s[60:61]
  v_pk_mul_f32 v[182:183], v[182:183], s[60:61]
  v_pk_mul_f32 v[184:185], v[184:185], s[60:61]
  v_pk_mul_f32 v[186:187], v[186:187], s[60:61]
  v_pk_mul_f32 v[188:189], v[188:189], s[60:61]
  v_pk_mul_f32 v[190:191], v[190:191], s[60:61]
  v_cvt_pk_bf16_f32 v64, v176, v177
  v_cvt_pk_bf16_f32 v65, v178, v179
  v_cvt_pk_bf16_f32 v68, v180, v181
  v_cvt_pk_bf16_f32 v69, v182, v183
  v_cvt_pk_bf16_f32 v66, v184, v185
  v_cvt_pk_bf16_f32 v67, v186, v187
  v_cvt_pk_bf16_f32 v70, v188, v189
  v_cvt_pk_bf16_f32 v71, v190, v191
  s_nop 1
  v_permlane32_swap_b32 v64, v66
  v_permlane32_swap_b32 v65, v67
  v_permlane32_swap_b32 v68, v70
  v_permlane32_swap_b32 v69, v71
  v_permlane16_swap_b32 v64, v66
  v_permlane16_swap_b32 v65, v67
  v_permlane16_swap_b32 v68, v70
  v_permlane16_swap_b32 v69, v71
  v_accvgpr_write_b32 a96, v64
  v_accvgpr_write_b32 a97, v65
  v_accvgpr_write_b32 a98, v66
  v_accvgpr_write_b32 a99, v67
  v_accvgpr_write_b32 a100, v68
  v_accvgpr_write_b32 a101, v69
  v_accvgpr_write_b32 a102, v70
  v_accvgpr_write_b32 a103, v71
  v_pk_mul_f32 v[192:193], v[192:193], s[60:61]
  v_pk_mul_f32 v[194:195], v[194:195], s[60:61]
  v_pk_mul_f32 v[196:197], v[196:197], s[60:61]
  v_pk_mul_f32 v[198:199], v[198:199], s[60:61]
  v_pk_mul_f32 v[200:201], v[200:201], s[60:61]
  v_pk_mul_f32 v[202:203], v[202:203], s[60:61]
  v_pk_mul_f32 v[204:205], v[204:205], s[60:61]
  v_pk_mul_f32 v[206:207], v[206:207], s[60:61]
  v_cvt_pk_bf16_f32 v72, v192, v193
  v_cvt_pk_bf16_f32 v73, v194, v195
  v_cvt_pk_bf16_f32 v76, v196, v197
  v_cvt_pk_bf16_f32 v77, v198, v199
  v_cvt_pk_bf16_f32 v74, v200, v201
  v_cvt_pk_bf16_f32 v75, v202, v203
  v_cvt_pk_bf16_f32 v78, v204, v205
  v_cvt_pk_bf16_f32 v79, v206, v207
  s_nop 1
  v_permlane32_swap_b32 v72, v74
  v_permlane32_swap_b32 v73, v75
  v_permlane32_swap_b32 v76, v78
  v_permlane32_swap_b32 v77, v79
  v_permlane16_swap_b32 v72, v74
  v_permlane16_swap_b32 v73, v75
  v_permlane16_swap_b32 v76, v78
  v_permlane16_swap_b32 v77, v79
  v_accvgpr_write_b32 a104, v72
  v_accvgpr_write_b32 a105, v73
  v_accvgpr_write_b32 a106, v74
  v_accvgpr_write_b32 a107, v75
  v_accvgpr_write_b32 a108, v76
  v_accvgpr_write_b32 a109, v77
  v_accvgpr_write_b32 a110, v78
  v_accvgpr_write_b32 a111, v79
  v_pk_mul_f32 v[208:209], v[208:209], s[60:61]
  v_pk_mul_f32 v[210:211], v[210:211], s[60:61]
  v_pk_mul_f32 v[212:213], v[212:213], s[60:61]
  v_pk_mul_f32 v[214:215], v[214:215], s[60:61]
  v_pk_mul_f32 v[216:217], v[216:217], s[60:61]
  v_pk_mul_f32 v[218:219], v[218:219], s[60:61]
  v_pk_mul_f32 v[220:221], v[220:221], s[60:61]
  v_pk_mul_f32 v[222:223], v[222:223], s[60:61]
  v_cvt_pk_bf16_f32 v64, v208, v209
  v_cvt_pk_bf16_f32 v65, v210, v211
  v_cvt_pk_bf16_f32 v68, v212, v213
  v_cvt_pk_bf16_f32 v69, v214, v215
  v_cvt_pk_bf16_f32 v66, v216, v217
  v_cvt_pk_bf16_f32 v67, v218, v219
  v_cvt_pk_bf16_f32 v70, v220, v221
  v_cvt_pk_bf16_f32 v71, v222, v223
  s_nop 1
  v_permlane32_swap_b32 v64, v66
  v_permlane32_swap_b32 v65, v67
  v_permlane32_swap_b32 v68, v70
  v_permlane32_swap_b32 v69, v71
  v_permlane16_swap_b32 v64, v66
  v_permlane16_swap_b32 v65, v67
  v_permlane16_swap_b32 v68, v70
  v_permlane16_swap_b32 v69, v71
  v_accvgpr_write_b32 a112, v64
  v_accvgpr_write_b32 a113, v65
  v_accvgpr_write_b32 a114, v66
  v_accvgpr_write_b32 a115, v67
  v_accvgpr_write_b32 a116, v68
  v_accvgpr_write_b32 a117, v69
  v_accvgpr_write_b32 a118, v70
  v_accvgpr_write_b32 a119, v71
  v_pk_mul_f32 v[224:225], v[224:225], s[60:61]
  v_pk_mul_f32 v[226:227], v[226:227], s[60:61]
  v_pk_mul_f32 v[228:229], v[228:229], s[60:61]
  v_pk_mul_f32 v[230:231], v[230:231], s[60:61]
  v_pk_mul_f32 v[232:233], v[232:233], s[60:61]
  v_pk_mul_f32 v[234:235], v[234:235], s[60:61]
  v_pk_mul_f32 v[236:237], v[236:237], s[60:61]
  v_pk_mul_f32 v[238:239], v[238:239], s[60:61]
  v_cvt_pk_bf16_f32 v72, v224, v225
  v_cvt_pk_bf16_f32 v73, v226, v227
  v_cvt_pk_bf16_f32 v76, v228, v229
  v_cvt_pk_bf16_f32 v77, v230, v231
  v_cvt_pk_bf16_f32 v74, v232, v233
  v_cvt_pk_bf16_f32 v75, v234, v235
  v_cvt_pk_bf16_f32 v78, v236, v237
  v_cvt_pk_bf16_f32 v79, v238, v239
  s_nop 1
  v_permlane32_swap_b32 v72, v74
  v_permlane32_swap_b32 v73, v75
  v_permlane32_swap_b32 v76, v78
  v_permlane32_swap_b32 v77, v79
  v_permlane16_swap_b32 v72, v74
  v_permlane16_swap_b32 v73, v75
  v_permlane16_swap_b32 v76, v78
  v_permlane16_swap_b32 v77, v79
  v_accvgpr_write_b32 a120, v72
  v_accvgpr_write_b32 a121, v73
  v_accvgpr_write_b32 a122, v74
  v_accvgpr_write_b32 a123, v75
  v_accvgpr_write_b32 a124, v76
  v_accvgpr_write_b32 a125, v77
  v_accvgpr_write_b32 a126, v78
  v_accvgpr_write_b32 a127, v79
  s_setpc_b64 s[66:67]
Lfb_29:
  s_call_b64 s[62:63], L_fb1
  s_branch Lbk_30
Lfb_31:
  s_call_b64 s[62:63], L_fb0
  s_branch Lbk_32
Lfb_33:
  s_call_b64 s[62:63], L_fb1
  s_branch Lbk_34
Lfb_35:
  s_call_b64 s[62:63], L_fb0
  s_branch Lbk_36
Lfb_37:
  s_call_b64 s[62:63], L_fb1
  s_branch Lbk_38
Lna_44:
  s_mov_b32 s46, 25165952
  buffer_load_dwordx2 v[14:15], v7, s[20:23], s46 offen sc1
  s_waitcnt vmcnt(0)
  v_cmp_eq_u64 vcc, v[14:15], v[12:13]
  s_nop 1
  s_and_b32 s64, vcc_lo, 7
  s_cmp_eq_u32 s67, 0
  s_cbranch_scc0 Lfl_46
  s_andn2_b32 s48, s64, s56
  s_cbranch_scc0 Lfl_46
  s_ff1_i32_b32 s51, s48
  s_bitset1_b32 s56, s51
  s_add_u32 s66, s51, 1
  s_add_u32 s67, s67, 1
  s_add_u32 s46, s40, s66
  s_and_b32 s46, s46, 3
  s_lshl_b32 s46, s46, 3
  s_add_u32 s46, s46, s58
  s_mul_i32 s46, s46, 49152
  s_lshl_b32 s47, s3, 13
  s_add_u32 s46, s46, s47
  s_add_u32 s46, s46, 24576
  s_add_u32 s47, s46, 4096
  buffer_load_dwordx4 a[0:3], v10, s[20:23], s46 offen offset:0 sc1
  buffer_load_dwordx4 a[4:7], v10, s[20:23], s46 offen offset:1024 sc1
  buffer_load_dwordx4 a[8:11], v10, s[20:23], s46 offen offset:2048 sc1
  buffer_load_dwordx4 a[12:15], v10, s[20:23], s46 offen offset:3072 sc1
  buffer_load_dwordx4 a[16:19], v10, s[20:23], s47 offen offset:0 sc1
  buffer_load_dwordx4 a[20:23], v10, s[20:23], s47 offen offset:1024 sc1
  buffer_load_dwordx4 a[24:27], v10, s[20:23], s47 offen offset:2048 sc1
  buffer_load_dwordx4 a[28:31], v10, s[20:23], s47 offen offset:3072 sc1
Lfl_46:
  s_add_u32 s59, s59, 1
  s_cmp_ge_u32 s59, 0x200000
  s_cbranch_scc1 Lnb_45
  s_cmp_gt_u32 s67, 0
  s_cbranch_scc0 Lna_44
  s_cmp_eq_u32 s67, 1
  s_cbranch_scc0 Lfl_47
  s_andn2_b32 s48, s64, s56
  s_cbranch_scc0 Lfl_47
  s_ff1_i32_b32 s52, s48
  s_bitset1_b32 s56, s52
  s_add_u32 s66, s52, 1
  s_add_u32 s67, s67, 1
  s_add_u32 s46, s40, s66
  s_and_b32 s46, s46, 3
  s_lshl_b32 s46, s46, 3
  s_add_u32 s46, s46, s58
  s_mul_i32 s46, s46, 49152
  s_lshl_b32 s47, s3, 13
  s_add_u32 s46, s46, s47
  s_add_u32 s46, s46, 24576
  s_add_u32 s47, s46, 4096
  buffer_load_dwordx4 a[32:35], v10, s[20:23], s46 offen offset:0 sc1
  buffer_load_dwordx4 a[36:39], v10, s[20:23], s46 offen offset:1024 sc1
  buffer_load_dwordx4 a[40:43], v10, s[20:23], s46 offen offset:2048 sc1
  buffer_load_dwordx4 a[44:47], v10, s[20:23], s46 offen offset:3072 sc1
  buffer_load_dwordx4 a[48:51], v10, s[20:23], s47 offen offset:0 sc1
  buffer_load_dwordx4 a[52:55], v10, s[20:23], s47 offen offset:1024 sc1
  buffer_load_dwordx4 a[56:59], v10, s[20:23], s47 offen offset:2048 sc1
  buffer_load_dwordx4 a[60:63], v10, s[20:23], s47 offen offset:3072 sc1
Lfl_47:
  s_cmp_eq_u32 s67, 2
  s_cbranch_scc0 Lfl_48
  s_andn2_b32 s48, s64, s56
  s_cbranch_scc0 Lfl_48
  s_ff1_i32_b32 s53, s48
  s_bitset1_b32 s56, s53
  s_add_u32 s66, s53, 1
  s_add_u32 s67, s67, 1
  s_add_u32 s46, s40, s66
  s_and_b32 s46, s46, 3
  s_lshl_b32 s46, s46, 3
  s_add_u32 s46, s46, s58
  s_mul_i32 s46, s46, 49152
  s_lshl_b32 s47, s3, 13
  s_add_u32 s46, s46, s47
  s_add_u32 s46, s46, 24576
  s_add_u32 s47, s46, 4096
  buffer_load_dwordx4 v[96:99], v10, s[20:23], s46 offen offset:0 sc1
  buffer_load_dwordx4 v[100:103], v10, s[20:23], s46 offen offset:1024 sc1
  buffer_load_dwordx4 v[104:107], v10, s[20:23], s46 offen offset:2048 sc1
  buffer_load_dwordx4 v[108:111], v10, s[20:23], s46 offen offset:3072 sc1
  buffer_load_dwordx4 v[112:115], v10, s[20:23], s47 offen offset:0 sc1
  buffer_load_dwordx4 v[116:119], v10, s[20:23], s47 offen offset:1024 sc1
  buffer_load_dwordx4 v[120:123], v10, s[20:23], s47 offen offset:2048 sc1
  buffer_load_dwordx4 v[124:127], v10, s[20:23], s47 offen offset:3072 sc1
Lfl_48:
  s_branch Lnb_45
Lna_49:
  s_mov_b32 s46, 25165952
  buffer_load_dwordx2 v[14:15], v7, s[20:23], s46 offen sc1
  s_waitcnt vmcnt(0)
  v_cmp_eq_u64 vcc, v[14:15], v[12:13]
  s_nop 1
  s_and_b32 s64, vcc_lo, 7
  s_cmp_eq_u32 s67, 1
  s_cbranch_scc0 Lfl_51
  s_andn2_b32 s48, s64, s56
  s_cbranch_scc0 Lfl_51
  s_ff1_i32_b32 s52, s48
  s_bitset1_b32 s56, s52
  s_add_u32 s66, s52, 1
  s_add_u32 s67, s67, 1
  s_add_u32 s46, s40, s66
  s_and_b32 s46, s46, 3
  s_lshl_b32 s46, s46, 3
  s_add_u32 s46, s46, s58
  s_mul_i32 s46, s46, 49152
  s_lshl_b32 s47, s3, 13
  s_add_u32 s46, s46, s47
  s_add_u32 s46, s46, 24576
  s_add_u32 s47, s46, 4096
  buffer_load_dwordx4 a[32:35], v10, s[20:23], s46 offen offset:0 sc1
  buffer_load_dwordx4 a[36:39], v10, s[20:23], s46 offen offset:1024 sc1
  buffer_load_dwordx4 a[40:43], v10, s[20:23], s46 offen offset:2048 sc1
  buffer_load_dwordx4 a[44:47], v10, s[20:23], s46 offen offset:3072 sc1
  buffer_load_dwordx4 a[48:51], v10, s[20:23], s47 offen offset:0 sc1
  buffer_load_dwordx4 a[52:55], v10, s[20:23], s47 offen offset:1024 sc1
  buffer_load_dwordx4 a[56:59], v10, s[20:23], s47 offen offset:2048 sc1
  buffer_load_dwordx4 a[60:63], v10, s[20:23], s47 offen offset:3072 sc1
Lfl_51:
  s_add_u32 s59, s59, 1
  s_cmp_ge_u32 s59, 0x200000
  s_cbranch_scc1 Lnb_50
  s_cmp_gt_u32 s67, 1
  s_cbranch_scc0 Lna_49
  s_cmp_eq_u32 s67, 2
  s_cbranch_scc0 Lfl_52
  s_andn2_b32 s48, s64, s56
  s_cbranch_scc0 Lfl_52
  s_ff1_i32_b32 s53, s48
  s_bitset1_b32 s56, s53
  s_add_u32 s66, s53, 1
  s_add_u32 s67, s67, 1
  s_add_u32 s46, s40, s66
  s_and_b32 s46, s46, 3
  s_lshl_b32 s46, s46, 3
  s_add_u32 s46, s46, s58
  s_mul_i32 s46, s46, 49152
  s_lshl_b32 s47, s3, 13
  s_add_u32 s46, s46, s47
  s_add_u32 s46, s46, 24576
  s_add_u32 s47, s46, 4096
  buffer_load_dwordx4 v[96:99], v10, s[20:23], s46 offen offset:0 sc1
  buffer_load_dwordx4 v[100:103], v10, s[20:23], s46 offen offset:1024 sc1
  buffer_load_dwordx4 v[104:107], v10, s[20:23], s46 offen offset:2048 sc1
  buffer_load_dwordx4 v[108:111], v10, s[20:23], s46 offen offset:3072 sc1
  buffer_load_dwordx4 v[112:115], v10, s[20:23], s47 offen offset:0 sc1
  buffer_load_dwordx4 v[116:119], v10, s[20:23], s47 offen offset:1024 sc1
  buffer_load_dwordx4 v[120:123], v10, s[20:23], s47 offen offset:2048 sc1
  buffer_load_dwordx4 v[124:127], v10, s[20:23], s47 offen offset:3072 sc1
Lfl_52:
  s_branch Lnb_50
Laa_53:
  s_waitcnt vmcnt(0)
  s_branch Lab_54
Laa_59:
  s_waitcnt vmcnt(0)
  s_branch Lab_60
Lna_64:
  s_mov_b32 s46, 25165952
  buffer_load_dwordx2 v[14:15], v7, s[20:23], s46 offen sc1
  s_waitcnt vmcnt(0)
  v_cmp_eq_u64 vcc, v[14:15], v[12:13]
  s_nop 1
  s_and_b32 s64, vcc_lo, 7
  s_cmp_eq_u32 s67, 2
  s_cbranch_scc0 Lfl_66
  s_andn2_b32 s48, s64, s56
  s_cbranch_scc0 Lfl_66
  s_ff1_i32_b32 s53, s48
  s_bitset1_b32 s56, s53
  s_add_u32 s66, s53, 1
  s_add_u32 s67, s67, 1
  s_add_u32 s46, s40, s66
  s_and_b32 s46, s46, 3
  s_lshl_b32 s46, s46, 3
  s_add_u32 s46, s46, s58
  s_mul_i32 s46, s46, 49152
  s_lshl_b32 s47, s3, 13
  s_add_u32 s46, s46, s47
  s_add_u32 s46, s46, 24576
  s_add_u32 s47, s46, 4096
  buffer_load_dwordx4 v[96:99], v10, s[20:23], s46 offen offset:0 sc1
  buffer_load_dwordx4 v[100:103], v10, s[20:23], s46 offen offset:1024 sc1
  buffer_load_dwordx4 v[104:107], v10, s[20:23], s46 offen offset:2048 sc1
  buffer_load_dwordx4 v[108:111], v10, s[20:23], s46 offen offset:3072 sc1
  buffer_load_dwordx4 v[112:115], v10, s[20:23], s47 offen offset:0 sc1
  buffer_load_dwordx4 v[116:119], v10, s[20:23], s47 offen offset:1024 sc1
  buffer_load_dwordx4 v[120:123], v10, s[20:23], s47 offen offset:2048 sc1
  buffer_load_dwordx4 v[124:127], v10, s[20:23], s47 offen offset:3072 sc1
Lfl_66:
  s_add_u32 s59, s59, 1
  s_cmp_ge_u32 s59, 0x200000
  s_cbranch_scc1 Lnb_65
  s_cmp_gt_u32 s67, 2
  s_cbranch_scc0 Lna_64
  s_branch Lnb_65
Lna_67:
  s_mov_b32 s46, 25165952
  buffer_load_dwordx2 v[14:15], v7, s[20:23], s46 offen sc1
  s_waitcnt vmcnt(0)
  v_cmp_eq_u64 vcc, v[14:15], v[12:13]
  s_nop 1
  s_and_b32 s64, vcc_lo, 7
  s_cmp_eq_u32 s67, 2
  s_cbranch_scc0 Lfl_69
  s_andn2_b32 s48, s64, s56
  s_cbranch_scc0 Lfl_69
  s_ff1_i32_b32 s53, s48
  s_bitset1_b32 s56, s53
  s_add_u32 s66, s53, 1
  s_add_u32 s67, s67, 1
  s_add_u32 s46, s40, s66
  s_and_b32 s46, s46, 3
  s_lshl_b32 s46, s46, 3
  s_add_u32 s46, s46, s58
  s_mul_i32 s46, s46, 49152
  s_lshl_b32 s47, s3, 13
  s_add_u32 s46, s46, s47
  s_add_u32 s46, s46, 24576
  s_add_u32 s47, s46, 4096
  buffer_load_dwordx4 v[96:99], v10, s[20:23], s46 offen offset:0 sc1
  buffer_load_dwordx4 v[100:103], v10, s[20:23], s46 offen offset:1024 sc1
  buffer_load_dwordx4 v[104:107], v10, s[20:23], s46 offen offset:2048 sc1
  buffer_load_dwordx4 v[108:111], v10, s[20:23], s46 offen offset:3072 sc1
  buffer_load_dwordx4 v[112:115], v10, s[20:23], s47 offen offset:0 sc1
  buffer_load_dwordx4 v[116:119], v10, s[20:23], s47 offen offset:1024 sc1
  buffer_load_dwordx4 v[120:123], v10, s[20:23], s47 offen offset:2048 sc1
  buffer_load_dwordx4 v[124:127], v10, s[20:23], s47 offen offset:3072 sc1
Lfl_69:
  s_add_u32 s59, s59, 1
  s_cmp_ge_u32 s59, 0x200000
  s_cbranch_scc1 Lnb_68
  s_cmp_gt_u32 s67, 2
  s_cbranch_scc0 Lna_67
  s_branch Lnb_68
Lna_70:
  s_mov_b32 s46, 25165952
  buffer_load_dwordx2 v[14:15], v7, s[20:23], s46 offen sc1
  s_waitcnt vmcnt(0)
  v_cmp_eq_u64 vcc, v[14:15], v[12:13]
  s_nop 1
  s_and_b32 s64, vcc_lo, 7
  s_cmp_eq_u32 s67, 2
  s_cbranch_scc0 Lfl_72
  s_andn2_b32 s48, s64, s56
  s_cbranch_scc0 Lfl_72
  s_ff1_i32_b32 s53, s48
  s_bitset1_b32 s56, s53
  s_add_u32 s66, s53, 1
  s_add_u32 s67, s67, 1
  s_add_u32 s46, s40, s66
  s_and_b32 s46, s46, 3
  s_lshl_b32 s46, s46, 3
  s_add_u32 s46, s46, s58
  s_mul_i32 s46, s46, 49152
  s_lshl_b32 s47, s3, 13
  s_add_u32 s46, s46, s47
  s_add_u32 s46, s46, 24576
  s_add_u32 s47, s46, 4096
  buffer_load_dwordx4 v[96:99], v10, s[20:23], s46 offen offset:0 sc1
  buffer_load_dwordx4 v[100:103], v10, s[20:23], s46 offen offset:1024 sc1
  buffer_load_dwordx4 v[104:107], v10, s[20:23], s46 offen offset:2048 sc1
  buffer_load_dwordx4 v[108:111], v10, s[20:23], s46 offen offset:3072 sc1
  buffer_load_dwordx4 v[112:115], v10, s[20:23], s47 offen offset:0 sc1
  buffer_load_dwordx4 v[116:119], v10, s[20:23], s47 offen offset:1024 sc1
  buffer_load_dwordx4 v[120:123], v10, s[20:23], s47 offen offset:2048 sc1
  buffer_load_dwordx4 v[124:127], v10, s[20:23], s47 offen offset:3072 sc1
Lfl_72:
  s_add_u32 s59, s59, 1
  s_cmp_ge_u32 s59, 0x200000
  s_cbranch_scc1 Lnb_71
  s_cmp_gt_u32 s67, 2
  s_cbranch_scc0 Lna_70
  s_branch Lnb_71
Lna_73:
  s_mov_b32 s46, 25165952
  buffer_load_dwordx2 v[14:15], v7, s[20:23], s46 offen sc1
  s_waitcnt vmcnt(0)
  v_cmp_eq_u64 vcc, v[14:15], v[12:13]
  s_nop 1
  s_and_b32 s64, vcc_lo, 7
  s_cmp_eq_u32 s67, 2
  s_cbranch_scc0 Lfl_75
  s_andn2_b32 s48, s64, s56
  s_cbranch_scc0 Lfl_75
  s_ff1_i32_b32 s53, s48
  s_bitset1_b32 s56, s53
  s_add_u32 s66, s53, 1
  s_add_u32 s67, s67, 1
  s_add_u32 s46, s40, s66
  s_and_b32 s46, s46, 3
  s_lshl_b32 s46, s46, 3
  s_add_u32 s46, s46, s58
  s_mul_i32 s46, s46, 49152
  s_lshl_b32 s47, s3, 13
  s_add_u32 s46, s46, s47
  s_add_u32 s46, s46, 24576
  s_add_u32 s47, s46, 4096
  buffer_load_dwordx4 v[96:99], v10, s[20:23], s46 offen offset:0 sc1
  buffer_load_dwordx4 v[100:103], v10, s[20:23], s46 offen offset:1024 sc1
  buffer_load_dwordx4 v[104:107], v10, s[20:23], s46 offen offset:2048 sc1
  buffer_load_dwordx4 v[108:111], v10, s[20:23], s46 offen offset:3072 sc1
  buffer_load_dwordx4 v[112:115], v10, s[20:23], s47 offen offset:0 sc1
  buffer_load_dwordx4 v[116:119], v10, s[20:23], s47 offen offset:1024 sc1
  buffer_load_dwordx4 v[120:123], v10, s[20:23], s47 offen offset:2048 sc1
  buffer_load_dwordx4 v[124:127], v10, s[20:23], s47 offen offset:3072 sc1
Lfl_75:
  s_add_u32 s59, s59, 1
  s_cmp_ge_u32 s59, 0x200000
  s_cbranch_scc1 Lnb_74
  s_cmp_gt_u32 s67, 2
  s_cbranch_scc0 Lna_73
  s_branch Lnb_74
L_fb0:
  s_nop 9
  v_max3_f32 v158, v16, v17, v18
  v_max3_f32 v159, v24, v25, v26
  v_max3_f32 v158, v158, v19, v20
  v_max3_f32 v159, v159, v27, v28
  v_max3_f32 v158, v158, v21, v22
  v_max3_f32 v159, v159, v29, v30
  v_max_f32 v158, v158, v23
  v_max_f32 v159, v159, v31
  v_mov_b32 v240, v158
  v_mov_b32 v241, v159
  s_nop 0
  v_permlane32_swap_b32 v158, v240
  v_permlane32_swap_b32 v159, v241
  v_max_f32 v158, v158, v240
  v_max_f32 v159, v159, v241
  v_mov_b32 v240, v158
  v_mov_b32 v241, v159
  s_nop 0
  v_permlane16_swap_b32 v158, v240
  v_permlane16_swap_b32 v159, v241
  v_max_f32 v158, v158, v240
  v_max_f32 v159, v159, v241
  v_max_f32 v158, 0, v158
  v_max_f32 v159, 0, v159
  v_exp_f32 v240, -v158
  v_exp_f32 v241, -v159
  v_sub_f32 v16, v16, v158
  v_sub_f32 v17, v17, v158
  v_sub_f32 v18, v18, v158
  v_sub_f32 v19, v19, v158
  v_sub_f32 v20, v20, v158
  v_sub_f32 v21, v21, v158
  v_sub_f32 v22, v22, v158
  v_sub_f32 v23, v23, v158
  v_sub_f32 v24, v24, v159
  v_sub_f32 v25, v25, v159
  v_sub_f32 v26, v26, v159
  v_sub_f32 v27, v27, v159
  v_sub_f32 v28, v28, v159
  v_sub_f32 v29, v29, v159
  v_sub_f32 v30, v30, v159
  v_sub_f32 v31, v31, v159
  v_sub_f32 v32, v32, v158
  v_sub_f32 v33, v33, v158
  v_sub_f32 v34, v34, v158
  v_sub_f32 v35, v35, v158
  v_sub_f32 v36, v36, v158
  v_sub_f32 v37, v37, v158
  v_sub_f32 v38, v38, v158
  v_sub_f32 v39, v39, v158
  v_sub_f32 v40, v40, v159
  v_sub_f32 v41, v41, v159
  v_sub_f32 v42, v42, v159
  v_sub_f32 v43, v43, v159
  v_sub_f32 v44, v44, v159
  v_sub_f32 v45, v45, v159
  v_sub_f32 v46, v46, v159
  v_sub_f32 v47, v47, v159
  v_sub_f32 v48, v48, v158
  v_sub_f32 v49, v49, v158
  v_sub_f32 v50, v50, v158
  v_sub_f32 v51, v51, v158
  v_sub_f32 v52, v52, v159
  v_sub_f32 v53, v53, v159
  v_sub_f32 v54, v54, v159
  v_sub_f32 v55, v55, v159
  v_mul_f32 v150, v150, v240
  v_mul_f32 v151, v151, v241
  v_accvgpr_read_b32 v144, a0
  v_accvgpr_read_b32 v145, a1
  v_accvgpr_read_b32 v146, a2
  v_accvgpr_read_b32 v147, a3
  v_mul_f32 v144, v144, v240
  v_mul_f32 v145, v145, v240
  v_mul_f32 v146, v146, v240
  v_mul_f32 v147, v147, v240
  v_accvgpr_write_b32 a0, v144
  v_accvgpr_write_b32 a1, v145
  v_accvgpr_write_b32 a2, v146
  v_accvgpr_write_b32 a3, v147
  v_accvgpr_read_b32 v144, a4
  v_accvgpr_read_b32 v145, a5
  v_accvgpr_read_b32 v146, a6
  v_accvgpr_read_b32 v147, a7
  v_mul_f32 v144, v144, v241
  v_mul_f32 v145, v145, v241
  v_mul_f32 v146, v146, v241
  v_mul_f32 v147, v147, v241
  v_accvgpr_write_b32 a4, v144
  v_accvgpr_write_b32 a5, v145
  v_accvgpr_write_b32 a6, v146
  v_accvgpr_write_b32 a7, v147
  v_accvgpr_read_b32 v144, a8
  v_accvgpr_read_b32 v145, a9
  v_accvgpr_read_b32 v146, a10
  v_accvgpr_read_b32 v147, a11
  v_mul_f32 v144, v144, v240
  v_mul_f32 v145, v145, v240
  v_mul_f32 v146, v146, v240
  v_mul_f32 v147, v147, v240
  v_accvgpr_write_b32 a8, v144
  v_accvgpr_write_b32 a9, v145
  v_accvgpr_write_b32 a10, v146
  v_accvgpr_write_b32 a11, v147
  v_accvgpr_read_b32 v144, a12
  v_accvgpr_read_b32 v145, a13
  v_accvgpr_read_b32 v146, a14
  v_accvgpr_read_b32 v147, a15
  v_mul_f32 v144, v144, v241
  v_mul_f32 v145, v145, v241
  v_mul_f32 v146, v146, v241
  v_mul_f32 v147, v147, v241
  v_accvgpr_write_b32 a12, v144
  v_accvgpr_write_b32 a13, v145
  v_accvgpr_write_b32 a14, v146
  v_accvgpr_write_b32 a15, v147
  v_accvgpr_read_b32 v144, a16
  v_accvgpr_read_b32 v145, a17
  v_accvgpr_read_b32 v146, a18
  v_accvgpr_read_b32 v147, a19
  v_mul_f32 v144, v144, v240
  v_mul_f32 v145, v145, v240
  v_mul_f32 v146, v146, v240
  v_mul_f32 v147, v147, v240
  v_accvgpr_write_b32 a16, v144
  v_accvgpr_write_b32 a17, v145
  v_accvgpr_write_b32 a18, v146
  v_accvgpr_write_b32 a19, v147
  v_accvgpr_read_b32 v144, a20
  v_accvgpr_read_b32 v145, a21
  v_accvgpr_read_b32 v146, a22
  v_accvgpr_read_b32 v147, a23
  v_mul_f32 v144, v144, v241
  v_mul_f32 v145, v145, v241
  v_mul_f32 v146, v146, v241
  v_mul_f32 v147, v147, v241
  v_accvgpr_write_b32 a20, v144
  v_accvgpr_write_b32 a21, v145
  v_accvgpr_write_b32 a22, v146
  v_accvgpr_write_b32 a23, v147
  v_accvgpr_read_b32 v144, a24
  v_accvgpr_read_b32 v145, a25
  v_accvgpr_read_b32 v146, a26
  v_accvgpr_read_b32 v147, a27
  v_mul_f32 v144, v144, v240
  v_mul_f32 v145, v145, v240
  v_mul_f32 v146, v146, v240
  v_mul_f32 v147, v147, v240
  v_accvgpr_write_b32 a24, v144
  v_accvgpr_write_b32 a25, v145
  v_accvgpr_write_b32 a26, v146
  v_accvgpr_write_b32 a27, v147
  v_accvgpr_read_b32 v144, a28
  v_accvgpr_read_b32 v145, a29
  v_accvgpr_read_b32 v146, a30
  v_accvgpr_read_b32 v147, a31
  v_mul_f32 v144, v144, v241
  v_mul_f32 v145, v145, v241
  v_mul_f32 v146, v146, v241
  v_mul_f32 v147, v147, v241
  v_accvgpr_write_b32 a28, v144
  v_accvgpr_write_b32 a29, v145
  v_accvgpr_write_b32 a30, v146
  v_accvgpr_write_b32 a31, v147
  v_accvgpr_read_b32 v144, a32
  v_accvgpr_read_b32 v145, a33
  v_accvgpr_read_b32 v146, a34
  v_accvgpr_read_b32 v147, a35
  v_mul_f32 v144, v144, v240
  v_mul_f32 v145, v145, v240
  v_mul_f32 v146, v146, v240
  v_mul_f32 v147, v147, v240
  v_accvgpr_write_b32 a32, v144
  v_accvgpr_write_b32 a33, v145
  v_accvgpr_write_b32 a34, v146
  v_accvgpr_write_b32 a35, v147
  v_accvgpr_read_b32 v144, a36
  v_accvgpr_read_b32 v145, a37
  v_accvgpr_read_b32 v146, a38
  v_accvgpr_read_b32 v147, a39
  v_mul_f32 v144, v144, v241
  v_mul_f32 v145, v145, v241
  v_mul_f32 v146, v146, v241
  v_mul_f32 v147, v147, v241
  v_accvgpr_write_b32 a36, v144
  v_accvgpr_write_b32 a37, v145
  v_accvgpr_write_b32 a38, v146
  v_accvgpr_write_b32 a39, v147
  v_accvgpr_read_b32 v144, a40
  v_accvgpr_read_b32 v145, a41
  v_accvgpr_read_b32 v146, a42
  v_accvgpr_read_b32 v147, a43
  v_mul_f32 v144, v144, v240
  v_mul_f32 v145, v145, v240
  v_mul_f32 v146, v146, v240
  v_mul_f32 v147, v147, v240
  v_accvgpr_write_b32 a40, v144
  v_accvgpr_write_b32 a41, v145
  v_accvgpr_write_b32 a42, v146
  v_accvgpr_write_b32 a43, v147
  v_accvgpr_read_b32 v144, a44
  v_accvgpr_read_b32 v145, a45
  v_accvgpr_read_b32 v146, a46
  v_accvgpr_read_b32 v147, a47
  v_mul_f32 v144, v144, v241
  v_mul_f32 v145, v145, v241
  v_mul_f32 v146, v146, v241
  v_mul_f32 v147, v147, v241
  v_accvgpr_write_b32 a44, v144
  v_accvgpr_write_b32 a45, v145
  v_accvgpr_write_b32 a46, v146
  v_accvgpr_write_b32 a47, v147
  v_accvgpr_read_b32 v144, a48
  v_accvgpr_read_b32 v145, a49
  v_accvgpr_read_b32 v146, a50
  v_accvgpr_read_b32 v147, a51
  v_mul_f32 v144, v144, v240
  v_mul_f32 v145, v145, v240
  v_mul_f32 v146, v146, v240
  v_mul_f32 v147, v147, v240
  v_accvgpr_write_b32 a48, v144
  v_accvgpr_write_b32 a49, v145
  v_accvgpr_write_b32 a50, v146
  v_accvgpr_write_b32 a51, v147
  v_accvgpr_read_b32 v144, a52
  v_accvgpr_read_b32 v145, a53
  v_accvgpr_read_b32 v146, a54
  v_accvgpr_read_b32 v147, a55
  v_mul_f32 v144, v144, v241
  v_mul_f32 v145, v145, v241
  v_mul_f32 v146, v146, v241
  v_mul_f32 v147, v147, v241
  v_accvgpr_write_b32 a52, v144
  v_accvgpr_write_b32 a53, v145
  v_accvgpr_write_b32 a54, v146
  v_accvgpr_write_b32 a55, v147
  v_accvgpr_read_b32 v144, a56
  v_accvgpr_read_b32 v145, a57
  v_accvgpr_read_b32 v146, a58
  v_accvgpr_read_b32 v147, a59
  v_mul_f32 v144, v144, v240
  v_mul_f32 v145, v145, v240
  v_mul_f32 v146, v146, v240
  v_mul_f32 v147, v147, v240
  v_accvgpr_write_b32 a56, v144
  v_accvgpr_write_b32 a57, v145
  v_accvgpr_write_b32 a58, v146
  v_accvgpr_write_b32 a59, v147
  v_accvgpr_read_b32 v144, a60
  v_accvgpr_read_b32 v145, a61
  v_accvgpr_read_b32 v146, a62
  v_accvgpr_read_b32 v147, a63
  v_mul_f32 v144, v144, v241
  v_mul_f32 v145, v145, v241
  v_mul_f32 v146, v146, v241
  v_mul_f32 v147, v147, v241
  v_accvgpr_write_b32 a60, v144
  v_accvgpr_write_b32 a61, v145
  v_accvgpr_write_b32 a62, v146
  v_accvgpr_write_b32 a63, v147
  v_exp_f32 v144, v16
  v_exp_f32 v145, v17
  v_exp_f32 v146, v18
  v_exp_f32 v147, v19
  v_add_f32 v156, v144, v145
  v_cvt_pk_bf16_f32 v128, v144, v145
  v_exp_f32 v144, v20
  v_exp_f32 v145, v21
  v_add_f32 v156, v156, v146
  v_add_f32 v156, v156, v147
  v_cvt_pk_bf16_f32 v129, v146, v147
  v_exp_f32 v146, v22
  v_exp_f32 v147, v23
  v_add_f32 v156, v156, v144
  v_add_f32 v156, v156, v145
  v_cvt_pk_bf16_f32 v130, v144, v145
  v_exp_f32 v144, v24
  v_exp_f32 v145, v25
  v_add_f32 v156, v156, v146
  v_add_f32 v156, v156, v147
  v_cvt_pk_bf16_f32 v131, v146, v147
  v_add_f32 v148, v150, v156
  v_exp_f32 v146, v26
  v_exp_f32 v147, v27
  v_add_f32 v157, v144, v145
  v_cvt_pk_bf16_f32 v132, v144, v145
  v_exp_f32 v144, v28
  v_exp_f32 v145, v29
  v_add_f32 v157, v157, v146
  v_add_f32 v157, v157, v147
  v_cvt_pk_bf16_f32 v133, v146, v147
  v_exp_f32 v146, v30
  v_exp_f32 v147, v31
  v_add_f32 v157, v157, v144
  v_add_f32 v157, v157, v145
  v_cvt_pk_bf16_f32 v134, v144, v145
  v_add_f32 v157, v157, v146
  v_add_f32 v157, v157, v147
  v_cvt_pk_bf16_f32 v135, v146, v147
  v_add_f32 v149, v151, v157
  s_nop 1
  s_setpc_b64 s[62:63]
L_fb1:
  s_nop 9
  v_max3_f32 v158, v32, v33, v34
  v_max3_f32 v159, v40, v41, v42
  v_max3_f32 v158, v158, v35, v36
  v_max3_f32 v159, v159, v43, v44
  v_max3_f32 v158, v158, v37, v38
  v_max3_f32 v159, v159, v45, v46
  v_max_f32 v158, v158, v39
  v_max_f32 v159, v159, v47
  v_mov_b32 v240, v158
  v_mov_b32 v241, v159
  s_nop 0
  v_permlane32_swap_b32 v158, v240
  v_permlane32_swap_b32 v159, v241
  v_max_f32 v158, v158, v240
  v_max_f32 v159, v159, v241
  v_mov_b32 v240, v158
  v_mov_b32 v241, v159
  s_nop 0
  v_permlane16_swap_b32 v158, v240
  v_permlane16_swap_b32 v159, v241
  v_max_f32 v158, v158, v240
  v_max_f32 v159, v159, v241
  v_max_f32 v158, 0, v158
  v_max_f32 v159, 0, v159
  v_exp_f32 v240, -v158
  v_exp_f32 v241, -v159
  v_sub_f32 v32, v32, v158
  v_sub_f32 v33, v33, v158
  v_sub_f32 v34, v34, v158
  v_sub_f32 v35, v35, v158
  v_sub_f32 v36, v36, v158
  v_sub_f32 v37, v37, v158
  v_sub_f32 v38, v38, v158
  v_sub_f32 v39, v39, v158
  v_sub_f32 v40, v40, v159
  v_sub_f32 v41, v41, v159
  v_sub_f32 v42, v42, v159
  v_sub_f32 v43, v43, v159
  v_sub_f32 v44, v44, v159
  v_sub_f32 v45, v45, v159
  v_sub_f32 v46, v46, v159
  v_sub_f32 v47, v47, v159
  v_sub_f32 v16, v16, v158
  v_sub_f32 v17, v17, v158
  v_sub_f32 v18, v18, v158
  v_sub_f32 v19, v19, v158
  v_sub_f32 v20, v20, v158
  v_sub_f32 v21, v21, v158
  v_sub_f32 v22, v22, v158
  v_sub_f32 v23, v23, v158
  v_sub_f32 v24, v24, v159
  v_sub_f32 v25, v25, v159
  v_sub_f32 v26, v26, v159
  v_sub_f32 v27, v27, v159
  v_sub_f32 v28, v28, v159
  v_sub_f32 v29, v29, v159
  v_sub_f32 v30, v30, v159
  v_sub_f32 v31, v31, v159
  v_sub_f32 v48, v48, v158
  v_sub_f32 v49, v49, v158
  v_sub_f32 v50, v50, v158
  v_sub_f32 v51, v51, v158
  v_sub_f32 v52, v52, v159
  v_sub_f32 v53, v53, v159
  v_sub_f32 v54, v54, v159
  v_sub_f32 v55, v55, v159
  v_mul_f32 v148, v148, v240
  v_mul_f32 v149, v149, v241
  v_accvgpr_read_b32 v144, a0
  v_accvgpr_read_b32 v145, a1
  v_accvgpr_read_b32 v146, a2
  v_accvgpr_read_b32 v147, a3
  v_mul_f32 v144, v144, v240
  v_mul_f32 v145, v145, v240
  v_mul_f32 v146, v146, v240
  v_mul_f32 v147, v147, v240
  v_accvgpr_write_b32 a0, v144
  v_accvgpr_write_b32 a1, v145
  v_accvgpr_write_b32 a2, v146
  v_accvgpr_write_b32 a3, v147
  v_accvgpr_read_b32 v144, a4
  v_accvgpr_read_b32 v145, a5
  v_accvgpr_read_b32 v146, a6
  v_accvgpr_read_b32 v147, a7
  v_mul_f32 v144, v144, v241
  v_mul_f32 v145, v145, v241
  v_mul_f32 v146, v146, v241
  v_mul_f32 v147, v147, v241
  v_accvgpr_write_b32 a4, v144
  v_accvgpr_write_b32 a5, v145
  v_accvgpr_write_b32 a6, v146
  v_accvgpr_write_b32 a7, v147
  v_accvgpr_read_b32 v144, a8
  v_accvgpr_read_b32 v145, a9
  v_accvgpr_read_b32 v146, a10
  v_accvgpr_read_b32 v147, a11
  v_mul_f32 v144, v144, v240
  v_mul_f32 v145, v145, v240
  v_mul_f32 v146, v146, v240
  v_mul_f32 v147, v147, v240
  v_accvgpr_write_b32 a8, v144
  v_accvgpr_write_b32 a9, v145
  v_accvgpr_write_b32 a10, v146
  v_accvgpr_write_b32 a11, v147
  v_accvgpr_read_b32 v144, a12
  v_accvgpr_read_b32 v145, a13
  v_accvgpr_read_b32 v146, a14
  v_accvgpr_read_b32 v147, a15
  v_mul_f32 v144, v144, v241
  v_mul_f32 v145, v145, v241
  v_mul_f32 v146, v146, v241
  v_mul_f32 v147, v147, v241
  v_accvgpr_write_b32 a12, v144
  v_accvgpr_write_b32 a13, v145
  v_accvgpr_write_b32 a14, v146
  v_accvgpr_write_b32 a15, v147
  v_accvgpr_read_b32 v144, a16
  v_accvgpr_read_b32 v145, a17
  v_accvgpr_read_b32 v146, a18
  v_accvgpr_read_b32 v147, a19
  v_mul_f32 v144, v144, v240
  v_mul_f32 v145, v145, v240
  v_mul_f32 v146, v146, v240
  v_mul_f32 v147, v147, v240
  v_accvgpr_write_b32 a16, v144
  v_accvgpr_write_b32 a17, v145
  v_accvgpr_write_b32 a18, v146
  v_accvgpr_write_b32 a19, v147
  v_accvgpr_read_b32 v144, a20
  v_accvgpr_read_b32 v145, a21
  v_accvgpr_read_b32 v146, a22
  v_accvgpr_read_b32 v147, a23
  v_mul_f32 v144, v144, v241
  v_mul_f32 v145, v145, v241
  v_mul_f32 v146, v146, v241
  v_mul_f32 v147, v147, v241
  v_accvgpr_write_b32 a20, v144
  v_accvgpr_write_b32 a21, v145
  v_accvgpr_write_b32 a22, v146
  v_accvgpr_write_b32 a23, v147
  v_accvgpr_read_b32 v144, a24
  v_accvgpr_read_b32 v145, a25
  v_accvgpr_read_b32 v146, a26
  v_accvgpr_read_b32 v147, a27
  v_mul_f32 v144, v144, v240
  v_mul_f32 v145, v145, v240
  v_mul_f32 v146, v146, v240
  v_mul_f32 v147, v147, v240
  v_accvgpr_write_b32 a24, v144
  v_accvgpr_write_b32 a25, v145
  v_accvgpr_write_b32 a26, v146
  v_accvgpr_write_b32 a27, v147
  v_accvgpr_read_b32 v144, a28
  v_accvgpr_read_b32 v145, a29
  v_accvgpr_read_b32 v146, a30
  v_accvgpr_read_b32 v147, a31
  v_mul_f32 v144, v144, v241
  v_mul_f32 v145, v145, v241
  v_mul_f32 v146, v146, v241
  v_mul_f32 v147, v147, v241
  v_accvgpr_write_b32 a28, v144
  v_accvgpr_write_b32 a29, v145
  v_accvgpr_write_b32 a30, v146
  v_accvgpr_write_b32 a31, v147
  v_accvgpr_read_b32 v144, a32
  v_accvgpr_read_b32 v145, a33
  v_accvgpr_read_b32 v146, a34
  v_accvgpr_read_b32 v147, a35
  v_mul_f32 v144, v144, v240
  v_mul_f32 v145, v145, v240
  v_mul_f32 v146, v146, v240
  v_mul_f32 v147, v147, v240
  v_accvgpr_write_b32 a32, v144
  v_accvgpr_write_b32 a33, v145
  v_accvgpr_write_b32 a34, v146
  v_accvgpr_write_b32 a35, v147
  v_accvgpr_read_b32 v144, a36
  v_accvgpr_read_b32 v145, a37
  v_accvgpr_read_b32 v146, a38
  v_accvgpr_read_b32 v147, a39
  v_mul_f32 v144, v144, v241
  v_mul_f32 v145, v145, v241
  v_mul_f32 v146, v146, v241
  v_mul_f32 v147, v147, v241
  v_accvgpr_write_b32 a36, v144
  v_accvgpr_write_b32 a37, v145
  v_accvgpr_write_b32 a38, v146
  v_accvgpr_write_b32 a39, v147
  v_accvgpr_read_b32 v144, a40
  v_accvgpr_read_b32 v145, a41
  v_accvgpr_read_b32 v146, a42
  v_accvgpr_read_b32 v147, a43
  v_mul_f32 v144, v144, v240
  v_mul_f32 v145, v145, v240
  v_mul_f32 v146, v146, v240
  v_mul_f32 v147, v147, v240
  v_accvgpr_write_b32 a40, v144
  v_accvgpr_write_b32 a41, v145
  v_accvgpr_write_b32 a42, v146
  v_accvgpr_write_b32 a43, v147
  v_accvgpr_read_b32 v144, a44
  v_accvgpr_read_b32 v145, a45
  v_accvgpr_read_b32 v146, a46
  v_accvgpr_read_b32 v147, a47
  v_mul_f32 v144, v144, v241
  v_mul_f32 v145, v145, v241
  v_mul_f32 v146, v146, v241
  v_mul_f32 v147, v147, v241
  v_accvgpr_write_b32 a44, v144
  v_accvgpr_write_b32 a45, v145
  v_accvgpr_write_b32 a46, v146
  v_accvgpr_write_b32 a47, v147
  v_accvgpr_read_b32 v144, a48
  v_accvgpr_read_b32 v145, a49
  v_accvgpr_read_b32 v146, a50
  v_accvgpr_read_b32 v147, a51
  v_mul_f32 v144, v144, v240
  v_mul_f32 v145, v145, v240
  v_mul_f32 v146, v146, v240
  v_mul_f32 v147, v147, v240
  v_accvgpr_write_b32 a48, v144
  v_accvgpr_write_b32 a49, v145
  v_accvgpr_write_b32 a50, v146
  v_accvgpr_write_b32 a51, v147
  v_accvgpr_read_b32 v144, a52
  v_accvgpr_read_b32 v145, a53
  v_accvgpr_read_b32 v146, a54
  v_accvgpr_read_b32 v147, a55
  v_mul_f32 v144, v144, v241
  v_mul_f32 v145, v145, v241
  v_mul_f32 v146, v146, v241
  v_mul_f32 v147, v147, v241
  v_accvgpr_write_b32 a52, v144
  v_accvgpr_write_b32 a53, v145
  v_accvgpr_write_b32 a54, v146
  v_accvgpr_write_b32 a55, v147
  v_accvgpr_read_b32 v144, a56
  v_accvgpr_read_b32 v145, a57
  v_accvgpr_read_b32 v146, a58
  v_accvgpr_read_b32 v147, a59
  v_mul_f32 v144, v144, v240
  v_mul_f32 v145, v145, v240
  v_mul_f32 v146, v146, v240
  v_mul_f32 v147, v147, v240
  v_accvgpr_write_b32 a56, v144
  v_accvgpr_write_b32 a57, v145
  v_accvgpr_write_b32 a58, v146
  v_accvgpr_write_b32 a59, v147
  v_accvgpr_read_b32 v144, a60
  v_accvgpr_read_b32 v145, a61
  v_accvgpr_read_b32 v146, a62
  v_accvgpr_read_b32 v147, a63
  v_mul_f32 v144, v144, v241
  v_mul_f32 v145, v145, v241
  v_mul_f32 v146, v146, v241
  v_mul_f32 v147, v147, v241
  v_accvgpr_write_b32 a60, v144
  v_accvgpr_write_b32 a61, v145
  v_accvgpr_write_b32 a62, v146
  v_accvgpr_write_b32 a63, v147
  v_exp_f32 v144, v32
  v_exp_f32 v145, v33
  v_exp_f32 v146, v34
  v_exp_f32 v147, v35
  v_add_f32 v156, v144, v145
  v_cvt_pk_bf16_f32 v136, v144, v145
  v_exp_f32 v144, v36
  v_exp_f32 v145, v37
  v_add_f32 v156, v156, v146
  v_add_f32 v156, v156, v147
  v_cvt_pk_bf16_f32 v137, v146, v147
  v_exp_f32 v146, v38
  v_exp_f32 v147, v39
  v_add_f32 v156, v156, v144
  v_add_f32 v156, v156, v145
  v_cvt_pk_bf16_f32 v138, v144, v145
  v_exp_f32 v144, v40
  v_exp_f32 v145, v41
  v_add_f32 v156, v156, v146
  v_add_f32 v156, v156, v147
  v_cvt_pk_bf16_f32 v139, v146, v147
  v_add_f32 v150, v148, v156
  v_exp_f32 v146, v42
  v_exp_f32 v147, v43
  v_add_f32 v157, v144, v145
  v_cvt_pk_bf16_f32 v140, v144, v145
  v_exp_f32 v144, v44
  v_exp_f32 v145, v45
  v_add_f32 v157, v157, v146
  v_add_f32 v157, v157, v147
  v_cvt_pk_bf16_f32 v141, v146, v147
  v_exp_f32 v146, v46
  v_exp_f32 v147, v47
  v_add_f32 v157, v157, v144
  v_add_f32 v157, v157, v145
  v_cvt_pk_bf16_f32 v142, v144, v145
  v_add_f32 v157, v157, v146
  v_add_f32 v157, v157, v147
  v_cvt_pk_bf16_f32 v143, v146, v147
  v_add_f32 v151, v149, v157
  s_nop 1
  s_setpc_b64 s[62:63]
L_end:
  s_endpgm
.section .rodata,"a"
.p2align 6
.amdhsa_kernel concat_heads__mha_block_cached__mha_block_cached__near_ridge_kernel
  .amdhsa_next_free_vgpr 512
  .amdhsa_next_free_sgpr 102
  .amdhsa_accum_offset 256
  .amdhsa_group_segment_fixed_size 0
  .amdhsa_kernarg_size 104
  .amdhsa_user_sgpr_count 2
  .amdhsa_user_sgpr_kernarg_segment_ptr 1
  .amdhsa_system_sgpr_workgroup_id_x 1
.end_amdhsa_kernel
```
